```python
import torch

def _softmax(x, axis=-1):
    return torch.softmax(x, dim=axis)
def _gelu(x):
    return torch.nn.functional.gelu(x, approximate="tanh")
def _silu(x):
    return torch.nn.functional.silu(x)
def _sigmoid(x):
    return torch.sigmoid(x)
def _layernorm(x, axis=-1, eps=1e-5):
    m = x.mean(dim=axis, keepdim=True)
    v = x.var(dim=axis, keepdim=True, unbiased=False)
    return (x - m) / torch.sqrt(v + eps)
def _scatter_add(tgt, idx, src, axis=0):
    return tgt.clone().index_add_(axis, idx, src)
def _segment_sum(src, seg, n):
    out = torch.zeros((n,) + src.shape[1:], dtype=src.dtype)
    return out.index_add_(0, seg, src)
def _pad(x, pw):
    flat = tuple(v for pair in reversed(pw) for v in pair)
    return torch.nn.functional.pad(x, flat)

kernel_name = 'standalone__softmax_full_causal__prompt'

def setup_inputs():

    _w = (lambda a: (lambda t: t.to(torch.bfloat16) if t.is_floating_point() else t)(torch.as_tensor(a)))
    B, H, S, D = 1, 16, 2048, 256
    return {
        "q": _w((lambda *s: torch.randn(*s, dtype=torch.bfloat16) * 0.8)(B, H, S, D)),
        "k": _w((lambda *s: torch.randn(*s, dtype=torch.bfloat16) * 0.8)(B, H, S, D)),
        "v": _w((lambda *s: torch.randn(*s, dtype=torch.bfloat16) * 0.05)(B, H, S, D)),
    }

def reference(q, k, v):
    B, H, S, D = q.shape[0], q.shape[1], q.shape[2], q.shape[3]
    scale = D ** -0.5
    scores = torch.einsum('bhqd,bhkd->bhqk', q, k) * scale
    qi = torch.reshape(torch.arange(S), (1, 1, S, 1))
    kj = torch.reshape(torch.arange(S), (1, 1, 1, S))
    causal_bias = (lambda x, dt: x.to(dt))(kj > qi, scores.dtype) * (-1e9)
    attn = _softmax(scores + causal_bias, axis=-1)
    return torch.einsum('bhqk,bhkd->bhqd', attn, v)
```

```asm
; @launch grid=(256,1,1) block=(256,1,1) lds=163840
.amdgcn_target "amdgcn-amd-amdhsa--gfx950"
.text
.globl standalone__softmax_full_causal__prompt_kernel
.p2align 8
.type standalone__softmax_full_causal__prompt_kernel,@function
standalone__softmax_full_causal__prompt_kernel:
  s_cmp_ge_u32 s2, 256
  s_cbranch_scc1 L_end
  s_load_dwordx4 s[80:83], s[0:1], 0
  s_load_dwordx4 s[84:87], s[0:1], 16
  s_load_dwordx4 s[88:91], s[0:1], 32
  v_and_b32 v1, 63, v0
  v_lshrrev_b32 v36, 6, v0
  s_nop 0
  v_readfirstlane_b32 s28, v36
  s_and_b32 s52, s2, 7
  s_lshr_b32 s53, s2, 3
  s_and_b32 s54, s53, 1
  s_lshl_b32 s52, s52, 1
  s_or_b32 s52, s52, s54
  s_lshr_b32 s53, s53, 1
  s_lshl_b32 s29, s52, 20
  s_mov_b32 s30, 0x3db8aa3b
  s_mov_b32 s45, 0x7ff00000
  s_mov_b32 s37, 0
  s_mov_b32 s38, 0
  s_mov_b32 s40, s29
  s_lshl_b32 s44, s28, 13
  s_mov_b32 s78, s53
  s_mov_b32 s79, 1
  s_add_u32 s76, s53, 16
  s_lshl_b32 s76, s76, 15
  s_add_u32 s76, s76, s29
  s_mov_b32 s77, s76
  s_sub_u32 s54, 15, s53
  s_min_u32 s64, s53, s54
  s_lshl_b32 s54, s64, 1
  s_lshr_b32 s55, 0x1555, s54
  s_and_b32 s55, s55, 3
  s_sub_u32 s39, 15, s54
  s_sub_u32 s39, s39, s55
  s_cmp_lt_u32 s53, 8
  s_cbranch_scc0 L_typeA
  s_sub_u32 s49, 15, s53
  s_sub_u32 s41, 17, s55
  s_mov_b32 s50, s39
  s_mov_b32 s32, 0
  s_mov_b32 s33, 1000
  s_mov_b32 s48, 0
  s_lshl_b32 s65, s53, 16
  s_add_u32 s65, s65, s29
  s_mov_b32 s43, 2
  s_mov_b32 s66, 100000
  s_mov_b32 s98, 100000
  s_branch L_common
L_typeA:
  s_mov_b32 s49, s53
  s_add_u32 s41, 17, s55
  s_mov_b32 s50, s41
  s_lshl_b32 s33, s53, 1
  s_mov_b32 s48, 2
  s_mov_b32 s32, s39
  s_mov_b32 s39, s41
  s_mov_b32 s66, 100000
  s_mov_b32 s65, s45
  s_mov_b32 s43, 2
  s_lshl_b32 s98, s64, 1
  s_add_u32 s98, s98, 2
  s_add_u32 s98, s98, s55
  s_add_u32 s98, s98, s55
L_common:
  s_mov_b32 s99, 0
  s_lshl_b32 s51, s52, 3
  s_add_u32 s51, s51, s64
  s_mul_i32 s46, s51, 0x21000
  s_lshl_b32 s34, s32, 15
  s_add_u32 s34, s34, s29
  s_mov_b32 s35, s34
  s_lshl_b32 s47, s49, 16
  s_add_u32 s47, s47, s29
  v_and_b32 v40, 31, v1
  v_lshrrev_b32 v41, 5, v1
  v_and_b32 v42, 15, v1
  v_xor_b32 v44, v40, v41
  v_lshlrev_b32 v44, 4, v44
  v_lshl_add_u32 v44, v41, 9, v44
  v_add_u32 v44, s44, v44
  v_xor_b32 v14, 0x0, v44
  v_xor_b32 v15, 0x20, v44
  v_xor_b32 v16, 0x40, v44
  v_xor_b32 v17, 0x60, v44
  v_xor_b32 v18, 0x1080, v44
  v_xor_b32 v19, 0x10a0, v44
  v_xor_b32 v20, 0x10c0, v44
  v_xor_b32 v21, 0x10e0, v44
  v_lshrrev_b32 v43, 4, v1
  v_xor_b32 v62, v42, v43
  v_lshlrev_b32 v62, 4, v62
  v_lshl_add_u32 v62, v43, 9, v62
  s_lshl_b32 s53, s28, 14
  v_add_u32 v62, s53, v62
  v_xor_b32 v24, v41, v42
  v_lshlrev_b32 v24, 4, v24
  v_lshl_add_u32 v24, v40, 8, v24
  s_add_u32 s53, s44, 98304
  v_add_u32 v24, s53, v24
  s_waitcnt lgkmcnt(0)
  s_mov_b32 s8, s82
  s_and_b32 s9, s83, 0xffff
  s_mov_b32 s10, 0x1000000
  s_mov_b32 s11, 0x00020000
  s_mov_b32 s4, s80
  s_and_b32 s5, s81, 0xffff
  s_mov_b32 s6, 0x1000000
  s_mov_b32 s7, 0x00020000
  s_add_u32 m0, s44, 0
  s_nop 0
  buffer_load_dwordx4 v14, s[8:11], s34 offen offset:0 lds
  buffer_load_dwordx4 v15, s[8:11], s34 offen offset:1024 lds
  buffer_load_dwordx4 v16, s[8:11], s34 offen offset:2048 lds
  buffer_load_dwordx4 v17, s[8:11], s34 offen offset:3072 lds
  s_add_u32 m0, s44, 4096
  s_nop 0
  buffer_load_dwordx4 v18, s[8:11], s34 offen offset:0 lds
  buffer_load_dwordx4 v19, s[8:11], s34 offen offset:1024 lds
  buffer_load_dwordx4 v20, s[8:11], s34 offen offset:2048 lds
  buffer_load_dwordx4 v21, s[8:11], s34 offen offset:3072 lds
  s_add_u32 s37, s37, 1
  s_add_u32 s34, s34, 0x8000
  s_cmp_eq_u32 s37, s39
  s_cselect_b32 s34, s40, s34
  s_cmp_ge_u32 s37, s41
  s_cselect_b32 s34, s45, s34
  v_mov_b32 v128, v40
  v_mov_b32 v129, v41
  v_mov_b32 v130, v42
  v_xor_b32 v40, 0x0, v62
  s_add_u32 m0, s44, 131072
  s_add_u32 s55, s47, 0
  buffer_load_dwordx4 v40, s[4:7], s55 offen lds
  v_xor_b32 v41, 0x40, v62
  s_add_u32 m0, s44, 132096
  s_add_u32 s55, s47, 2048
  buffer_load_dwordx4 v41, s[4:7], s55 offen lds
  v_xor_b32 v42, 0x80, v62
  s_add_u32 m0, s44, 133120
  s_add_u32 s55, s47, 4096
  buffer_load_dwordx4 v42, s[4:7], s55 offen lds
  v_xor_b32 v43, 0xc0, v62
  s_add_u32 m0, s44, 134144
  s_add_u32 s55, s47, 6144
  buffer_load_dwordx4 v43, s[4:7], s55 offen lds
  v_xor_b32 v40, 0x0, v62
  s_add_u32 m0, s44, 135168
  s_add_u32 s55, s47, 8192
  buffer_load_dwordx4 v40, s[4:7], s55 offen lds
  v_xor_b32 v41, 0x40, v62
  s_add_u32 m0, s44, 136192
  s_add_u32 s55, s47, 10240
  buffer_load_dwordx4 v41, s[4:7], s55 offen lds
  v_xor_b32 v42, 0x80, v62
  s_add_u32 m0, s44, 137216
  s_add_u32 s55, s47, 12288
  buffer_load_dwordx4 v42, s[4:7], s55 offen lds
  v_xor_b32 v43, 0xc0, v62
  s_add_u32 m0, s44, 138240
  s_add_u32 s55, s47, 14336
  buffer_load_dwordx4 v43, s[4:7], s55 offen lds
  v_xor_b32 v40, 0x0, v62
  s_add_u32 m0, s44, 98304
  s_add_u32 s55, s47, 256
  buffer_load_dwordx4 v40, s[4:7], s55 offen lds
  v_xor_b32 v41, 0x40, v62
  s_add_u32 m0, s44, 99328
  s_add_u32 s55, s47, 2304
  buffer_load_dwordx4 v41, s[4:7], s55 offen lds
  v_xor_b32 v42, 0x80, v62
  s_add_u32 m0, s44, 100352
  s_add_u32 s55, s47, 4352
  buffer_load_dwordx4 v42, s[4:7], s55 offen lds
  v_xor_b32 v43, 0xc0, v62
  s_add_u32 m0, s44, 101376
  s_add_u32 s55, s47, 6400
  buffer_load_dwordx4 v43, s[4:7], s55 offen lds
  v_xor_b32 v40, 0x0, v62
  s_add_u32 m0, s44, 102400
  s_add_u32 s55, s47, 8448
  buffer_load_dwordx4 v40, s[4:7], s55 offen lds
  v_xor_b32 v41, 0x40, v62
  s_add_u32 m0, s44, 103424
  s_add_u32 s55, s47, 10496
  buffer_load_dwordx4 v41, s[4:7], s55 offen lds
  v_xor_b32 v42, 0x80, v62
  s_add_u32 m0, s44, 104448
  s_add_u32 s55, s47, 12544
  buffer_load_dwordx4 v42, s[4:7], s55 offen lds
  v_xor_b32 v43, 0xc0, v62
  s_add_u32 m0, s44, 105472
  s_add_u32 s55, s47, 14592
  buffer_load_dwordx4 v43, s[4:7], s55 offen lds
  v_mov_b32 v40, v128
  v_mov_b32 v41, v129
  v_mov_b32 v42, v130
  s_mov_b32 s12, s84
  s_and_b32 s13, s85, 0xffff
  s_mov_b32 s14, 0x1000000
  s_mov_b32 s15, 0x00020000
  s_mov_b32 s16, s86
  s_and_b32 s17, s87, 0xffff
  s_mov_b32 s18, 0x1000000
  s_mov_b32 s19, 0x00020000
  s_mov_b32 s24, s88
  s_and_b32 s25, s89, 0xffff
  s_mov_b32 s26, 0x100
  s_mov_b32 s27, 0x00020000
  s_mov_b32 s20, s90
  s_and_b32 s21, s91, 0xffff
  s_mov_b32 s22, 0x10000000
  s_mov_b32 s23, 0x00020000
  s_mov_b64 s[68:69], s[8:9]
  s_mov_b64 s[70:71], s[10:11]
  s_mov_b64 s[72:73], s[12:13]
  s_mov_b64 s[74:75], s[14:15]
  v_xor_b32 v43, v41, v42
  v_lshlrev_b32 v43, 4, v43
  v_lshl_add_u32 v43, v40, 9, v43
  v_xor_b32 v2, 0x0, v43
  v_xor_b32 v3, 0x20, v43
  v_xor_b32 v4, 0x40, v43
  v_xor_b32 v5, 0x60, v43
  v_xor_b32 v6, 0x80, v43
  v_xor_b32 v7, 0xa0, v43
  v_xor_b32 v8, 0xc0, v43
  v_xor_b32 v9, 0xe0, v43
  v_lshlrev_b32 v43, 2, v41
  v_xor_b32 v43, v43, v40
  v_lshlrev_b32 v43, 4, v43
  v_lshl_add_u32 v43, v41, 9, v43
  v_add_u32 v22, s44, v43
  v_xor_b32 v23, 0x80, v22
  v_lshrrev_b32 v43, 2, v42
  v_lshl_add_u32 v44, v41, 2, v43
  v_lshlrev_b32 v44, 9, v44
  v_bfe_u32 v40, v1, 4, 1
  v_lshl_add_u32 v44, v40, 5, v44
  v_and_b32 v40, 3, v1
  v_lshl_add_u32 v44, v40, 3, v44
  v_add_u32 v44, 0x10000, v44
  v_xor_b32 v40, 0, v43
  v_lshl_add_u32 v10, v40, 6, v44
  v_xor_b32 v40, 1, v43
  v_lshl_add_u32 v11, v40, 6, v44
  v_xor_b32 v40, 2, v43
  v_lshl_add_u32 v12, v40, 6, v44
  v_xor_b32 v40, 3, v43
  v_lshl_add_u32 v13, v40, 6, v44
  v_lshlrev_b32 v25, 4, v1
  v_lshlrev_b32 v48, 7, v0
  v_mov_b32 v37, 0xff800000
  v_mov_b32 v61, 0
  s_lshl_b32 s52, s49, 7
  s_lshl_b32 s53, s28, 5
  s_add_u32 s52, s52, s53
  v_and_b32 v36, 31, v1
  v_lshrrev_b32 v39, 5, v1
  v_lshlrev_b32 v39, 2, v39
  v_sub_u32 v36, v36, v39
  v_add_u32 v26, s52, v36
  v_mov_b32 v30, 0
  v_mov_b32 v31, 0
  v_mov_b32 v32, 0
  v_mov_b32 v33, 0
  s_mov_b32 s42, 0
  s_sub_u32 s31, s50, 1
  s_waitcnt vmcnt(0)
  v_xor_b32 v44, 0x0, v24
  ds_read_b128 a[128:131], v44 offset:32768
  v_xor_b32 v45, 0x20, v24
  ds_read_b128 a[132:135], v45 offset:32768
  v_xor_b32 v46, 0x40, v24
  ds_read_b128 a[136:139], v46 offset:32768
  v_xor_b32 v47, 0x60, v24
  ds_read_b128 a[140:143], v47 offset:32768
  v_xor_b32 v44, 0x80, v24
  ds_read_b128 a[144:147], v44 offset:32768
  v_xor_b32 v45, 0xa0, v24
  ds_read_b128 a[148:151], v45 offset:32768
  v_xor_b32 v46, 0xc0, v24
  ds_read_b128 a[152:155], v46 offset:32768
  v_xor_b32 v47, 0xe0, v24
  ds_read_b128 a[156:159], v47 offset:32768
  v_xor_b32 v44, 0x0, v24
  ds_read_b128 a[160:163], v44 offset:0
  v_xor_b32 v45, 0x20, v24
  ds_read_b128 a[164:167], v45 offset:0
  v_xor_b32 v46, 0x40, v24
  ds_read_b128 a[168:171], v46 offset:0
  v_xor_b32 v47, 0x60, v24
  ds_read_b128 a[172:175], v47 offset:0
  v_xor_b32 v44, 0x80, v24
  ds_read_b128 a[176:179], v44 offset:0
  v_xor_b32 v45, 0xa0, v24
  ds_read_b128 a[180:183], v45 offset:0
  v_xor_b32 v46, 0xc0, v24
  ds_read_b128 a[184:187], v46 offset:0
  v_xor_b32 v47, 0xe0, v24
  ds_read_b128 a[188:191], v47 offset:0
  s_waitcnt lgkmcnt(0)
  s_barrier
  ds_read_b128 v[128:131], v2 offset:0
  ds_read_b128 v[132:135], v3 offset:0
  ds_read_b128 v[136:139], v4 offset:0
  ds_read_b128 v[140:143], v5 offset:0
  ds_read_b128 v[144:147], v6 offset:0
  ds_read_b128 v[148:151], v7 offset:0
  s_waitcnt lgkmcnt(4)
  v_mfma_f32_32x32x16_bf16 v[64:79], v[128:131], a[128:131], 0
  ds_read_b128 v[152:155], v8 offset:0
  v_accvgpr_write_b32 a0, 0
  s_add_u32 m0, s44, 32768
  s_nop 0
  buffer_load_dwordx4 v14, s[8:11], s34 offen offset:0 lds
  v_accvgpr_write_b32 a1, 0
  v_mfma_f32_32x32x16_bf16 v[64:79], v[132:135], a[132:135], v[64:79]
  ds_read_b128 v[156:159], v9 offset:0
  v_accvgpr_write_b32 a2, 0
  buffer_load_dwordx4 v15, s[8:11], s34 offen offset:1024 lds
  v_accvgpr_write_b32 a3, 0
  s_waitcnt lgkmcnt(4)
  v_mfma_f32_32x32x16_bf16 v[64:79], v[136:139], a[136:139], v[64:79]
  ds_read_b128 v[128:131], v2 offset:256
  v_accvgpr_write_b32 a4, 0
  buffer_load_dwordx4 v16, s[8:11], s34 offen offset:2048 lds
  v_accvgpr_write_b32 a5, 0
  v_accvgpr_write_b32 a6, 0
  v_mfma_f32_32x32x16_bf16 v[64:79], v[140:143], a[140:143], v[64:79]
  ds_read_b128 v[132:135], v3 offset:256
  v_accvgpr_write_b32 a7, 0
  buffer_load_dwordx4 v17, s[8:11], s34 offen offset:3072 lds
  v_accvgpr_write_b32 a8, 0
  v_accvgpr_write_b32 a9, 0
  s_waitcnt lgkmcnt(4)
  v_mfma_f32_32x32x16_bf16 v[64:79], v[144:147], a[144:147], v[64:79]
  ds_read_b128 v[136:139], v4 offset:256
  v_accvgpr_write_b32 a10, 0
  s_add_u32 m0, s44, 36864
  s_nop 0
  buffer_load_dwordx4 v18, s[8:11], s34 offen offset:0 lds
  v_mfma_f32_32x32x16_bf16 v[64:79], v[148:151], a[148:151], v[64:79]
  ds_read_b128 v[140:143], v5 offset:256
  v_accvgpr_write_b32 a11, 0
  buffer_load_dwordx4 v19, s[8:11], s34 offen offset:1024 lds
  v_accvgpr_write_b32 a12, 0
  v_accvgpr_write_b32 a13, 0
  s_waitcnt lgkmcnt(4)
  v_mfma_f32_32x32x16_bf16 v[64:79], v[152:155], a[152:155], v[64:79]
  ds_read_b128 v[144:147], v6 offset:256
  v_accvgpr_write_b32 a14, 0
  buffer_load_dwordx4 v20, s[8:11], s34 offen offset:2048 lds
  v_accvgpr_write_b32 a15, 0
  v_mfma_f32_32x32x16_bf16 v[64:79], v[156:159], a[156:159], v[64:79]
  ds_read_b128 v[148:151], v7 offset:256
  v_accvgpr_write_b32 a16, 0
  buffer_load_dwordx4 v21, s[8:11], s34 offen offset:3072 lds
  v_accvgpr_write_b32 a17, 0
  v_accvgpr_write_b32 a18, 0
  s_waitcnt lgkmcnt(4)
  v_mfma_f32_32x32x16_bf16 v[64:79], v[128:131], a[160:163], v[64:79]
  ds_read_b128 v[152:155], v8 offset:256
  v_accvgpr_write_b32 a19, 0
  s_add_u32 s37, s37, 1
  s_add_u32 s34, s34, 0x8000
  s_cmp_eq_u32 s37, s39
  s_cselect_b32 s34, s40, s34
  s_cmp_ge_u32 s37, s41
  s_cselect_b32 s34, s45, s34
  v_accvgpr_write_b32 a20, 0
  v_accvgpr_write_b32 a21, 0
  v_mfma_f32_32x32x16_bf16 v[64:79], v[132:135], a[164:167], v[64:79]
  ds_read_b128 v[156:159], v9 offset:256
  v_accvgpr_write_b32 a22, 0
  s_add_u32 s36, s35, 0x1000
  s_add_u32 m0, s44, 65536
  s_nop 0
  buffer_load_dwordx4 v22, s[12:15], s35 offen offset:0 lds
  s_waitcnt lgkmcnt(4)
  v_mfma_f32_32x32x16_bf16 v[64:79], v[136:139], a[168:171], v[64:79]
  ds_read_b128 v[128:131], v2 offset:16384
  v_accvgpr_write_b32 a23, 0
  buffer_load_dwordx4 v23, s[12:15], s35 offen offset:1024 lds
  v_accvgpr_write_b32 a24, 0
  v_accvgpr_write_b32 a25, 0
  v_mfma_f32_32x32x16_bf16 v[64:79], v[140:143], a[172:175], v[64:79]
  ds_read_b128 v[132:135], v3 offset:16384
  v_accvgpr_write_b32 a26, 0
  buffer_load_dwordx4 v22, s[12:15], s35 offen offset:2048 lds
  v_accvgpr_write_b32 a27, 0
  s_waitcnt lgkmcnt(4)
  v_mfma_f32_32x32x16_bf16 v[64:79], v[144:147], a[176:179], v[64:79]
  ds_read_b128 v[136:139], v4 offset:16384
  v_accvgpr_write_b32 a28, 0
  buffer_load_dwordx4 v23, s[12:15], s35 offen offset:3072 lds
  v_accvgpr_write_b32 a29, 0
  v_accvgpr_write_b32 a30, 0
  v_mfma_f32_32x32x16_bf16 v[64:79], v[148:151], a[180:183], v[64:79]
  ds_read_b128 v[140:143], v5 offset:16384
  v_accvgpr_write_b32 a31, 0
  s_add_u32 m0, s44, 69632
  s_nop 0
  buffer_load_dwordx4 v22, s[12:15], s36 offen offset:0 lds
  s_waitcnt lgkmcnt(4)
  v_mfma_f32_32x32x16_bf16 v[64:79], v[152:155], a[184:187], v[64:79]
  ds_read_b128 v[144:147], v6 offset:16384
  v_accvgpr_write_b32 a32, 0
  buffer_load_dwordx4 v23, s[12:15], s36 offen offset:1024 lds
  v_accvgpr_write_b32 a33, 0
  v_accvgpr_write_b32 a34, 0
  v_mfma_f32_32x32x16_bf16 v[64:79], v[156:159], a[188:191], v[64:79]
  ds_read_b128 v[148:151], v7 offset:16384
  v_accvgpr_write_b32 a35, 0
  buffer_load_dwordx4 v22, s[12:15], s36 offen offset:2048 lds
  v_accvgpr_write_b32 a36, 0
  v_accvgpr_write_b32 a37, 0
  s_waitcnt lgkmcnt(4)
  v_mfma_f32_32x32x16_bf16 v[80:95], v[128:131], a[128:131], 0
  ds_read_b128 v[152:155], v8 offset:16384
  v_accvgpr_write_b32 a38, 0
  buffer_load_dwordx4 v23, s[12:15], s36 offen offset:3072 lds
  v_accvgpr_write_b32 a39, 0
  v_mfma_f32_32x32x16_bf16 v[80:95], v[132:135], a[132:135], v[80:95]
  ds_read_b128 v[156:159], v9 offset:16384
  v_accvgpr_write_b32 a40, 0
  s_add_u32 s38, s38, 1
  s_add_u32 s35, s35, 0x8000
  s_cmp_eq_u32 s38, s39
  s_cselect_b32 s35, s40, s35
  s_cmp_ge_u32 s38, s41
  s_cselect_b32 s35, s45, s35
  v_accvgpr_write_b32 a41, 0
  v_accvgpr_write_b32 a42, 0
  s_waitcnt lgkmcnt(4)
  v_mfma_f32_32x32x16_bf16 v[80:95], v[136:139], a[136:139], v[80:95]
  ds_read_b128 v[128:131], v2 offset:16640
  v_accvgpr_write_b32 a43, 0
  v_accvgpr_write_b32 a44, 0
  v_accvgpr_write_b32 a45, 0
  v_accvgpr_write_b32 a46, 0
  v_accvgpr_write_b32 a47, 0
  v_accvgpr_write_b32 a48, 0
  v_mfma_f32_32x32x16_bf16 v[80:95], v[140:143], a[140:143], v[80:95]
  ds_read_b128 v[132:135], v3 offset:16640
  v_accvgpr_write_b32 a49, 0
  v_accvgpr_write_b32 a50, 0
  v_accvgpr_write_b32 a51, 0
  v_accvgpr_write_b32 a52, 0
  v_accvgpr_write_b32 a53, 0
  s_waitcnt lgkmcnt(4)
  v_mfma_f32_32x32x16_bf16 v[80:95], v[144:147], a[144:147], v[80:95]
  ds_read_b128 v[136:139], v4 offset:16640
  v_accvgpr_write_b32 a54, 0
  v_accvgpr_write_b32 a55, 0
  v_accvgpr_write_b32 a56, 0
  v_accvgpr_write_b32 a57, 0
  v_accvgpr_write_b32 a58, 0
  v_accvgpr_write_b32 a59, 0
  v_mfma_f32_32x32x16_bf16 v[80:95], v[148:151], a[148:151], v[80:95]
  ds_read_b128 v[140:143], v5 offset:16640
  v_accvgpr_write_b32 a60, 0
  v_accvgpr_write_b32 a61, 0
  v_accvgpr_write_b32 a62, 0
  v_accvgpr_write_b32 a63, 0
  v_accvgpr_write_b32 a64, 0
  v_accvgpr_write_b32 a65, 0
  s_waitcnt lgkmcnt(4)
  v_mfma_f32_32x32x16_bf16 v[80:95], v[152:155], a[152:155], v[80:95]
  ds_read_b128 v[144:147], v6 offset:16640
  v_accvgpr_write_b32 a66, 0
  v_accvgpr_write_b32 a67, 0
  v_accvgpr_write_b32 a68, 0
  v_accvgpr_write_b32 a69, 0
  v_accvgpr_write_b32 a70, 0
  v_mfma_f32_32x32x16_bf16 v[80:95], v[156:159], a[156:159], v[80:95]
  ds_read_b128 v[148:151], v7 offset:16640
  v_accvgpr_write_b32 a71, 0
  v_accvgpr_write_b32 a72, 0
  v_accvgpr_write_b32 a73, 0
  v_accvgpr_write_b32 a74, 0
  v_accvgpr_write_b32 a75, 0
  v_accvgpr_write_b32 a76, 0
  s_waitcnt lgkmcnt(4)
  v_mfma_f32_32x32x16_bf16 v[80:95], v[128:131], a[160:163], v[80:95]
  ds_read_b128 v[152:155], v8 offset:16640
  v_accvgpr_write_b32 a77, 0
  v_accvgpr_write_b32 a78, 0
  v_accvgpr_write_b32 a79, 0
  v_accvgpr_write_b32 a80, 0
  v_accvgpr_write_b32 a81, 0
  v_accvgpr_write_b32 a82, 0
  v_mfma_f32_32x32x16_bf16 v[80:95], v[132:135], a[164:167], v[80:95]
  ds_read_b128 v[156:159], v9 offset:16640
  v_accvgpr_write_b32 a83, 0
  v_accvgpr_write_b32 a84, 0
  v_accvgpr_write_b32 a85, 0
  v_accvgpr_write_b32 a86, 0
  v_accvgpr_write_b32 a87, 0
  s_waitcnt lgkmcnt(4)
  v_mfma_f32_32x32x16_bf16 v[80:95], v[136:139], a[168:171], v[80:95]
  v_accvgpr_write_b32 a88, 0
  v_accvgpr_write_b32 a89, 0
  v_accvgpr_write_b32 a90, 0
  v_accvgpr_write_b32 a91, 0
  v_accvgpr_write_b32 a92, 0
  v_accvgpr_write_b32 a93, 0
  v_accvgpr_write_b32 a94, 0
  v_mfma_f32_32x32x16_bf16 v[80:95], v[140:143], a[172:175], v[80:95]
  v_accvgpr_write_b32 a95, 0
  v_accvgpr_write_b32 a96, 0
  v_accvgpr_write_b32 a97, 0
  v_accvgpr_write_b32 a98, 0
  v_accvgpr_write_b32 a99, 0
  v_accvgpr_write_b32 a100, 0
  s_waitcnt lgkmcnt(2)
  v_mfma_f32_32x32x16_bf16 v[80:95], v[144:147], a[176:179], v[80:95]
  v_accvgpr_write_b32 a101, 0
  v_accvgpr_write_b32 a102, 0
  v_accvgpr_write_b32 a103, 0
  v_accvgpr_write_b32 a104, 0
  v_accvgpr_write_b32 a105, 0
  v_accvgpr_write_b32 a106, 0
  v_accvgpr_write_b32 a107, 0
  v_mfma_f32_32x32x16_bf16 v[80:95], v[148:151], a[180:183], v[80:95]
  v_accvgpr_write_b32 a108, 0
  v_accvgpr_write_b32 a109, 0
  v_accvgpr_write_b32 a110, 0
  v_accvgpr_write_b32 a111, 0
  v_accvgpr_write_b32 a112, 0
  v_accvgpr_write_b32 a113, 0
  v_accvgpr_write_b32 a114, 0
  s_waitcnt lgkmcnt(0)
  v_mfma_f32_32x32x16_bf16 v[80:95], v[152:155], a[184:187], v[80:95]
  v_accvgpr_write_b32 a115, 0
  v_accvgpr_write_b32 a116, 0
  v_accvgpr_write_b32 a117, 0
  v_accvgpr_write_b32 a118, 0
  v_accvgpr_write_b32 a119, 0
  v_accvgpr_write_b32 a120, 0
  v_mfma_f32_32x32x16_bf16 v[80:95], v[156:159], a[188:191], v[80:95]
  v_accvgpr_write_b32 a121, 0
  v_accvgpr_write_b32 a122, 0
  v_accvgpr_write_b32 a123, 0
  v_accvgpr_write_b32 a124, 0
  v_accvgpr_write_b32 a125, 0
  v_accvgpr_write_b32 a126, 0
  v_accvgpr_write_b32 a127, 0
  s_waitcnt vmcnt(0) lgkmcnt(0)
  s_barrier
  ds_read_b128 v[128:131], v2 offset:32768
  ds_read_b128 v[132:135], v3 offset:32768
  ds_read_b128 v[136:139], v4 offset:32768
  ds_read_b128 v[140:143], v5 offset:32768
  ds_read_b128 v[144:147], v6 offset:32768
  ds_read_b128 v[148:151], v7 offset:32768
  s_nop 7
  s_cmp_ge_u32 s32, s33
  s_cbranch_scc1 L_mask0_1
L_ret_2:
  s_cmp_ge_u32 s32, s33
  s_cbranch_scc1 L_mask1_3
L_ret_4:
  v_max3_f32 v35, v64, v65, v66
  v_max3_f32 v35, v35, v67, v68
  v_max3_f32 v35, v35, v69, v70
  v_max3_f32 v35, v35, v71, v72
  v_max3_f32 v35, v35, v73, v74
  v_max3_f32 v35, v35, v75, v76
  v_max3_f32 v35, v35, v77, v78
  v_max_f32 v35, v35, v79
  v_max3_f32 v35, v35, v80, v81
  v_max3_f32 v35, v35, v82, v83
  v_max3_f32 v35, v35, v84, v85
  v_max3_f32 v35, v35, v86, v87
  v_max3_f32 v35, v35, v88, v89
  v_max3_f32 v35, v35, v90, v91
  v_max3_f32 v35, v35, v92, v93
  v_max3_f32 v35, v35, v94, v95
  v_mov_b32 v36, v35
  s_nop 1
  v_permlane32_swap_b32 v36, v35
  v_max_f32 v35, v35, v36
  v_mov_b32 v27, v35
  v_add_f32 v28, 0x42b17218, v35
  v_mul_f32 v29, s30, v35
  s_add_u32 s32, s32, 1
  v_fma_f32 v64, v64, s30, -v29
  v_fma_f32 v65, v65, s30, -v29
  v_exp_f32 v64, v64
  v_fma_f32 v66, v66, s30, -v29
  v_exp_f32 v65, v65
  v_fma_f32 v67, v67, s30, -v29
  v_exp_f32 v66, v66
  v_add_f32 v30, v30, v64
  v_fma_f32 v68, v68, s30, -v29
  v_exp_f32 v67, v67
  v_add_f32 v31, v31, v65
  v_cvt_pk_bf16_f32 v64, v64, v65
  v_fma_f32 v69, v69, s30, -v29
  v_exp_f32 v68, v68
  v_add_f32 v32, v32, v66
  v_fma_f32 v70, v70, s30, -v29
  v_exp_f32 v69, v69
  v_add_f32 v33, v33, v67
  v_cvt_pk_bf16_f32 v65, v66, v67
  v_fma_f32 v71, v71, s30, -v29
  v_exp_f32 v70, v70
  v_add_f32 v30, v30, v68
  v_fma_f32 v72, v72, s30, -v29
  v_exp_f32 v71, v71
  v_add_f32 v31, v31, v69
  v_cvt_pk_bf16_f32 v66, v68, v69
  v_fma_f32 v73, v73, s30, -v29
  v_exp_f32 v72, v72
  v_add_f32 v32, v32, v70
  v_fma_f32 v74, v74, s30, -v29
  v_exp_f32 v73, v73
  v_add_f32 v33, v33, v71
  v_cvt_pk_bf16_f32 v67, v70, v71
  v_fma_f32 v75, v75, s30, -v29
  v_exp_f32 v74, v74
  v_add_f32 v30, v30, v72
  v_fma_f32 v76, v76, s30, -v29
  v_exp_f32 v75, v75
  v_add_f32 v31, v31, v73
  v_cvt_pk_bf16_f32 v72, v72, v73
  v_fma_f32 v77, v77, s30, -v29
  v_exp_f32 v76, v76
  v_add_f32 v32, v32, v74
  v_fma_f32 v78, v78, s30, -v29
  v_exp_f32 v77, v77
  v_add_f32 v33, v33, v75
  v_cvt_pk_bf16_f32 v73, v74, v75
  v_fma_f32 v79, v79, s30, -v29
  v_exp_f32 v78, v78
  v_add_f32 v30, v30, v76
  v_exp_f32 v79, v79
  v_add_f32 v31, v31, v77
  v_cvt_pk_bf16_f32 v74, v76, v77
  v_add_f32 v32, v32, v78
  v_add_f32 v33, v33, v79
  v_cvt_pk_bf16_f32 v75, v78, v79
L_after_pro0:
  s_cmp_eq_u32 s31, 0
  s_cbranch_scc1 L_tail0
L_body0:
  s_cmp_lg_u32 s42, 0
  s_cbranch_scc1 L_resc_12
L_ret_13:
  s_waitcnt lgkmcnt(4)
  v_mfma_f32_32x32x16_bf16 v[96:111], v[128:131], a[128:131], 0
  ds_read_b128 v[152:155], v8 offset:32768
  s_add_u32 m0, s44, 0
  s_nop 0
  buffer_load_dwordx4 v14, s[8:11], s34 offen offset:0 lds
  v_mfma_f32_32x32x16_bf16 v[96:111], v[132:135], a[132:135], v[96:111]
  ds_read_b128 v[156:159], v9 offset:32768
  v_fma_f32 v80, v80, s30, -v29
  v_fma_f32 v81, v81, s30, -v29
  v_exp_f32 v80, v80
  s_waitcnt lgkmcnt(4)
  v_mfma_f32_32x32x16_bf16 v[96:111], v[136:139], a[136:139], v[96:111]
  ds_read_b128 v[128:131], v2 offset:33024
  v_fma_f32 v82, v82, s30, -v29
  buffer_load_dwordx4 v15, s[8:11], s34 offen offset:1024 lds
  v_mfma_f32_32x32x16_bf16 v[96:111], v[140:143], a[140:143], v[96:111]
  ds_read_b128 v[132:135], v3 offset:33024
  v_exp_f32 v81, v81
  v_fma_f32 v83, v83, s30, -v29
  v_exp_f32 v82, v82
  s_waitcnt lgkmcnt(4)
  v_mfma_f32_32x32x16_bf16 v[96:111], v[144:147], a[144:147], v[96:111]
  ds_read_b128 v[136:139], v4 offset:33024
  v_add_f32 v30, v30, v80
  v_fma_f32 v84, v84, s30, -v29
  v_exp_f32 v83, v83
  v_mfma_f32_32x32x16_bf16 v[96:111], v[148:151], a[148:151], v[96:111]
  ds_read_b128 v[140:143], v5 offset:33024
  v_add_f32 v31, v31, v81
  buffer_load_dwordx4 v16, s[8:11], s34 offen offset:2048 lds
  s_waitcnt lgkmcnt(4)
  v_mfma_f32_32x32x16_bf16 v[96:111], v[152:155], a[152:155], v[96:111]
  ds_read_b128 v[144:147], v6 offset:33024
  v_cvt_pk_bf16_f32 v80, v80, v81
  v_fma_f32 v85, v85, s30, -v29
  v_exp_f32 v84, v84
  v_mfma_f32_32x32x16_bf16 v[96:111], v[156:159], a[156:159], v[96:111]
  ds_read_b128 v[148:151], v7 offset:33024
  v_add_f32 v32, v32, v82
  buffer_load_dwordx4 v17, s[8:11], s34 offen offset:3072 lds
  s_waitcnt lgkmcnt(4)
  v_mfma_f32_32x32x16_bf16 v[96:111], v[128:131], a[160:163], v[96:111]
  ds_read_b128 v[152:155], v8 offset:33024
  v_fma_f32 v86, v86, s30, -v29
  v_exp_f32 v85, v85
  v_add_f32 v33, v33, v83
  v_mfma_f32_32x32x16_bf16 v[96:111], v[132:135], a[164:167], v[96:111]
  ds_read_b128 v[156:159], v9 offset:33024
  s_add_u32 m0, s44, 4096
  s_nop 0
  buffer_load_dwordx4 v18, s[8:11], s34 offen offset:0 lds
  s_waitcnt lgkmcnt(4)
  v_mfma_f32_32x32x16_bf16 v[96:111], v[136:139], a[168:171], v[96:111]
  ds_read_b128 v[128:131], v2 offset:49152
  v_cvt_pk_bf16_f32 v81, v82, v83
  v_fma_f32 v87, v87, s30, -v29
  v_exp_f32 v86, v86
  v_mfma_f32_32x32x16_bf16 v[96:111], v[140:143], a[172:175], v[96:111]
  ds_read_b128 v[132:135], v3 offset:49152
  v_add_f32 v30, v30, v84
  v_fma_f32 v88, v88, s30, -v29
  v_exp_f32 v87, v87
  v_add_f32 v31, v31, v85
  s_waitcnt lgkmcnt(4)
  v_mfma_f32_32x32x16_bf16 v[96:111], v[144:147], a[176:179], v[96:111]
  ds_read_b128 v[136:139], v4 offset:49152
  v_cvt_pk_bf16_f32 v82, v84, v85
  buffer_load_dwordx4 v19, s[8:11], s34 offen offset:1024 lds
  v_mfma_f32_32x32x16_bf16 v[96:111], v[148:151], a[180:183], v[96:111]
  ds_read_b128 v[140:143], v5 offset:49152
  v_fma_f32 v89, v89, s30, -v29
  v_exp_f32 v88, v88
  v_add_f32 v32, v32, v86
  s_waitcnt lgkmcnt(4)
  v_mfma_f32_32x32x16_bf16 v[96:111], v[152:155], a[184:187], v[96:111]
  ds_read_b128 v[144:147], v6 offset:49152
  v_fma_f32 v90, v90, s30, -v29
  buffer_load_dwordx4 v20, s[8:11], s34 offen offset:2048 lds
  v_mfma_f32_32x32x16_bf16 v[96:111], v[156:159], a[188:191], v[96:111]
  ds_read_b128 v[148:151], v7 offset:49152
  v_exp_f32 v89, v89
  v_add_f32 v33, v33, v87
  v_cvt_pk_bf16_f32 v83, v86, v87
  s_waitcnt lgkmcnt(4)
  v_mfma_f32_32x32x16_bf16 v[112:127], v[128:131], a[128:131], 0
  ds_read_b128 v[152:155], v8 offset:49152
  v_fma_f32 v91, v91, s30, -v29
  buffer_load_dwordx4 v21, s[8:11], s34 offen offset:3072 lds
  v_mfma_f32_32x32x16_bf16 v[112:127], v[132:135], a[132:135], v[112:127]
  ds_read_b128 v[156:159], v9 offset:49152
  v_exp_f32 v90, v90
  v_add_f32 v30, v30, v88
  v_fma_f32 v92, v92, s30, -v29
  s_waitcnt lgkmcnt(4)
  v_mfma_f32_32x32x16_bf16 v[112:127], v[136:139], a[136:139], v[112:127]
  ds_read_b128 v[128:131], v2 offset:49408
  v_exp_f32 v91, v91
  s_add_u32 s37, s37, 1
  s_add_u32 s34, s34, 0x8000
  s_cmp_eq_u32 s37, s39
  s_cselect_b32 s34, s40, s34
  s_cmp_ge_u32 s37, s41
  s_cselect_b32 s34, s45, s34
  v_mfma_f32_32x32x16_bf16 v[112:127], v[140:143], a[140:143], v[112:127]
  ds_read_b128 v[132:135], v3 offset:49408
  v_add_f32 v31, v31, v89
  v_cvt_pk_bf16_f32 v88, v88, v89
  v_fma_f32 v93, v93, s30, -v29
  s_waitcnt lgkmcnt(4)
  v_mfma_f32_32x32x16_bf16 v[112:127], v[144:147], a[144:147], v[112:127]
  ds_read_b128 v[136:139], v4 offset:49408
  v_exp_f32 v92, v92
  v_add_f32 v32, v32, v90
  v_fma_f32 v94, v94, s30, -v29
  v_mfma_f32_32x32x16_bf16 v[112:127], v[148:151], a[148:151], v[112:127]
  ds_read_b128 v[140:143], v5 offset:49408
  s_add_u32 s36, s35, 0x1000
  s_add_u32 m0, s44, 98304
  s_nop 0
  buffer_load_dwordx4 v22, s[12:15], s35 offen offset:0 lds
  s_waitcnt lgkmcnt(4)
  v_mfma_f32_32x32x16_bf16 v[112:127], v[152:155], a[152:155], v[112:127]
  ds_read_b128 v[144:147], v6 offset:49408
  v_exp_f32 v93, v93
  v_add_f32 v33, v33, v91
  v_cvt_pk_bf16_f32 v89, v90, v91
  v_fma_f32 v95, v95, s30, -v29
  v_mfma_f32_32x32x16_bf16 v[112:127], v[156:159], a[156:159], v[112:127]
  ds_read_b128 v[148:151], v7 offset:49408
  buffer_load_dwordx4 v23, s[12:15], s35 offen offset:1024 lds
  s_waitcnt lgkmcnt(4)
  v_mfma_f32_32x32x16_bf16 v[112:127], v[128:131], a[160:163], v[112:127]
  ds_read_b128 v[152:155], v8 offset:49408
  v_exp_f32 v94, v94
  v_add_f32 v30, v30, v92
  v_exp_f32 v95, v95
  v_mfma_f32_32x32x16_bf16 v[112:127], v[132:135], a[164:167], v[112:127]
  ds_read_b128 v[156:159], v9 offset:49408
  ds_read_b64_tr_b16 v[160:161], v10 offset:0
  ds_read_b64_tr_b16 v[162:163], v10 offset:4096
  buffer_load_dwordx4 v22, s[12:15], s35 offen offset:2048 lds
  s_waitcnt lgkmcnt(6)
  v_mfma_f32_32x32x16_bf16 v[112:127], v[136:139], a[168:171], v[112:127]
  ds_read_b64_tr_b16 v[164:165], v11 offset:0
  v_add_f32 v31, v31, v93
  ds_read_b64_tr_b16 v[166:167], v11 offset:4096
  v_cvt_pk_bf16_f32 v90, v92, v93
  v_mfma_f32_32x32x16_bf16 v[112:127], v[140:143], a[172:175], v[112:127]
  ds_read_b64_tr_b16 v[168:169], v12 offset:0
  v_add_f32 v32, v32, v94
  ds_read_b64_tr_b16 v[170:171], v12 offset:4096
  v_add_f32 v33, v33, v95
  v_cvt_pk_bf16_f32 v91, v94, v95
  s_waitcnt lgkmcnt(8)
  v_mfma_f32_32x32x16_bf16 v[112:127], v[144:147], a[176:179], v[112:127]
  ds_read_b64_tr_b16 v[172:173], v13 offset:0
  ds_read_b64_tr_b16 v[174:175], v13 offset:4096
  buffer_load_dwordx4 v23, s[12:15], s35 offen offset:3072 lds
  v_mfma_f32_32x32x16_bf16 v[112:127], v[148:151], a[180:183], v[112:127]
  ds_read_b64_tr_b16 v[176:177], v10 offset:256
  s_cmp_ge_u32 s32, s33
  s_cbranch_scc1 L_mask0_6
L_ret_7:
  ds_read_b64_tr_b16 v[178:179], v10 offset:4352
  v_max3_f32 v35, v96, v97, v98
  v_max3_f32 v35, v35, v99, v100
  s_waitcnt lgkmcnt(10)
  v_mfma_f32_32x32x16_bf16 v[112:127], v[152:155], a[184:187], v[112:127]
  ds_read_b64_tr_b16 v[180:181], v11 offset:256
  ds_read_b64_tr_b16 v[182:183], v11 offset:4352
  s_add_u32 m0, s44, 102400
  s_nop 0
  buffer_load_dwordx4 v22, s[12:15], s36 offen offset:0 lds
  v_mfma_f32_32x32x16_bf16 v[112:127], v[156:159], a[188:191], v[112:127]
  ds_read_b64_tr_b16 v[184:185], v12 offset:256
  v_max3_f32 v35, v35, v101, v102
  ds_read_b64_tr_b16 v[186:187], v12 offset:4352
  v_max3_f32 v35, v35, v103, v104
  v_max3_f32 v35, v35, v105, v106
  s_waitcnt lgkmcnt(10)
  v_mfma_f32_32x32x16_bf16 a[0:15], v[160:163], v[64:67], a[0:15]
  ds_read_b64_tr_b16 v[188:189], v13 offset:256
  ds_read_b64_tr_b16 v[190:191], v13 offset:4352
  buffer_load_dwordx4 v23, s[12:15], s36 offen offset:1024 lds
  v_mfma_f32_32x32x16_bf16 a[16:31], v[164:167], v[64:67], a[16:31]
  ds_read_b64_tr_b16 v[192:193], v10 offset:8192
  v_max3_f32 v35, v35, v107, v108
  ds_read_b64_tr_b16 v[194:195], v10 offset:12288
  v_max3_f32 v35, v35, v109, v110
  v_max_f32 v35, v35, v111
  s_waitcnt lgkmcnt(10)
  v_mfma_f32_32x32x16_bf16 a[32:47], v[168:171], v[64:67], a[32:47]
  ds_read_b64_tr_b16 v[196:197], v11 offset:8192
  ds_read_b64_tr_b16 v[198:199], v11 offset:12288
  buffer_load_dwordx4 v22, s[12:15], s36 offen offset:2048 lds
  v_mfma_f32_32x32x16_bf16 a[48:63], v[172:175], v[64:67], a[48:63]
  ds_read_b64_tr_b16 v[160:161], v12 offset:8192
  s_cmp_ge_u32 s32, s33
  s_cbranch_scc1 L_mask1_8
L_ret_9:
  ds_read_b64_tr_b16 v[162:163], v12 offset:12288
  v_max3_f32 v35, v35, v112, v113
  v_max3_f32 v35, v35, v114, v115
  s_waitcnt lgkmcnt(10)
  v_mfma_f32_32x32x16_bf16 a[64:79], v[176:179], v[64:67], a[64:79]
  ds_read_b64_tr_b16 v[164:165], v13 offset:8192
  v_max3_f32 v35, v35, v116, v117
  ds_read_b64_tr_b16 v[166:167], v13 offset:12288
  v_max3_f32 v35, v35, v118, v119
  v_max3_f32 v35, v35, v120, v121
  v_mfma_f32_32x32x16_bf16 a[80:95], v[180:183], v[64:67], a[80:95]
  ds_read_b64_tr_b16 v[168:169], v10 offset:8448
  v_max3_f32 v35, v35, v122, v123
  ds_read_b64_tr_b16 v[170:171], v10 offset:12544
  buffer_load_dwordx4 v23, s[12:15], s36 offen offset:3072 lds
  s_waitcnt lgkmcnt(10)
  v_mfma_f32_32x32x16_bf16 a[96:111], v[184:187], v[64:67], a[96:111]
  ds_read_b64_tr_b16 v[172:173], v11 offset:8448
  v_max3_f32 v35, v35, v124, v125
  ds_read_b64_tr_b16 v[174:175], v11 offset:12544
  v_max3_f32 v35, v35, v126, v127
  v_mfma_f32_32x32x16_bf16 a[112:127], v[188:191], v[64:67], a[112:127]
  ds_read_b64_tr_b16 v[176:177], v12 offset:8448
  v_cmp_gt_f32 vcc, v35, v28
  s_cbranch_vccnz L_rare_10
L_ret_11:
  ds_read_b64_tr_b16 v[178:179], v12 offset:12544
  s_add_u32 s38, s38, 1
  s_add_u32 s35, s35, 0x8000
  s_cmp_eq_u32 s38, s39
  s_cselect_b32 s35, s40, s35
  s_cmp_ge_u32 s38, s41
  s_cselect_b32 s35, s45, s35
  s_waitcnt lgkmcnt(10)
  v_mfma_f32_32x32x16_bf16 a[0:15], v[192:195], v[72:75], a[0:15]
  ds_read_b64_tr_b16 v[180:181], v13 offset:8448
  s_add_u32 s32, s32, 1
  s_cmp_eq_u32 s32, s66
  s_cselect_b32 s32, 0, s32
  ds_read_b64_tr_b16 v[182:183], v13 offset:12544
  v_fma_f32 v96, v96, s30, -v29
  v_mfma_f32_32x32x16_bf16 a[16:31], v[196:199], v[72:75], a[16:31]
  ds_read_b64_tr_b16 v[184:185], v10 offset:16384
  v_fma_f32 v97, v97, s30, -v29
  ds_read_b64_tr_b16 v[186:187], v10 offset:20480
  buffer_load_dword v49, v48, s[68:71], s76 offen
  s_waitcnt lgkmcnt(10)
  v_mfma_f32_32x32x16_bf16 a[32:47], v[160:163], v[72:75], a[32:47]
  ds_read_b64_tr_b16 v[188:189], v11 offset:16384
  v_exp_f32 v96, v96
  ds_read_b64_tr_b16 v[190:191], v11 offset:20480
  v_fma_f32 v98, v98, s30, -v29
  v_mfma_f32_32x32x16_bf16 a[48:63], v[164:167], v[72:75], a[48:63]
  ds_read_b64_tr_b16 v[192:193], v12 offset:16384
  v_exp_f32 v97, v97
  ds_read_b64_tr_b16 v[194:195], v12 offset:20480
  v_fma_f32 v99, v99, s30, -v29
  s_waitcnt lgkmcnt(10)
  v_mfma_f32_32x32x16_bf16 a[64:79], v[168:171], v[72:75], a[64:79]
  ds_read_b64_tr_b16 v[196:197], v13 offset:16384
  v_exp_f32 v98, v98
  ds_read_b64_tr_b16 v[198:199], v13 offset:20480
  buffer_load_dword v49, v48, s[72:75], s77 offen
  v_mfma_f32_32x32x16_bf16 a[80:95], v[172:175], v[72:75], a[80:95]
  ds_read_b64_tr_b16 v[160:161], v10 offset:16640
  v_add_f32 v30, v30, v96
  ds_read_b64_tr_b16 v[162:163], v10 offset:20736
  v_fma_f32 v100, v100, s30, -v29
  s_waitcnt lgkmcnt(10)
  v_mfma_f32_32x32x16_bf16 a[96:111], v[176:179], v[72:75], a[96:111]
  ds_read_b64_tr_b16 v[164:165], v11 offset:16640
  v_exp_f32 v99, v99
  ds_read_b64_tr_b16 v[166:167], v11 offset:20736
  v_add_f32 v31, v31, v97
  v_cvt_pk_bf16_f32 v96, v96, v97
  v_mfma_f32_32x32x16_bf16 a[112:127], v[180:183], v[72:75], a[112:127]
  ds_read_b64_tr_b16 v[168:169], v12 offset:16640
  v_fma_f32 v101, v101, s30, -v29
  ds_read_b64_tr_b16 v[170:171], v12 offset:20736
  v_exp_f32 v100, v100
  s_waitcnt lgkmcnt(10)
  v_mfma_f32_32x32x16_bf16 a[0:15], v[184:187], v[80:83], a[0:15]
  ds_read_b64_tr_b16 v[172:173], v13 offset:16640
  v_add_f32 v32, v32, v98
  ds_read_b64_tr_b16 v[174:175], v13 offset:20736
  v_fma_f32 v102, v102, s30, -v29
  v_exp_f32 v101, v101
  v_mfma_f32_32x32x16_bf16 a[16:31], v[188:191], v[80:83], a[16:31]
  ds_read_b64_tr_b16 v[176:177], v10 offset:24576
  v_add_f32 v33, v33, v99
  ds_read_b64_tr_b16 v[178:179], v10 offset:28672
  v_cvt_pk_bf16_f32 v97, v98, v99
  s_waitcnt lgkmcnt(10)
  v_mfma_f32_32x32x16_bf16 a[32:47], v[192:195], v[80:83], a[32:47]
  ds_read_b64_tr_b16 v[180:181], v11 offset:24576
  v_fma_f32 v103, v103, s30, -v29
  ds_read_b64_tr_b16 v[182:183], v11 offset:28672
  v_exp_f32 v102, v102
  v_mfma_f32_32x32x16_bf16 a[48:63], v[196:199], v[80:83], a[48:63]
  ds_read_b64_tr_b16 v[184:185], v12 offset:24576
  v_add_f32 v30, v30, v100
  ds_read_b64_tr_b16 v[186:187], v12 offset:28672
  v_fma_f32 v104, v104, s30, -v29
  v_exp_f32 v103, v103
  s_waitcnt lgkmcnt(10)
  v_mfma_f32_32x32x16_bf16 a[64:79], v[160:163], v[80:83], a[64:79]
  ds_read_b64_tr_b16 v[188:189], v13 offset:24576
  v_add_f32 v31, v31, v101
  ds_read_b64_tr_b16 v[190:191], v13 offset:28672
  v_cvt_pk_bf16_f32 v98, v100, v101
  v_fma_f32 v105, v105, s30, -v29
  v_mfma_f32_32x32x16_bf16 a[80:95], v[164:167], v[80:83], a[80:95]
  ds_read_b64_tr_b16 v[192:193], v10 offset:24832
  v_exp_f32 v104, v104
  ds_read_b64_tr_b16 v[194:195], v10 offset:28928
  v_add_f32 v32, v32, v102
  s_waitcnt lgkmcnt(10)
  v_mfma_f32_32x32x16_bf16 a[96:111], v[168:171], v[80:83], a[96:111]
  ds_read_b64_tr_b16 v[196:197], v11 offset:24832
  v_fma_f32 v106, v106, s30, -v29
  ds_read_b64_tr_b16 v[198:199], v11 offset:28928
  v_exp_f32 v105, v105
  v_mfma_f32_32x32x16_bf16 a[112:127], v[172:175], v[80:83], a[112:127]
  ds_read_b64_tr_b16 v[160:161], v12 offset:24832
  v_add_f32 v33, v33, v103
  ds_read_b64_tr_b16 v[162:163], v12 offset:28928
  v_cvt_pk_bf16_f32 v99, v102, v103
  v_fma_f32 v107, v107, s30, -v29
  s_waitcnt lgkmcnt(10)
  v_mfma_f32_32x32x16_bf16 a[0:15], v[176:179], v[88:91], a[0:15]
  ds_read_b64_tr_b16 v[164:165], v13 offset:24832
  v_exp_f32 v106, v106
  ds_read_b64_tr_b16 v[166:167], v13 offset:28928
  v_add_f32 v30, v30, v104
  v_mfma_f32_32x32x16_bf16 a[16:31], v[180:183], v[88:91], a[16:31]
  s_waitcnt vmcnt(2) lgkmcnt(0)
  v_fma_f32 v108, v108, s30, -v29
  s_barrier
  s_cmp_lg_u32 s43, 0
  s_cbranch_scc0 L_ret_5
  s_call_b64 s[96:97], L_hook
L_ret_5:
  v_exp_f32 v107, v107
  v_mfma_f32_32x32x16_bf16 a[32:47], v[184:187], v[88:91], a[32:47]
  ds_read_b128 v[128:131], v2 offset:0
  v_add_f32 v31, v31, v105
  v_cvt_pk_bf16_f32 v104, v104, v105
  v_fma_f32 v109, v109, s30, -v29
  v_mfma_f32_32x32x16_bf16 a[48:63], v[188:191], v[88:91], a[48:63]
  ds_read_b128 v[132:135], v3 offset:0
  v_exp_f32 v108, v108
  v_add_f32 v32, v32, v106
  v_fma_f32 v110, v110, s30, -v29
  v_mfma_f32_32x32x16_bf16 a[64:79], v[192:195], v[88:91], a[64:79]
  ds_read_b128 v[136:139], v4 offset:0
  v_exp_f32 v109, v109
  v_add_f32 v33, v33, v107
  v_cvt_pk_bf16_f32 v105, v106, v107
  v_fma_f32 v111, v111, s30, -v29
  v_mfma_f32_32x32x16_bf16 a[80:95], v[196:199], v[88:91], a[80:95]
  ds_read_b128 v[140:143], v5 offset:0
  v_exp_f32 v110, v110
  v_add_f32 v30, v30, v108
  v_mfma_f32_32x32x16_bf16 a[96:111], v[160:163], v[88:91], a[96:111]
  ds_read_b128 v[144:147], v6 offset:0
  v_exp_f32 v111, v111
  v_add_f32 v31, v31, v109
  v_cvt_pk_bf16_f32 v106, v108, v109
  v_add_f32 v32, v32, v110
  v_mfma_f32_32x32x16_bf16 a[112:127], v[164:167], v[88:91], a[112:127]
  ds_read_b128 v[148:151], v7 offset:0
  v_add_f32 v33, v33, v111
  v_cvt_pk_bf16_f32 v107, v110, v111
  s_cmp_eq_u32 s31, s98
  s_cselect_b32 s54, 4, 0
  s_or_b32 s43, s43, s54
  s_sub_u32 s31, s31, 1
L_after_pro1:
  s_cmp_eq_u32 s31, 0
  s_cbranch_scc1 L_tail1
L_body1:
  s_cmp_lg_u32 s42, 0
  s_cbranch_scc1 L_resc_21
L_ret_22:
  s_waitcnt lgkmcnt(4)
  v_mfma_f32_32x32x16_bf16 v[64:79], v[128:131], a[128:131], 0
  ds_read_b128 v[152:155], v8 offset:0
  s_add_u32 m0, s44, 32768
  s_nop 0
  buffer_load_dwordx4 v14, s[8:11], s34 offen offset:0 lds
  v_mfma_f32_32x32x16_bf16 v[64:79], v[132:135], a[132:135], v[64:79]
  ds_read_b128 v[156:159], v9 offset:0
  v_fma_f32 v112, v112, s30, -v29
  v_fma_f32 v113, v113, s30, -v29
  v_exp_f32 v112, v112
  s_waitcnt lgkmcnt(4)
  v_mfma_f32_32x32x16_bf16 v[64:79], v[136:139], a[136:139], v[64:79]
  ds_read_b128 v[128:131], v2 offset:256
  v_fma_f32 v114, v114, s30, -v29
  buffer_load_dwordx4 v15, s[8:11], s34 offen offset:1024 lds
  v_mfma_f32_32x32x16_bf16 v[64:79], v[140:143], a[140:143], v[64:79]
  ds_read_b128 v[132:135], v3 offset:256
  v_exp_f32 v113, v113
  v_fma_f32 v115, v115, s30, -v29
  v_exp_f32 v114, v114
  s_waitcnt lgkmcnt(4)
  v_mfma_f32_32x32x16_bf16 v[64:79], v[144:147], a[144:147], v[64:79]
  ds_read_b128 v[136:139], v4 offset:256
  v_add_f32 v30, v30, v112
  v_fma_f32 v116, v116, s30, -v29
  v_exp_f32 v115, v115
  v_mfma_f32_32x32x16_bf16 v[64:79], v[148:151], a[148:151], v[64:79]
  ds_read_b128 v[140:143], v5 offset:256
  v_add_f32 v31, v31, v113
  buffer_load_dwordx4 v16, s[8:11], s34 offen offset:2048 lds
  s_waitcnt lgkmcnt(4)
  v_mfma_f32_32x32x16_bf16 v[64:79], v[152:155], a[152:155], v[64:79]
  ds_read_b128 v[144:147], v6 offset:256
  v_cvt_pk_bf16_f32 v112, v112, v113
  v_fma_f32 v117, v117, s30, -v29
  v_exp_f32 v116, v116
  v_mfma_f32_32x32x16_bf16 v[64:79], v[156:159], a[156:159], v[64:79]
  ds_read_b128 v[148:151], v7 offset:256
  v_add_f32 v32, v32, v114
  buffer_load_dwordx4 v17, s[8:11], s34 offen offset:3072 lds
  s_waitcnt lgkmcnt(4)
  v_mfma_f32_32x32x16_bf16 v[64:79], v[128:131], a[160:163], v[64:79]
  ds_read_b128 v[152:155], v8 offset:256
  v_fma_f32 v118, v118, s30, -v29
  v_exp_f32 v117, v117
  v_add_f32 v33, v33, v115
  v_mfma_f32_32x32x16_bf16 v[64:79], v[132:135], a[164:167], v[64:79]
  ds_read_b128 v[156:159], v9 offset:256
  s_add_u32 m0, s44, 36864
  s_nop 0
  buffer_load_dwordx4 v18, s[8:11], s34 offen offset:0 lds
  s_waitcnt lgkmcnt(4)
  v_mfma_f32_32x32x16_bf16 v[64:79], v[136:139], a[168:171], v[64:79]
  ds_read_b128 v[128:131], v2 offset:16384
  v_cvt_pk_bf16_f32 v113, v114, v115
  v_fma_f32 v119, v119, s30, -v29
  v_exp_f32 v118, v118
  v_mfma_f32_32x32x16_bf16 v[64:79], v[140:143], a[172:175], v[64:79]
  ds_read_b128 v[132:135], v3 offset:16384
  v_add_f32 v30, v30, v116
  v_fma_f32 v120, v120, s30, -v29
  v_exp_f32 v119, v119
  v_add_f32 v31, v31, v117
  s_waitcnt lgkmcnt(4)
  v_mfma_f32_32x32x16_bf16 v[64:79], v[144:147], a[176:179], v[64:79]
  ds_read_b128 v[136:139], v4 offset:16384
  v_cvt_pk_bf16_f32 v114, v116, v117
  buffer_load_dwordx4 v19, s[8:11], s34 offen offset:1024 lds
  v_mfma_f32_32x32x16_bf16 v[64:79], v[148:151], a[180:183], v[64:79]
  ds_read_b128 v[140:143], v5 offset:16384
  v_fma_f32 v121, v121, s30, -v29
  v_exp_f32 v120, v120
  v_add_f32 v32, v32, v118
  s_waitcnt lgkmcnt(4)
  v_mfma_f32_32x32x16_bf16 v[64:79], v[152:155], a[184:187], v[64:79]
  ds_read_b128 v[144:147], v6 offset:16384
  v_fma_f32 v122, v122, s30, -v29
  buffer_load_dwordx4 v20, s[8:11], s34 offen offset:2048 lds
  v_mfma_f32_32x32x16_bf16 v[64:79], v[156:159], a[188:191], v[64:79]
  ds_read_b128 v[148:151], v7 offset:16384
  v_exp_f32 v121, v121
  v_add_f32 v33, v33, v119
  v_cvt_pk_bf16_f32 v115, v118, v119
  s_waitcnt lgkmcnt(4)
  v_mfma_f32_32x32x16_bf16 v[80:95], v[128:131], a[128:131], 0
  ds_read_b128 v[152:155], v8 offset:16384
  v_fma_f32 v123, v123, s30, -v29
  buffer_load_dwordx4 v21, s[8:11], s34 offen offset:3072 lds
  v_mfma_f32_32x32x16_bf16 v[80:95], v[132:135], a[132:135], v[80:95]
  ds_read_b128 v[156:159], v9 offset:16384
  v_exp_f32 v122, v122
  v_add_f32 v30, v30, v120
  v_fma_f32 v124, v124, s30, -v29
  s_waitcnt lgkmcnt(4)
  v_mfma_f32_32x32x16_bf16 v[80:95], v[136:139], a[136:139], v[80:95]
  ds_read_b128 v[128:131], v2 offset:16640
  v_exp_f32 v123, v123
  s_add_u32 s37, s37, 1
  s_add_u32 s34, s34, 0x8000
  s_cmp_eq_u32 s37, s39
  s_cselect_b32 s34, s40, s34
  s_cmp_ge_u32 s37, s41
  s_cselect_b32 s34, s45, s34
  v_mfma_f32_32x32x16_bf16 v[80:95], v[140:143], a[140:143], v[80:95]
  ds_read_b128 v[132:135], v3 offset:16640
  v_add_f32 v31, v31, v121
  v_cvt_pk_bf16_f32 v120, v120, v121
  v_fma_f32 v125, v125, s30, -v29
  s_waitcnt lgkmcnt(4)
  v_mfma_f32_32x32x16_bf16 v[80:95], v[144:147], a[144:147], v[80:95]
  ds_read_b128 v[136:139], v4 offset:16640
  v_exp_f32 v124, v124
  v_add_f32 v32, v32, v122
  v_fma_f32 v126, v126, s30, -v29
  v_mfma_f32_32x32x16_bf16 v[80:95], v[148:151], a[148:151], v[80:95]
  ds_read_b128 v[140:143], v5 offset:16640
  s_add_u32 s36, s35, 0x1000
  s_add_u32 m0, s44, 65536
  s_nop 0
  buffer_load_dwordx4 v22, s[12:15], s35 offen offset:0 lds
  s_waitcnt lgkmcnt(4)
  v_mfma_f32_32x32x16_bf16 v[80:95], v[152:155], a[152:155], v[80:95]
  ds_read_b128 v[144:147], v6 offset:16640
  v_exp_f32 v125, v125
  v_add_f32 v33, v33, v123
  v_cvt_pk_bf16_f32 v121, v122, v123
  v_fma_f32 v127, v127, s30, -v29
  v_mfma_f32_32x32x16_bf16 v[80:95], v[156:159], a[156:159], v[80:95]
  ds_read_b128 v[148:151], v7 offset:16640
  buffer_load_dwordx4 v23, s[12:15], s35 offen offset:1024 lds
  s_waitcnt lgkmcnt(4)
  v_mfma_f32_32x32x16_bf16 v[80:95], v[128:131], a[160:163], v[80:95]
  ds_read_b128 v[152:155], v8 offset:16640
  v_exp_f32 v126, v126
  v_add_f32 v30, v30, v124
  v_exp_f32 v127, v127
  v_mfma_f32_32x32x16_bf16 v[80:95], v[132:135], a[164:167], v[80:95]
  ds_read_b128 v[156:159], v9 offset:16640
  ds_read_b64_tr_b16 v[160:161], v10 offset:32768
  ds_read_b64_tr_b16 v[162:163], v10 offset:36864
  buffer_load_dwordx4 v22, s[12:15], s35 offen offset:2048 lds
  s_waitcnt lgkmcnt(6)
  v_mfma_f32_32x32x16_bf16 v[80:95], v[136:139], a[168:171], v[80:95]
  ds_read_b64_tr_b16 v[164:165], v11 offset:32768
  v_add_f32 v31, v31, v125
  ds_read_b64_tr_b16 v[166:167], v11 offset:36864
  v_cvt_pk_bf16_f32 v122, v124, v125
  v_mfma_f32_32x32x16_bf16 v[80:95], v[140:143], a[172:175], v[80:95]
  ds_read_b64_tr_b16 v[168:169], v12 offset:32768
  v_add_f32 v32, v32, v126
  ds_read_b64_tr_b16 v[170:171], v12 offset:36864
  v_add_f32 v33, v33, v127
  v_cvt_pk_bf16_f32 v123, v126, v127
  s_waitcnt lgkmcnt(8)
  v_mfma_f32_32x32x16_bf16 v[80:95], v[144:147], a[176:179], v[80:95]
  ds_read_b64_tr_b16 v[172:173], v13 offset:32768
  ds_read_b64_tr_b16 v[174:175], v13 offset:36864
  buffer_load_dwordx4 v23, s[12:15], s35 offen offset:3072 lds
  v_mfma_f32_32x32x16_bf16 v[80:95], v[148:151], a[180:183], v[80:95]
  ds_read_b64_tr_b16 v[176:177], v10 offset:33024
  s_cmp_ge_u32 s32, s33
  s_cbranch_scc1 L_mask0_15
L_ret_16:
  ds_read_b64_tr_b16 v[178:179], v10 offset:37120
  v_max3_f32 v35, v64, v65, v66
  v_max3_f32 v35, v35, v67, v68
  s_waitcnt lgkmcnt(10)
  v_mfma_f32_32x32x16_bf16 v[80:95], v[152:155], a[184:187], v[80:95]
  ds_read_b64_tr_b16 v[180:181], v11 offset:33024
  ds_read_b64_tr_b16 v[182:183], v11 offset:37120
  s_add_u32 m0, s44, 69632
  s_nop 0
  buffer_load_dwordx4 v22, s[12:15], s36 offen offset:0 lds
  v_mfma_f32_32x32x16_bf16 v[80:95], v[156:159], a[188:191], v[80:95]
  ds_read_b64_tr_b16 v[184:185], v12 offset:33024
  v_max3_f32 v35, v35, v69, v70
  ds_read_b64_tr_b16 v[186:187], v12 offset:37120
  v_max3_f32 v35, v35, v71, v72
  v_max3_f32 v35, v35, v73, v74
  s_waitcnt lgkmcnt(10)
  v_mfma_f32_32x32x16_bf16 a[0:15], v[160:163], v[96:99], a[0:15]
  ds_read_b64_tr_b16 v[188:189], v13 offset:33024
  ds_read_b64_tr_b16 v[190:191], v13 offset:37120
  buffer_load_dwordx4 v23, s[12:15], s36 offen offset:1024 lds
  v_mfma_f32_32x32x16_bf16 a[16:31], v[164:167], v[96:99], a[16:31]
  ds_read_b64_tr_b16 v[192:193], v10 offset:40960
  v_max3_f32 v35, v35, v75, v76
  ds_read_b64_tr_b16 v[194:195], v10 offset:45056
  v_max3_f32 v35, v35, v77, v78
  v_max_f32 v35, v35, v79
  s_waitcnt lgkmcnt(10)
  v_mfma_f32_32x32x16_bf16 a[32:47], v[168:171], v[96:99], a[32:47]
  ds_read_b64_tr_b16 v[196:197], v11 offset:40960
  ds_read_b64_tr_b16 v[198:199], v11 offset:45056
  buffer_load_dwordx4 v22, s[12:15], s36 offen offset:2048 lds
  v_mfma_f32_32x32x16_bf16 a[48:63], v[172:175], v[96:99], a[48:63]
  ds_read_b64_tr_b16 v[160:161], v12 offset:40960
  s_cmp_ge_u32 s32, s33
  s_cbranch_scc1 L_mask1_17
L_ret_18:
  ds_read_b64_tr_b16 v[162:163], v12 offset:45056
  v_max3_f32 v35, v35, v80, v81
  v_max3_f32 v35, v35, v82, v83
  s_waitcnt lgkmcnt(10)
  v_mfma_f32_32x32x16_bf16 a[64:79], v[176:179], v[96:99], a[64:79]
  ds_read_b64_tr_b16 v[164:165], v13 offset:40960
  v_max3_f32 v35, v35, v84, v85
  ds_read_b64_tr_b16 v[166:167], v13 offset:45056
  v_max3_f32 v35, v35, v86, v87
  v_max3_f32 v35, v35, v88, v89
  v_mfma_f32_32x32x16_bf16 a[80:95], v[180:183], v[96:99], a[80:95]
  ds_read_b64_tr_b16 v[168:169], v10 offset:41216
  v_max3_f32 v35, v35, v90, v91
  ds_read_b64_tr_b16 v[170:171], v10 offset:45312
  buffer_load_dwordx4 v23, s[12:15], s36 offen offset:3072 lds
  s_waitcnt lgkmcnt(10)
  v_mfma_f32_32x32x16_bf16 a[96:111], v[184:187], v[96:99], a[96:111]
  ds_read_b64_tr_b16 v[172:173], v11 offset:41216
  v_max3_f32 v35, v35, v92, v93
  ds_read_b64_tr_b16 v[174:175], v11 offset:45312
  v_max3_f32 v35, v35, v94, v95
  v_mfma_f32_32x32x16_bf16 a[112:127], v[188:191], v[96:99], a[112:127]
  ds_read_b64_tr_b16 v[176:177], v12 offset:41216
  v_cmp_gt_f32 vcc, v35, v28
  s_cbranch_vccnz L_rare_19
L_ret_20:
  ds_read_b64_tr_b16 v[178:179], v12 offset:45312
  s_add_u32 s38, s38, 1
  s_add_u32 s35, s35, 0x8000
  s_cmp_eq_u32 s38, s39
  s_cselect_b32 s35, s40, s35
  s_cmp_ge_u32 s38, s41
  s_cselect_b32 s35, s45, s35
  s_waitcnt lgkmcnt(10)
  v_mfma_f32_32x32x16_bf16 a[0:15], v[192:195], v[104:107], a[0:15]
  ds_read_b64_tr_b16 v[180:181], v13 offset:41216
  s_add_u32 s32, s32, 1
  s_cmp_eq_u32 s32, s66
  s_cselect_b32 s32, 0, s32
  ds_read_b64_tr_b16 v[182:183], v13 offset:45312
  v_fma_f32 v64, v64, s30, -v29
  v_mfma_f32_32x32x16_bf16 a[16:31], v[196:199], v[104:107], a[16:31]
  ds_read_b64_tr_b16 v[184:185], v10 offset:49152
  v_fma_f32 v65, v65, s30, -v29
  ds_read_b64_tr_b16 v[186:187], v10 offset:53248
  buffer_load_dword v49, v48, s[68:71], s76 offen
  s_waitcnt lgkmcnt(10)
  v_mfma_f32_32x32x16_bf16 a[32:47], v[160:163], v[104:107], a[32:47]
  ds_read_b64_tr_b16 v[188:189], v11 offset:49152
  v_exp_f32 v64, v64
  ds_read_b64_tr_b16 v[190:191], v11 offset:53248
  v_fma_f32 v66, v66, s30, -v29
  v_mfma_f32_32x32x16_bf16 a[48:63], v[164:167], v[104:107], a[48:63]
  ds_read_b64_tr_b16 v[192:193], v12 offset:49152
  v_exp_f32 v65, v65
  ds_read_b64_tr_b16 v[194:195], v12 offset:53248
  v_fma_f32 v67, v67, s30, -v29
  s_waitcnt lgkmcnt(10)
  v_mfma_f32_32x32x16_bf16 a[64:79], v[168:171], v[104:107], a[64:79]
  ds_read_b64_tr_b16 v[196:197], v13 offset:49152
  v_exp_f32 v66, v66
  ds_read_b64_tr_b16 v[198:199], v13 offset:53248
  buffer_load_dword v49, v48, s[72:75], s77 offen
  v_mfma_f32_32x32x16_bf16 a[80:95], v[172:175], v[104:107], a[80:95]
  ds_read_b64_tr_b16 v[160:161], v10 offset:49408
  v_add_f32 v30, v30, v64
  ds_read_b64_tr_b16 v[162:163], v10 offset:53504
  v_fma_f32 v68, v68, s30, -v29
  s_waitcnt lgkmcnt(10)
  v_mfma_f32_32x32x16_bf16 a[96:111], v[176:179], v[104:107], a[96:111]
  ds_read_b64_tr_b16 v[164:165], v11 offset:49408
  v_exp_f32 v67, v67
  ds_read_b64_tr_b16 v[166:167], v11 offset:53504
  v_add_f32 v31, v31, v65
  v_cvt_pk_bf16_f32 v64, v64, v65
  v_mfma_f32_32x32x16_bf16 a[112:127], v[180:183], v[104:107], a[112:127]
  ds_read_b64_tr_b16 v[168:169], v12 offset:49408
  v_fma_f32 v69, v69, s30, -v29
  ds_read_b64_tr_b16 v[170:171], v12 offset:53504
  v_exp_f32 v68, v68
  s_waitcnt lgkmcnt(10)
  v_mfma_f32_32x32x16_bf16 a[0:15], v[184:187], v[112:115], a[0:15]
  ds_read_b64_tr_b16 v[172:173], v13 offset:49408
  v_add_f32 v32, v32, v66
  ds_read_b64_tr_b16 v[174:175], v13 offset:53504
  v_fma_f32 v70, v70, s30, -v29
  v_exp_f32 v69, v69
  v_mfma_f32_32x32x16_bf16 a[16:31], v[188:191], v[112:115], a[16:31]
  ds_read_b64_tr_b16 v[176:177], v10 offset:57344
  v_add_f32 v33, v33, v67
  ds_read_b64_tr_b16 v[178:179], v10 offset:61440
  v_cvt_pk_bf16_f32 v65, v66, v67
  s_waitcnt lgkmcnt(10)
  v_mfma_f32_32x32x16_bf16 a[32:47], v[192:195], v[112:115], a[32:47]
  ds_read_b64_tr_b16 v[180:181], v11 offset:57344
  v_fma_f32 v71, v71, s30, -v29
  ds_read_b64_tr_b16 v[182:183], v11 offset:61440
  v_exp_f32 v70, v70
  v_mfma_f32_32x32x16_bf16 a[48:63], v[196:199], v[112:115], a[48:63]
  ds_read_b64_tr_b16 v[184:185], v12 offset:57344
  v_add_f32 v30, v30, v68
  ds_read_b64_tr_b16 v[186:187], v12 offset:61440
  v_fma_f32 v72, v72, s30, -v29
  v_exp_f32 v71, v71
  s_waitcnt lgkmcnt(10)
  v_mfma_f32_32x32x16_bf16 a[64:79], v[160:163], v[112:115], a[64:79]
  ds_read_b64_tr_b16 v[188:189], v13 offset:57344
  v_add_f32 v31, v31, v69
  ds_read_b64_tr_b16 v[190:191], v13 offset:61440
  v_cvt_pk_bf16_f32 v66, v68, v69
  v_fma_f32 v73, v73, s30, -v29
  v_mfma_f32_32x32x16_bf16 a[80:95], v[164:167], v[112:115], a[80:95]
  ds_read_b64_tr_b16 v[192:193], v10 offset:57600
  v_exp_f32 v72, v72
  ds_read_b64_tr_b16 v[194:195], v10 offset:61696
  v_add_f32 v32, v32, v70
  s_waitcnt lgkmcnt(10)
  v_mfma_f32_32x32x16_bf16 a[96:111], v[168:171], v[112:115], a[96:111]
  ds_read_b64_tr_b16 v[196:197], v11 offset:57600
  v_fma_f32 v74, v74, s30, -v29
  ds_read_b64_tr_b16 v[198:199], v11 offset:61696
  v_exp_f32 v73, v73
  v_mfma_f32_32x32x16_bf16 a[112:127], v[172:175], v[112:115], a[112:127]
  ds_read_b64_tr_b16 v[160:161], v12 offset:57600
  v_add_f32 v33, v33, v71
  ds_read_b64_tr_b16 v[162:163], v12 offset:61696
  v_cvt_pk_bf16_f32 v67, v70, v71
  v_fma_f32 v75, v75, s30, -v29
  s_waitcnt lgkmcnt(10)
  v_mfma_f32_32x32x16_bf16 a[0:15], v[176:179], v[120:123], a[0:15]
  ds_read_b64_tr_b16 v[164:165], v13 offset:57600
  v_exp_f32 v74, v74
  ds_read_b64_tr_b16 v[166:167], v13 offset:61696
  v_add_f32 v30, v30, v72
  v_mfma_f32_32x32x16_bf16 a[16:31], v[180:183], v[120:123], a[16:31]
  s_waitcnt vmcnt(2) lgkmcnt(0)
  v_fma_f32 v76, v76, s30, -v29
  s_barrier
  s_cmp_lg_u32 s43, 0
  s_cbranch_scc0 L_ret_14
  s_call_b64 s[96:97], L_hook
L_ret_14:
  v_exp_f32 v75, v75
  v_mfma_f32_32x32x16_bf16 a[32:47], v[184:187], v[120:123], a[32:47]
  ds_read_b128 v[128:131], v2 offset:32768
  v_add_f32 v31, v31, v73
  v_cvt_pk_bf16_f32 v72, v72, v73
  v_fma_f32 v77, v77, s30, -v29
  v_mfma_f32_32x32x16_bf16 a[48:63], v[188:191], v[120:123], a[48:63]
  ds_read_b128 v[132:135], v3 offset:32768
  v_exp_f32 v76, v76
  v_add_f32 v32, v32, v74
  v_fma_f32 v78, v78, s30, -v29
  v_mfma_f32_32x32x16_bf16 a[64:79], v[192:195], v[120:123], a[64:79]
  ds_read_b128 v[136:139], v4 offset:32768
  v_exp_f32 v77, v77
  v_add_f32 v33, v33, v75
  v_cvt_pk_bf16_f32 v73, v74, v75
  v_fma_f32 v79, v79, s30, -v29
  v_mfma_f32_32x32x16_bf16 a[80:95], v[196:199], v[120:123], a[80:95]
  ds_read_b128 v[140:143], v5 offset:32768
  v_exp_f32 v78, v78
  v_add_f32 v30, v30, v76
  v_mfma_f32_32x32x16_bf16 a[96:111], v[160:163], v[120:123], a[96:111]
  ds_read_b128 v[144:147], v6 offset:32768
  v_exp_f32 v79, v79
  v_add_f32 v31, v31, v77
  v_cvt_pk_bf16_f32 v74, v76, v77
  v_add_f32 v32, v32, v78
  v_mfma_f32_32x32x16_bf16 a[112:127], v[164:167], v[120:123], a[112:127]
  ds_read_b128 v[148:151], v7 offset:32768
  v_add_f32 v33, v33, v79
  v_cvt_pk_bf16_f32 v75, v78, v79
  s_cmp_eq_u32 s31, s98
  s_cselect_b32 s54, 4, 0
  s_or_b32 s43, s43, s54
  s_sub_u32 s31, s31, 1
  s_cmp_lg_u32 s31, 0
  s_cbranch_scc1 L_body0
L_tail0:
  s_cmp_eq_u32 s48, 0
  s_cbranch_scc1 L_tailq0
  s_waitcnt lgkmcnt(0)
  s_cmp_lg_u32 s42, 0
  s_cbranch_scc1 L_resc_23
L_ret_24:
  ds_read_b64_tr_b16 v[160:161], v10 offset:0
  ds_read_b64_tr_b16 v[162:163], v10 offset:4096
  ds_read_b64_tr_b16 v[164:165], v11 offset:0
  ds_read_b64_tr_b16 v[166:167], v11 offset:4096
  ds_read_b64_tr_b16 v[168:169], v12 offset:0
  ds_read_b64_tr_b16 v[170:171], v12 offset:4096
  ds_read_b64_tr_b16 v[172:173], v13 offset:0
  ds_read_b64_tr_b16 v[174:175], v13 offset:4096
  ds_read_b64_tr_b16 v[176:177], v10 offset:256
  ds_read_b64_tr_b16 v[178:179], v10 offset:4352
  ds_read_b64_tr_b16 v[180:181], v11 offset:256
  ds_read_b64_tr_b16 v[182:183], v11 offset:4352
  ds_read_b64_tr_b16 v[184:185], v12 offset:256
  ds_read_b64_tr_b16 v[186:187], v12 offset:4352
  s_waitcnt lgkmcnt(10)
  v_mfma_f32_32x32x16_bf16 a[0:15], v[160:163], v[64:67], a[0:15]
  ds_read_b64_tr_b16 v[188:189], v13 offset:256
  ds_read_b64_tr_b16 v[190:191], v13 offset:4352
  s_add_u32 m0, s44, 0
  s_nop 0
  buffer_load_dwordx4 v14, s[8:11], s34 offen offset:0 lds
  v_mfma_f32_32x32x16_bf16 a[16:31], v[164:167], v[64:67], a[16:31]
  ds_read_b64_tr_b16 v[192:193], v10 offset:8192
  v_fma_f32 v80, v80, s30, -v29
  ds_read_b64_tr_b16 v[194:195], v10 offset:12288
  buffer_load_dwordx4 v15, s[8:11], s34 offen offset:1024 lds
  s_waitcnt lgkmcnt(10)
  v_mfma_f32_32x32x16_bf16 a[32:47], v[168:171], v[64:67], a[32:47]
  ds_read_b64_tr_b16 v[196:197], v11 offset:8192
  v_fma_f32 v81, v81, s30, -v29
  ds_read_b64_tr_b16 v[198:199], v11 offset:12288
  buffer_load_dwordx4 v16, s[8:11], s34 offen offset:2048 lds
  v_mfma_f32_32x32x16_bf16 a[48:63], v[172:175], v[64:67], a[48:63]
  ds_read_b64_tr_b16 v[160:161], v12 offset:8192
  ds_read_b64_tr_b16 v[162:163], v12 offset:12288
  buffer_load_dwordx4 v17, s[8:11], s34 offen offset:3072 lds
  s_waitcnt lgkmcnt(10)
  v_mfma_f32_32x32x16_bf16 a[64:79], v[176:179], v[64:67], a[64:79]
  ds_read_b64_tr_b16 v[164:165], v13 offset:8192
  ds_read_b64_tr_b16 v[166:167], v13 offset:12288
  s_add_u32 m0, s44, 4096
  s_nop 0
  buffer_load_dwordx4 v18, s[8:11], s34 offen offset:0 lds
  v_mfma_f32_32x32x16_bf16 a[80:95], v[180:183], v[64:67], a[80:95]
  ds_read_b64_tr_b16 v[168:169], v10 offset:8448
  v_exp_f32 v80, v80
  ds_read_b64_tr_b16 v[170:171], v10 offset:12544
  buffer_load_dwordx4 v19, s[8:11], s34 offen offset:1024 lds
  s_waitcnt lgkmcnt(10)
  v_mfma_f32_32x32x16_bf16 a[96:111], v[184:187], v[64:67], a[96:111]
  ds_read_b64_tr_b16 v[172:173], v11 offset:8448
  ds_read_b64_tr_b16 v[174:175], v11 offset:12544
  buffer_load_dwordx4 v20, s[8:11], s34 offen offset:2048 lds
  v_mfma_f32_32x32x16_bf16 a[112:127], v[188:191], v[64:67], a[112:127]
  ds_read_b64_tr_b16 v[176:177], v12 offset:8448
  v_fma_f32 v82, v82, s30, -v29
  ds_read_b64_tr_b16 v[178:179], v12 offset:12544
  buffer_load_dwordx4 v21, s[8:11], s34 offen offset:3072 lds
  s_waitcnt lgkmcnt(10)
  v_mfma_f32_32x32x16_bf16 a[0:15], v[192:195], v[72:75], a[0:15]
  ds_read_b64_tr_b16 v[180:181], v13 offset:8448
  ds_read_b64_tr_b16 v[182:183], v13 offset:12544
  s_add_u32 s37, s37, 1
  s_add_u32 s34, s34, 0x8000
  s_cmp_eq_u32 s37, s39
  s_cselect_b32 s34, s40, s34
  s_cmp_ge_u32 s37, s41
  s_cselect_b32 s34, s45, s34
  v_mfma_f32_32x32x16_bf16 a[16:31], v[196:199], v[72:75], a[16:31]
  ds_read_b64_tr_b16 v[184:185], v10 offset:16384
  ds_read_b64_tr_b16 v[186:187], v10 offset:20480
  s_add_u32 s36, s35, 0x1000
  s_add_u32 m0, s44, 98304
  s_nop 0
  buffer_load_dwordx4 v22, s[12:15], s35 offen offset:0 lds
  s_waitcnt lgkmcnt(10)
  v_mfma_f32_32x32x16_bf16 a[32:47], v[160:163], v[72:75], a[32:47]
  ds_read_b64_tr_b16 v[188:189], v11 offset:16384
  ds_read_b64_tr_b16 v[190:191], v11 offset:20480
  buffer_load_dwordx4 v23, s[12:15], s35 offen offset:1024 lds
  v_mfma_f32_32x32x16_bf16 a[48:63], v[164:167], v[72:75], a[48:63]
  ds_read_b64_tr_b16 v[192:193], v12 offset:16384
  v_exp_f32 v81, v81
  ds_read_b64_tr_b16 v[194:195], v12 offset:20480
  buffer_load_dwordx4 v22, s[12:15], s35 offen offset:2048 lds
  s_waitcnt lgkmcnt(10)
  v_mfma_f32_32x32x16_bf16 a[64:79], v[168:171], v[72:75], a[64:79]
  ds_read_b64_tr_b16 v[196:197], v13 offset:16384
  v_fma_f32 v83, v83, s30, -v29
  ds_read_b64_tr_b16 v[198:199], v13 offset:20480
  buffer_load_dwordx4 v23, s[12:15], s35 offen offset:3072 lds
  v_mfma_f32_32x32x16_bf16 a[80:95], v[172:175], v[72:75], a[80:95]
  ds_read_b64_tr_b16 v[160:161], v10 offset:16640
  v_exp_f32 v82, v82
  ds_read_b64_tr_b16 v[162:163], v10 offset:20736
  v_add_f32 v30, v30, v80
  s_add_u32 m0, s44, 102400
  s_nop 0
  buffer_load_dwordx4 v22, s[12:15], s36 offen offset:0 lds
  v_fma_f32 v84, v84, s30, -v29
  v_exp_f32 v83, v83
  v_add_f32 v31, v31, v81
  v_cvt_pk_bf16_f32 v80, v80, v81
  v_fma_f32 v85, v85, s30, -v29
  v_exp_f32 v84, v84
  v_add_f32 v32, v32, v82
  v_fma_f32 v86, v86, s30, -v29
  v_exp_f32 v85, v85
  v_add_f32 v33, v33, v83
  v_cvt_pk_bf16_f32 v81, v82, v83
  v_fma_f32 v87, v87, s30, -v29
  v_exp_f32 v86, v86
  v_add_f32 v30, v30, v84
  v_fma_f32 v88, v88, s30, -v29
  v_exp_f32 v87, v87
  v_add_f32 v31, v31, v85
  v_cvt_pk_bf16_f32 v82, v84, v85
  v_fma_f32 v89, v89, s30, -v29
  v_exp_f32 v88, v88
  v_add_f32 v32, v32, v86
  v_fma_f32 v90, v90, s30, -v29
  v_exp_f32 v89, v89
  v_add_f32 v33, v33, v87
  v_cvt_pk_bf16_f32 v83, v86, v87
  s_waitcnt lgkmcnt(10)
  v_mfma_f32_32x32x16_bf16 a[96:111], v[176:179], v[72:75], a[96:111]
  ds_read_b64_tr_b16 v[164:165], v11 offset:16640
  ds_read_b64_tr_b16 v[166:167], v11 offset:20736
  buffer_load_dwordx4 v23, s[12:15], s36 offen offset:1024 lds
  v_mfma_f32_32x32x16_bf16 a[112:127], v[180:183], v[72:75], a[112:127]
  ds_read_b64_tr_b16 v[168:169], v12 offset:16640
  ds_read_b64_tr_b16 v[170:171], v12 offset:20736
  buffer_load_dwordx4 v22, s[12:15], s36 offen offset:2048 lds
  s_waitcnt lgkmcnt(10)
  v_mfma_f32_32x32x16_bf16 a[0:15], v[184:187], v[80:83], a[0:15]
  ds_read_b64_tr_b16 v[172:173], v13 offset:16640
  ds_read_b64_tr_b16 v[174:175], v13 offset:20736
  buffer_load_dwordx4 v23, s[12:15], s36 offen offset:3072 lds
  v_mfma_f32_32x32x16_bf16 a[16:31], v[188:191], v[80:83], a[16:31]
  ds_read_b64_tr_b16 v[176:177], v10 offset:24576
  ds_read_b64_tr_b16 v[178:179], v10 offset:28672
  s_add_u32 s38, s38, 1
  s_add_u32 s35, s35, 0x8000
  s_cmp_eq_u32 s38, s39
  s_cselect_b32 s35, s40, s35
  s_cmp_ge_u32 s38, s41
  s_cselect_b32 s35, s45, s35
  s_waitcnt lgkmcnt(10)
  v_mfma_f32_32x32x16_bf16 a[32:47], v[192:195], v[80:83], a[32:47]
  ds_read_b64_tr_b16 v[180:181], v11 offset:24576
  ds_read_b64_tr_b16 v[182:183], v11 offset:28672
  buffer_load_dword v49, v48, s[68:71], s76 offen
  v_mfma_f32_32x32x16_bf16 a[48:63], v[196:199], v[80:83], a[48:63]
  ds_read_b64_tr_b16 v[184:185], v12 offset:24576
  ds_read_b64_tr_b16 v[186:187], v12 offset:28672
  buffer_load_dword v49, v48, s[72:75], s77 offen
  s_waitcnt lgkmcnt(10)
  v_mfma_f32_32x32x16_bf16 a[64:79], v[160:163], v[80:83], a[64:79]
  ds_read_b64_tr_b16 v[188:189], v13 offset:24576
  ds_read_b64_tr_b16 v[190:191], v13 offset:28672
  v_mfma_f32_32x32x16_bf16 a[80:95], v[164:167], v[80:83], a[80:95]
  ds_read_b64_tr_b16 v[192:193], v10 offset:24832
  v_fma_f32 v91, v91, s30, -v29
  ds_read_b64_tr_b16 v[194:195], v10 offset:28928
  v_exp_f32 v90, v90
  v_add_f32 v30, v30, v88
  v_fma_f32 v92, v92, s30, -v29
  v_exp_f32 v91, v91
  v_add_f32 v31, v31, v89
  v_cvt_pk_bf16_f32 v88, v88, v89
  v_fma_f32 v93, v93, s30, -v29
  v_exp_f32 v92, v92
  v_add_f32 v32, v32, v90
  v_fma_f32 v94, v94, s30, -v29
  v_exp_f32 v93, v93
  v_add_f32 v33, v33, v91
  v_cvt_pk_bf16_f32 v89, v90, v91
  v_fma_f32 v95, v95, s30, -v29
  v_exp_f32 v94, v94
  v_add_f32 v30, v30, v92
  v_exp_f32 v95, v95
  v_add_f32 v31, v31, v93
  v_cvt_pk_bf16_f32 v90, v92, v93
  v_add_f32 v32, v32, v94
  v_add_f32 v33, v33, v95
  v_cvt_pk_bf16_f32 v91, v94, v95
  s_waitcnt lgkmcnt(10)
  v_mfma_f32_32x32x16_bf16 a[96:111], v[168:171], v[80:83], a[96:111]
  ds_read_b64_tr_b16 v[196:197], v11 offset:24832
  ds_read_b64_tr_b16 v[198:199], v11 offset:28928
  v_mfma_f32_32x32x16_bf16 a[112:127], v[172:175], v[80:83], a[112:127]
  ds_read_b64_tr_b16 v[160:161], v12 offset:24832
  ds_read_b64_tr_b16 v[162:163], v12 offset:28928
  s_waitcnt lgkmcnt(10)
  v_mfma_f32_32x32x16_bf16 a[0:15], v[176:179], v[88:91], a[0:15]
  ds_read_b64_tr_b16 v[164:165], v13 offset:24832
  ds_read_b64_tr_b16 v[166:167], v13 offset:28928
  v_mfma_f32_32x32x16_bf16 a[16:31], v[180:183], v[88:91], a[16:31]
  s_waitcnt vmcnt(2) lgkmcnt(0)
  s_barrier
  s_cmp_lg_u32 s43, 0
  s_cbranch_scc0 L_ret_25
  s_call_b64 s[96:97], L_hook
L_ret_25:
  v_mfma_f32_32x32x16_bf16 a[32:47], v[184:187], v[88:91], a[32:47]
  v_mfma_f32_32x32x16_bf16 a[48:63], v[188:191], v[88:91], a[48:63]
  v_mfma_f32_32x32x16_bf16 a[64:79], v[192:195], v[88:91], a[64:79]
  v_mfma_f32_32x32x16_bf16 a[80:95], v[196:199], v[88:91], a[80:95]
  v_mfma_f32_32x32x16_bf16 a[96:111], v[160:163], v[88:91], a[96:111]
  v_mfma_f32_32x32x16_bf16 a[112:127], v[164:167], v[88:91], a[112:127]
  s_branch L_epi
L_tailq0:
  s_waitcnt lgkmcnt(0)
  s_cmp_lg_u32 s42, 0
  s_cbranch_scc1 L_resc_29
L_ret_30:
  ds_read_b64_tr_b16 v[160:161], v10 offset:0
  ds_read_b64_tr_b16 v[162:163], v10 offset:4096
  ds_read_b64_tr_b16 v[164:165], v11 offset:0
  ds_read_b64_tr_b16 v[166:167], v11 offset:4096
  ds_read_b64_tr_b16 v[168:169], v12 offset:0
  ds_read_b64_tr_b16 v[170:171], v12 offset:4096
  ds_read_b64_tr_b16 v[172:173], v13 offset:0
  ds_read_b64_tr_b16 v[174:175], v13 offset:4096
  ds_read_b64_tr_b16 v[176:177], v10 offset:256
  ds_read_b64_tr_b16 v[178:179], v10 offset:4352
  ds_read_b64_tr_b16 v[180:181], v11 offset:256
  ds_read_b64_tr_b16 v[182:183], v11 offset:4352
  ds_read_b64_tr_b16 v[184:185], v12 offset:256
  ds_read_b64_tr_b16 v[186:187], v12 offset:4352
  s_waitcnt lgkmcnt(10)
  v_mfma_f32_32x32x16_bf16 a[0:15], v[160:163], v[64:67], a[0:15]
  ds_read_b64_tr_b16 v[188:189], v13 offset:256
  ds_read_b64_tr_b16 v[190:191], v13 offset:4352
  v_xor_b32 v40, 0x0, v62
  s_add_u32 m0, s44, 131072
  s_add_u32 s55, s65, 0
  buffer_load_dwordx4 v40, s[4:7], s55 offen lds
  v_xor_b32 v41, 0x40, v62
  s_add_u32 m0, s44, 132096
  s_add_u32 s55, s65, 2048
  buffer_load_dwordx4 v41, s[4:7], s55 offen lds
  v_mfma_f32_32x32x16_bf16 a[16:31], v[164:167], v[64:67], a[16:31]
  ds_read_b64_tr_b16 v[192:193], v10 offset:8192
  ds_read_b64_tr_b16 v[194:195], v10 offset:12288
  v_xor_b32 v42, 0x80, v62
  s_add_u32 m0, s44, 133120
  s_add_u32 s55, s65, 4096
  buffer_load_dwordx4 v42, s[4:7], s55 offen lds
  s_waitcnt lgkmcnt(10)
  v_mfma_f32_32x32x16_bf16 a[32:47], v[168:171], v[64:67], a[32:47]
  ds_read_b64_tr_b16 v[196:197], v11 offset:8192
  ds_read_b64_tr_b16 v[198:199], v11 offset:12288
  v_xor_b32 v43, 0xc0, v62
  s_add_u32 m0, s44, 134144
  s_add_u32 s55, s65, 6144
  buffer_load_dwordx4 v43, s[4:7], s55 offen lds
  v_xor_b32 v40, 0x0, v62
  s_add_u32 m0, s44, 135168
  s_add_u32 s55, s65, 8192
  buffer_load_dwordx4 v40, s[4:7], s55 offen lds
  v_xor_b32 v41, 0x40, v62
  s_add_u32 m0, s44, 136192
  s_add_u32 s55, s65, 10240
  buffer_load_dwordx4 v41, s[4:7], s55 offen lds
  v_mfma_f32_32x32x16_bf16 a[48:63], v[172:175], v[64:67], a[48:63]
  ds_read_b64_tr_b16 v[160:161], v12 offset:8192
  ds_read_b64_tr_b16 v[162:163], v12 offset:12288
  v_xor_b32 v42, 0x80, v62
  s_add_u32 m0, s44, 137216
  s_add_u32 s55, s65, 12288
  buffer_load_dwordx4 v42, s[4:7], s55 offen lds
  s_waitcnt lgkmcnt(10)
  v_mfma_f32_32x32x16_bf16 a[64:79], v[176:179], v[64:67], a[64:79]
  ds_read_b64_tr_b16 v[164:165], v13 offset:8192
  ds_read_b64_tr_b16 v[166:167], v13 offset:12288
  v_xor_b32 v43, 0xc0, v62
  s_add_u32 m0, s44, 138240
  s_add_u32 s55, s65, 14336
  buffer_load_dwordx4 v43, s[4:7], s55 offen lds
  s_add_u32 m0, s44, 0
  s_nop 0
  buffer_load_dwordx4 v14, s[8:11], s34 offen offset:0 lds
  buffer_load_dwordx4 v15, s[8:11], s34 offen offset:1024 lds
  v_mfma_f32_32x32x16_bf16 a[80:95], v[180:183], v[64:67], a[80:95]
  ds_read_b64_tr_b16 v[168:169], v10 offset:8448
  ds_read_b64_tr_b16 v[170:171], v10 offset:12544
  buffer_load_dwordx4 v16, s[8:11], s34 offen offset:2048 lds
  s_waitcnt lgkmcnt(10)
  v_mfma_f32_32x32x16_bf16 a[96:111], v[184:187], v[64:67], a[96:111]
  ds_read_b64_tr_b16 v[172:173], v11 offset:8448
  ds_read_b64_tr_b16 v[174:175], v11 offset:12544
  buffer_load_dwordx4 v17, s[8:11], s34 offen offset:3072 lds
  s_add_u32 m0, s44, 4096
  s_nop 0
  buffer_load_dwordx4 v18, s[8:11], s34 offen offset:0 lds
  buffer_load_dwordx4 v19, s[8:11], s34 offen offset:1024 lds
  v_mfma_f32_32x32x16_bf16 a[112:127], v[188:191], v[64:67], a[112:127]
  ds_read_b64_tr_b16 v[176:177], v12 offset:8448
  ds_read_b64_tr_b16 v[178:179], v12 offset:12544
  buffer_load_dwordx4 v20, s[8:11], s34 offen offset:2048 lds
  s_waitcnt lgkmcnt(10)
  v_mfma_f32_32x32x16_bf16 a[0:15], v[192:195], v[72:75], a[0:15]
  ds_read_b64_tr_b16 v[180:181], v13 offset:8448
  ds_read_b64_tr_b16 v[182:183], v13 offset:12544
  buffer_load_dwordx4 v21, s[8:11], s34 offen offset:3072 lds
  s_add_u32 s37, s37, 1
  s_add_u32 s34, s34, 0x8000
  s_cmp_eq_u32 s37, s39
  s_cselect_b32 s34, s40, s34
  s_cmp_ge_u32 s37, s41
  s_cselect_b32 s34, s45, s34
  s_add_u32 s36, s35, 0x1000
  s_add_u32 m0, s44, 98304
  s_nop 0
  buffer_load_dwordx4 v22, s[12:15], s35 offen offset:0 lds
  v_mfma_f32_32x32x16_bf16 a[16:31], v[196:199], v[72:75], a[16:31]
  ds_read_b64_tr_b16 v[184:185], v10 offset:16384
  ds_read_b64_tr_b16 v[186:187], v10 offset:20480
  buffer_load_dwordx4 v23, s[12:15], s35 offen offset:1024 lds
  s_waitcnt lgkmcnt(10)
  v_mfma_f32_32x32x16_bf16 a[32:47], v[160:163], v[72:75], a[32:47]
  ds_read_b64_tr_b16 v[188:189], v11 offset:16384
  ds_read_b64_tr_b16 v[190:191], v11 offset:20480
  buffer_load_dwordx4 v22, s[12:15], s35 offen offset:2048 lds
  buffer_load_dwordx4 v23, s[12:15], s35 offen offset:3072 lds
  s_add_u32 m0, s44, 102400
  s_nop 0
  buffer_load_dwordx4 v22, s[12:15], s36 offen offset:0 lds
  v_mfma_f32_32x32x16_bf16 a[48:63], v[164:167], v[72:75], a[48:63]
  ds_read_b64_tr_b16 v[192:193], v12 offset:16384
  ds_read_b64_tr_b16 v[194:195], v12 offset:20480
  buffer_load_dwordx4 v23, s[12:15], s36 offen offset:1024 lds
  s_waitcnt lgkmcnt(10)
  v_mfma_f32_32x32x16_bf16 a[64:79], v[168:171], v[72:75], a[64:79]
  ds_read_b64_tr_b16 v[196:197], v13 offset:16384
  ds_read_b64_tr_b16 v[198:199], v13 offset:20480
  buffer_load_dwordx4 v22, s[12:15], s36 offen offset:2048 lds
  buffer_load_dwordx4 v23, s[12:15], s36 offen offset:3072 lds
  s_add_u32 s38, s38, 1
  s_add_u32 s35, s35, 0x8000
  s_cmp_eq_u32 s38, s39
  s_cselect_b32 s35, s40, s35
  s_cmp_ge_u32 s38, s41
  s_cselect_b32 s35, s45, s35
  v_mfma_f32_32x32x16_bf16 a[80:95], v[172:175], v[72:75], a[80:95]
  ds_read_b64_tr_b16 v[160:161], v10 offset:16640
  v_fma_f32 v80, v80, s30, -v29
  ds_read_b64_tr_b16 v[162:163], v10 offset:20736
  v_fma_f32 v81, v81, s30, -v29
  s_waitcnt vmcnt(16)
  v_exp_f32 v80, v80
  v_xor_b32 v44, 0x0, v24
  ds_read_b128 a[128:131], v44 offset:32768
  v_fma_f32 v82, v82, s30, -v29
  v_xor_b32 v45, 0x20, v24
  ds_read_b128 a[132:135], v45 offset:32768
  v_exp_f32 v81, v81
  v_fma_f32 v83, v83, s30, -v29
  v_exp_f32 v82, v82
  v_add_f32 v30, v30, v80
  v_fma_f32 v84, v84, s30, -v29
  v_exp_f32 v83, v83
  v_add_f32 v31, v31, v81
  v_cvt_pk_bf16_f32 v80, v80, v81
  v_fma_f32 v85, v85, s30, -v29
  v_exp_f32 v84, v84
  v_add_f32 v32, v32, v82
  v_fma_f32 v86, v86, s30, -v29
  v_exp_f32 v85, v85
  v_add_f32 v33, v33, v83
  v_cvt_pk_bf16_f32 v81, v82, v83
  v_fma_f32 v87, v87, s30, -v29
  v_exp_f32 v86, v86
  v_add_f32 v30, v30, v84
  v_fma_f32 v88, v88, s30, -v29
  v_exp_f32 v87, v87
  v_add_f32 v31, v31, v85
  v_cvt_pk_bf16_f32 v82, v84, v85
  v_fma_f32 v89, v89, s30, -v29
  v_exp_f32 v88, v88
  v_add_f32 v32, v32, v86
  v_fma_f32 v90, v90, s30, -v29
  v_exp_f32 v89, v89
  v_add_f32 v33, v33, v87
  v_cvt_pk_bf16_f32 v83, v86, v87
  s_waitcnt lgkmcnt(12)
  v_mfma_f32_32x32x16_bf16 a[96:111], v[176:179], v[72:75], a[96:111]
  ds_read_b64_tr_b16 v[164:165], v11 offset:16640
  ds_read_b64_tr_b16 v[166:167], v11 offset:20736
  v_xor_b32 v46, 0x40, v24
  ds_read_b128 a[136:139], v46 offset:32768
  v_mfma_f32_32x32x16_bf16 a[112:127], v[180:183], v[72:75], a[112:127]
  ds_read_b64_tr_b16 v[168:169], v12 offset:16640
  ds_read_b64_tr_b16 v[170:171], v12 offset:20736
  v_xor_b32 v47, 0x60, v24
  ds_read_b128 a[140:143], v47 offset:32768
  v_xor_b32 v44, 0x80, v24
  ds_read_b128 a[144:147], v44 offset:32768
  v_xor_b32 v45, 0xa0, v24
  ds_read_b128 a[148:151], v45 offset:32768
  s_waitcnt lgkmcnt(15)
  v_mfma_f32_32x32x16_bf16 a[0:15], v[184:187], v[80:83], a[0:15]
  ds_read_b64_tr_b16 v[172:173], v13 offset:16640
  ds_read_b64_tr_b16 v[174:175], v13 offset:20736
  v_xor_b32 v46, 0xc0, v24
  ds_read_b128 a[152:155], v46 offset:32768
  v_mfma_f32_32x32x16_bf16 a[16:31], v[188:191], v[80:83], a[16:31]
  ds_read_b64_tr_b16 v[176:177], v10 offset:24576
  ds_read_b64_tr_b16 v[178:179], v10 offset:28672
  v_xor_b32 v47, 0xe0, v24
  ds_read_b128 a[156:159], v47 offset:32768
  s_waitcnt lgkmcnt(15)
  v_mfma_f32_32x32x16_bf16 a[32:47], v[192:195], v[80:83], a[32:47]
  ds_read_b64_tr_b16 v[180:181], v11 offset:24576
  ds_read_b64_tr_b16 v[182:183], v11 offset:28672
  s_waitcnt lgkmcnt(0)
  v_xor_b32 v40, 0x0, v62
  s_add_u32 m0, s44, 131072
  s_add_u32 s55, s65, 256
  buffer_load_dwordx4 v40, s[4:7], s55 offen lds
  v_xor_b32 v41, 0x40, v62
  s_add_u32 m0, s44, 132096
  s_add_u32 s55, s65, 2304
  buffer_load_dwordx4 v41, s[4:7], s55 offen lds
  v_mfma_f32_32x32x16_bf16 a[48:63], v[196:199], v[80:83], a[48:63]
  ds_read_b64_tr_b16 v[184:185], v12 offset:24576
  ds_read_b64_tr_b16 v[186:187], v12 offset:28672
  v_xor_b32 v42, 0x80, v62
  s_add_u32 m0, s44, 133120
  s_add_u32 s55, s65, 4352
  buffer_load_dwordx4 v42, s[4:7], s55 offen lds
  v_mfma_f32_32x32x16_bf16 a[64:79], v[160:163], v[80:83], a[64:79]
  ds_read_b64_tr_b16 v[188:189], v13 offset:24576
  ds_read_b64_tr_b16 v[190:191], v13 offset:28672
  v_xor_b32 v43, 0xc0, v62
  s_add_u32 m0, s44, 134144
  s_add_u32 s55, s65, 6400
  buffer_load_dwordx4 v43, s[4:7], s55 offen lds
  v_xor_b32 v40, 0x0, v62
  s_add_u32 m0, s44, 135168
  s_add_u32 s55, s65, 8448
  buffer_load_dwordx4 v40, s[4:7], s55 offen lds
  v_xor_b32 v41, 0x40, v62
  s_add_u32 m0, s44, 136192
  s_add_u32 s55, s65, 10496
  buffer_load_dwordx4 v41, s[4:7], s55 offen lds
  v_mfma_f32_32x32x16_bf16 a[80:95], v[164:167], v[80:83], a[80:95]
  ds_read_b64_tr_b16 v[192:193], v10 offset:24832
  v_fma_f32 v91, v91, s30, -v29
  ds_read_b64_tr_b16 v[194:195], v10 offset:28928
  v_exp_f32 v90, v90
  v_xor_b32 v42, 0x80, v62
  s_add_u32 m0, s44, 137216
  s_add_u32 s55, s65, 12544
  buffer_load_dwordx4 v42, s[4:7], s55 offen lds
  v_add_f32 v30, v30, v88
  v_fma_f32 v92, v92, s30, -v29
  v_exp_f32 v91, v91
  v_add_f32 v31, v31, v89
  v_cvt_pk_bf16_f32 v88, v88, v89
  v_fma_f32 v93, v93, s30, -v29
  v_exp_f32 v92, v92
  v_add_f32 v32, v32, v90
  v_fma_f32 v94, v94, s30, -v29
  v_exp_f32 v93, v93
  v_add_f32 v33, v33, v91
  v_cvt_pk_bf16_f32 v89, v90, v91
  v_fma_f32 v95, v95, s30, -v29
  v_exp_f32 v94, v94
  v_add_f32 v30, v30, v92
  v_exp_f32 v95, v95
  v_add_f32 v31, v31, v93
  v_cvt_pk_bf16_f32 v90, v92, v93
  v_add_f32 v32, v32, v94
  v_add_f32 v33, v33, v95
  v_cvt_pk_bf16_f32 v91, v94, v95
  v_mfma_f32_32x32x16_bf16 a[96:111], v[168:171], v[80:83], a[96:111]
  ds_read_b64_tr_b16 v[196:197], v11 offset:24832
  ds_read_b64_tr_b16 v[198:199], v11 offset:28928
  v_xor_b32 v43, 0xc0, v62
  s_add_u32 m0, s44, 138240
  s_add_u32 s55, s65, 14592
  buffer_load_dwordx4 v43, s[4:7], s55 offen lds
  buffer_load_dword v49, v48, s[68:71], s76 offen
  buffer_load_dword v49, v48, s[72:75], s77 offen
  v_mfma_f32_32x32x16_bf16 a[112:127], v[172:175], v[80:83], a[112:127]
  ds_read_b64_tr_b16 v[160:161], v12 offset:24832
  ds_read_b64_tr_b16 v[162:163], v12 offset:28928
  v_mfma_f32_32x32x16_bf16 a[0:15], v[176:179], v[88:91], a[0:15]
  ds_read_b64_tr_b16 v[164:165], v13 offset:24832
  ds_read_b64_tr_b16 v[166:167], v13 offset:28928
  v_mfma_f32_32x32x16_bf16 a[16:31], v[180:183], v[88:91], a[16:31]
  s_waitcnt vmcnt(2) lgkmcnt(0)
  s_barrier
  s_cmp_lg_u32 s43, 0
  s_cbranch_scc0 L_ret_31
  s_call_b64 s[96:97], L_hook
L_ret_31:
  v_xor_b32 v44, 0x0, v24
  ds_read_b128 a[160:163], v44 offset:32768
  v_xor_b32 v45, 0x20, v24
  ds_read_b128 a[164:167], v45 offset:32768
  v_mfma_f32_32x32x16_bf16 a[32:47], v[184:187], v[88:91], a[32:47]
  v_xor_b32 v46, 0x40, v24
  ds_read_b128 a[168:171], v46 offset:32768
  v_mfma_f32_32x32x16_bf16 a[48:63], v[188:191], v[88:91], a[48:63]
  v_xor_b32 v47, 0x60, v24
  ds_read_b128 a[172:175], v47 offset:32768
  v_xor_b32 v44, 0x80, v24
  ds_read_b128 a[176:179], v44 offset:32768
  v_xor_b32 v45, 0xa0, v24
  ds_read_b128 a[180:183], v45 offset:32768
  v_mfma_f32_32x32x16_bf16 a[64:79], v[192:195], v[88:91], a[64:79]
  v_xor_b32 v46, 0xc0, v24
  ds_read_b128 a[184:187], v46 offset:32768
  v_mfma_f32_32x32x16_bf16 a[80:95], v[196:199], v[88:91], a[80:95]
  v_xor_b32 v47, 0xe0, v24
  ds_read_b128 a[188:191], v47 offset:32768
  v_mfma_f32_32x32x16_bf16 a[96:111], v[160:163], v[88:91], a[96:111]
  v_mfma_f32_32x32x16_bf16 a[112:127], v[164:167], v[88:91], a[112:127]
  s_waitcnt lgkmcnt(0)
  s_branch L_epi
L_tailq1:
  s_waitcnt lgkmcnt(0)
  s_cmp_lg_u32 s42, 0
  s_cbranch_scc1 L_resc_32
L_ret_33:
  ds_read_b64_tr_b16 v[160:161], v10 offset:32768
  ds_read_b64_tr_b16 v[162:163], v10 offset:36864
  ds_read_b64_tr_b16 v[164:165], v11 offset:32768
  ds_read_b64_tr_b16 v[166:167], v11 offset:36864
  ds_read_b64_tr_b16 v[168:169], v12 offset:32768
  ds_read_b64_tr_b16 v[170:171], v12 offset:36864
  ds_read_b64_tr_b16 v[172:173], v13 offset:32768
  ds_read_b64_tr_b16 v[174:175], v13 offset:36864
  ds_read_b64_tr_b16 v[176:177], v10 offset:33024
  ds_read_b64_tr_b16 v[178:179], v10 offset:37120
  ds_read_b64_tr_b16 v[180:181], v11 offset:33024
  ds_read_b64_tr_b16 v[182:183], v11 offset:37120
  ds_read_b64_tr_b16 v[184:185], v12 offset:33024
  ds_read_b64_tr_b16 v[186:187], v12 offset:37120
  s_waitcnt lgkmcnt(10)
  v_mfma_f32_32x32x16_bf16 a[0:15], v[160:163], v[96:99], a[0:15]
  ds_read_b64_tr_b16 v[188:189], v13 offset:33024
  ds_read_b64_tr_b16 v[190:191], v13 offset:37120
  v_xor_b32 v40, 0x0, v62
  s_add_u32 m0, s44, 131072
  s_add_u32 s55, s65, 0
  buffer_load_dwordx4 v40, s[4:7], s55 offen lds
  v_xor_b32 v41, 0x40, v62
  s_add_u32 m0, s44, 132096
  s_add_u32 s55, s65, 2048
  buffer_load_dwordx4 v41, s[4:7], s55 offen lds
  v_mfma_f32_32x32x16_bf16 a[16:31], v[164:167], v[96:99], a[16:31]
  ds_read_b64_tr_b16 v[192:193], v10 offset:40960
  ds_read_b64_tr_b16 v[194:195], v10 offset:45056
  v_xor_b32 v42, 0x80, v62
  s_add_u32 m0, s44, 133120
  s_add_u32 s55, s65, 4096
  buffer_load_dwordx4 v42, s[4:7], s55 offen lds
  s_waitcnt lgkmcnt(10)
  v_mfma_f32_32x32x16_bf16 a[32:47], v[168:171], v[96:99], a[32:47]
  ds_read_b64_tr_b16 v[196:197], v11 offset:40960
  ds_read_b64_tr_b16 v[198:199], v11 offset:45056
  v_xor_b32 v43, 0xc0, v62
  s_add_u32 m0, s44, 134144
  s_add_u32 s55, s65, 6144
  buffer_load_dwordx4 v43, s[4:7], s55 offen lds
  v_xor_b32 v40, 0x0, v62
  s_add_u32 m0, s44, 135168
  s_add_u32 s55, s65, 8192
  buffer_load_dwordx4 v40, s[4:7], s55 offen lds
  v_xor_b32 v41, 0x40, v62
  s_add_u32 m0, s44, 136192
  s_add_u32 s55, s65, 10240
  buffer_load_dwordx4 v41, s[4:7], s55 offen lds
  v_mfma_f32_32x32x16_bf16 a[48:63], v[172:175], v[96:99], a[48:63]
  ds_read_b64_tr_b16 v[160:161], v12 offset:40960
  ds_read_b64_tr_b16 v[162:163], v12 offset:45056
  v_xor_b32 v42, 0x80, v62
  s_add_u32 m0, s44, 137216
  s_add_u32 s55, s65, 12288
  buffer_load_dwordx4 v42, s[4:7], s55 offen lds
  s_waitcnt lgkmcnt(10)
  v_mfma_f32_32x32x16_bf16 a[64:79], v[176:179], v[96:99], a[64:79]
  ds_read_b64_tr_b16 v[164:165], v13 offset:40960
  ds_read_b64_tr_b16 v[166:167], v13 offset:45056
  v_xor_b32 v43, 0xc0, v62
  s_add_u32 m0, s44, 138240
  s_add_u32 s55, s65, 14336
  buffer_load_dwordx4 v43, s[4:7], s55 offen lds
  s_add_u32 m0, s44, 32768
  s_nop 0
  buffer_load_dwordx4 v14, s[8:11], s34 offen offset:0 lds
  buffer_load_dwordx4 v15, s[8:11], s34 offen offset:1024 lds
  v_mfma_f32_32x32x16_bf16 a[80:95], v[180:183], v[96:99], a[80:95]
  ds_read_b64_tr_b16 v[168:169], v10 offset:41216
  ds_read_b64_tr_b16 v[170:171], v10 offset:45312
  buffer_load_dwordx4 v16, s[8:11], s34 offen offset:2048 lds
  s_waitcnt lgkmcnt(10)
  v_mfma_f32_32x32x16_bf16 a[96:111], v[184:187], v[96:99], a[96:111]
  ds_read_b64_tr_b16 v[172:173], v11 offset:41216
  ds_read_b64_tr_b16 v[174:175], v11 offset:45312
  buffer_load_dwordx4 v17, s[8:11], s34 offen offset:3072 lds
  s_add_u32 m0, s44, 36864
  s_nop 0
  buffer_load_dwordx4 v18, s[8:11], s34 offen offset:0 lds
  buffer_load_dwordx4 v19, s[8:11], s34 offen offset:1024 lds
  v_mfma_f32_32x32x16_bf16 a[112:127], v[188:191], v[96:99], a[112:127]
  ds_read_b64_tr_b16 v[176:177], v12 offset:41216
  ds_read_b64_tr_b16 v[178:179], v12 offset:45312
  buffer_load_dwordx4 v20, s[8:11], s34 offen offset:2048 lds
  s_waitcnt lgkmcnt(10)
  v_mfma_f32_32x32x16_bf16 a[0:15], v[192:195], v[104:107], a[0:15]
  ds_read_b64_tr_b16 v[180:181], v13 offset:41216
  ds_read_b64_tr_b16 v[182:183], v13 offset:45312
  buffer_load_dwordx4 v21, s[8:11], s34 offen offset:3072 lds
  s_add_u32 s37, s37, 1
  s_add_u32 s34, s34, 0x8000
  s_cmp_eq_u32 s37, s39
  s_cselect_b32 s34, s40, s34
  s_cmp_ge_u32 s37, s41
  s_cselect_b32 s34, s45, s34
  s_add_u32 s36, s35, 0x1000
  s_add_u32 m0, s44, 65536
  s_nop 0
  buffer_load_dwordx4 v22, s[12:15], s35 offen offset:0 lds
  v_mfma_f32_32x32x16_bf16 a[16:31], v[196:199], v[104:107], a[16:31]
  ds_read_b64_tr_b16 v[184:185], v10 offset:49152
  ds_read_b64_tr_b16 v[186:187], v10 offset:53248
  buffer_load_dwordx4 v23, s[12:15], s35 offen offset:1024 lds
  s_waitcnt lgkmcnt(10)
  v_mfma_f32_32x32x16_bf16 a[32:47], v[160:163], v[104:107], a[32:47]
  ds_read_b64_tr_b16 v[188:189], v11 offset:49152
  ds_read_b64_tr_b16 v[190:191], v11 offset:53248
  buffer_load_dwordx4 v22, s[12:15], s35 offen offset:2048 lds
  buffer_load_dwordx4 v23, s[12:15], s35 offen offset:3072 lds
  s_add_u32 m0, s44, 69632
  s_nop 0
  buffer_load_dwordx4 v22, s[12:15], s36 offen offset:0 lds
  v_mfma_f32_32x32x16_bf16 a[48:63], v[164:167], v[104:107], a[48:63]
  ds_read_b64_tr_b16 v[192:193], v12 offset:49152
  ds_read_b64_tr_b16 v[194:195], v12 offset:53248
  buffer_load_dwordx4 v23, s[12:15], s36 offen offset:1024 lds
  s_waitcnt lgkmcnt(10)
  v_mfma_f32_32x32x16_bf16 a[64:79], v[168:171], v[104:107], a[64:79]
  ds_read_b64_tr_b16 v[196:197], v13 offset:49152
  ds_read_b64_tr_b16 v[198:199], v13 offset:53248
  buffer_load_dwordx4 v22, s[12:15], s36 offen offset:2048 lds
  buffer_load_dwordx4 v23, s[12:15], s36 offen offset:3072 lds
  s_add_u32 s38, s38, 1
  s_add_u32 s35, s35, 0x8000
  s_cmp_eq_u32 s38, s39
  s_cselect_b32 s35, s40, s35
  s_cmp_ge_u32 s38, s41
  s_cselect_b32 s35, s45, s35
  v_mfma_f32_32x32x16_bf16 a[80:95], v[172:175], v[104:107], a[80:95]
  ds_read_b64_tr_b16 v[160:161], v10 offset:49408
  v_fma_f32 v112, v112, s30, -v29
  ds_read_b64_tr_b16 v[162:163], v10 offset:53504
  v_fma_f32 v113, v113, s30, -v29
  s_waitcnt vmcnt(16)
  v_exp_f32 v112, v112
  v_xor_b32 v44, 0x0, v24
  ds_read_b128 a[128:131], v44 offset:32768
  v_fma_f32 v114, v114, s30, -v29
  v_xor_b32 v45, 0x20, v24
  ds_read_b128 a[132:135], v45 offset:32768
  v_exp_f32 v113, v113
  v_fma_f32 v115, v115, s30, -v29
  v_exp_f32 v114, v114
  v_add_f32 v30, v30, v112
  v_fma_f32 v116, v116, s30, -v29
  v_exp_f32 v115, v115
  v_add_f32 v31, v31, v113
  v_cvt_pk_bf16_f32 v112, v112, v113
  v_fma_f32 v117, v117, s30, -v29
  v_exp_f32 v116, v116
  v_add_f32 v32, v32, v114
  v_fma_f32 v118, v118, s30, -v29
  v_exp_f32 v117, v117
  v_add_f32 v33, v33, v115
  v_cvt_pk_bf16_f32 v113, v114, v115
  v_fma_f32 v119, v119, s30, -v29
  v_exp_f32 v118, v118
  v_add_f32 v30, v30, v116
  v_fma_f32 v120, v120, s30, -v29
  v_exp_f32 v119, v119
  v_add_f32 v31, v31, v117
  v_cvt_pk_bf16_f32 v114, v116, v117
  v_fma_f32 v121, v121, s30, -v29
  v_exp_f32 v120, v120
  v_add_f32 v32, v32, v118
  v_fma_f32 v122, v122, s30, -v29
  v_exp_f32 v121, v121
  v_add_f32 v33, v33, v119
  v_cvt_pk_bf16_f32 v115, v118, v119
  s_waitcnt lgkmcnt(12)
  v_mfma_f32_32x32x16_bf16 a[96:111], v[176:179], v[104:107], a[96:111]
  ds_read_b64_tr_b16 v[164:165], v11 offset:49408
  ds_read_b64_tr_b16 v[166:167], v11 offset:53504
  v_xor_b32 v46, 0x40, v24
  ds_read_b128 a[136:139], v46 offset:32768
  v_mfma_f32_32x32x16_bf16 a[112:127], v[180:183], v[104:107], a[112:127]
  ds_read_b64_tr_b16 v[168:169], v12 offset:49408
  ds_read_b64_tr_b16 v[170:171], v12 offset:53504
  v_xor_b32 v47, 0x60, v24
  ds_read_b128 a[140:143], v47 offset:32768
  v_xor_b32 v44, 0x80, v24
  ds_read_b128 a[144:147], v44 offset:32768
  v_xor_b32 v45, 0xa0, v24
  ds_read_b128 a[148:151], v45 offset:32768
  s_waitcnt lgkmcnt(15)
  v_mfma_f32_32x32x16_bf16 a[0:15], v[184:187], v[112:115], a[0:15]
  ds_read_b64_tr_b16 v[172:173], v13 offset:49408
  ds_read_b64_tr_b16 v[174:175], v13 offset:53504
  v_xor_b32 v46, 0xc0, v24
  ds_read_b128 a[152:155], v46 offset:32768
  v_mfma_f32_32x32x16_bf16 a[16:31], v[188:191], v[112:115], a[16:31]
  ds_read_b64_tr_b16 v[176:177], v10 offset:57344
  ds_read_b64_tr_b16 v[178:179], v10 offset:61440
  v_xor_b32 v47, 0xe0, v24
  ds_read_b128 a[156:159], v47 offset:32768
  s_waitcnt lgkmcnt(15)
  v_mfma_f32_32x32x16_bf16 a[32:47], v[192:195], v[112:115], a[32:47]
  ds_read_b64_tr_b16 v[180:181], v11 offset:57344
  ds_read_b64_tr_b16 v[182:183], v11 offset:61440
  s_waitcnt lgkmcnt(0)
  v_xor_b32 v40, 0x0, v62
  s_add_u32 m0, s44, 131072
  s_add_u32 s55, s65, 256
  buffer_load_dwordx4 v40, s[4:7], s55 offen lds
  v_xor_b32 v41, 0x40, v62
  s_add_u32 m0, s44, 132096
  s_add_u32 s55, s65, 2304
  buffer_load_dwordx4 v41, s[4:7], s55 offen lds
  v_mfma_f32_32x32x16_bf16 a[48:63], v[196:199], v[112:115], a[48:63]
  ds_read_b64_tr_b16 v[184:185], v12 offset:57344
  ds_read_b64_tr_b16 v[186:187], v12 offset:61440
  v_xor_b32 v42, 0x80, v62
  s_add_u32 m0, s44, 133120
  s_add_u32 s55, s65, 4352
  buffer_load_dwordx4 v42, s[4:7], s55 offen lds
  v_mfma_f32_32x32x16_bf16 a[64:79], v[160:163], v[112:115], a[64:79]
  ds_read_b64_tr_b16 v[188:189], v13 offset:57344
  ds_read_b64_tr_b16 v[190:191], v13 offset:61440
  v_xor_b32 v43, 0xc0, v62
  s_add_u32 m0, s44, 134144
  s_add_u32 s55, s65, 6400
  buffer_load_dwordx4 v43, s[4:7], s55 offen lds
  v_xor_b32 v40, 0x0, v62
  s_add_u32 m0, s44, 135168
  s_add_u32 s55, s65, 8448
  buffer_load_dwordx4 v40, s[4:7], s55 offen lds
  v_xor_b32 v41, 0x40, v62
  s_add_u32 m0, s44, 136192
  s_add_u32 s55, s65, 10496
  buffer_load_dwordx4 v41, s[4:7], s55 offen lds
  v_mfma_f32_32x32x16_bf16 a[80:95], v[164:167], v[112:115], a[80:95]
  ds_read_b64_tr_b16 v[192:193], v10 offset:57600
  v_fma_f32 v123, v123, s30, -v29
  ds_read_b64_tr_b16 v[194:195], v10 offset:61696
  v_exp_f32 v122, v122
  v_xor_b32 v42, 0x80, v62
  s_add_u32 m0, s44, 137216
  s_add_u32 s55, s65, 12544
  buffer_load_dwordx4 v42, s[4:7], s55 offen lds
  v_add_f32 v30, v30, v120
  v_fma_f32 v124, v124, s30, -v29
  v_exp_f32 v123, v123
  v_add_f32 v31, v31, v121
  v_cvt_pk_bf16_f32 v120, v120, v121
  v_fma_f32 v125, v125, s30, -v29
  v_exp_f32 v124, v124
  v_add_f32 v32, v32, v122
  v_fma_f32 v126, v126, s30, -v29
  v_exp_f32 v125, v125
  v_add_f32 v33, v33, v123
  v_cvt_pk_bf16_f32 v121, v122, v123
  v_fma_f32 v127, v127, s30, -v29
  v_exp_f32 v126, v126
  v_add_f32 v30, v30, v124
  v_exp_f32 v127, v127
  v_add_f32 v31, v31, v125
  v_cvt_pk_bf16_f32 v122, v124, v125
  v_add_f32 v32, v32, v126
  v_add_f32 v33, v33, v127
  v_cvt_pk_bf16_f32 v123, v126, v127
  v_mfma_f32_32x32x16_bf16 a[96:111], v[168:171], v[112:115], a[96:111]
  ds_read_b64_tr_b16 v[196:197], v11 offset:57600
  ds_read_b64_tr_b16 v[198:199], v11 offset:61696
  v_xor_b32 v43, 0xc0, v62
  s_add_u32 m0, s44, 138240
  s_add_u32 s55, s65, 14592
  buffer_load_dwordx4 v43, s[4:7], s55 offen lds
  buffer_load_dword v49, v48, s[68:71], s76 offen
  buffer_load_dword v49, v48, s[72:75], s77 offen
  v_mfma_f32_32x32x16_bf16 a[112:127], v[172:175], v[112:115], a[112:127]
  ds_read_b64_tr_b16 v[160:161], v12 offset:57600
  ds_read_b64_tr_b16 v[162:163], v12 offset:61696
  v_mfma_f32_32x32x16_bf16 a[0:15], v[176:179], v[120:123], a[0:15]
  ds_read_b64_tr_b16 v[164:165], v13 offset:57600
  ds_read_b64_tr_b16 v[166:167], v13 offset:61696
  v_mfma_f32_32x32x16_bf16 a[16:31], v[180:183], v[120:123], a[16:31]
  s_waitcnt vmcnt(2) lgkmcnt(0)
  s_barrier
  s_cmp_lg_u32 s43, 0
  s_cbranch_scc0 L_ret_34
  s_call_b64 s[96:97], L_hook
L_ret_34:
  v_xor_b32 v44, 0x0, v24
  ds_read_b128 a[160:163], v44 offset:32768
  v_xor_b32 v45, 0x20, v24
  ds_read_b128 a[164:167], v45 offset:32768
  v_mfma_f32_32x32x16_bf16 a[32:47], v[184:187], v[120:123], a[32:47]
  v_xor_b32 v46, 0x40, v24
  ds_read_b128 a[168:171], v46 offset:32768
  v_mfma_f32_32x32x16_bf16 a[48:63], v[188:191], v[120:123], a[48:63]
  v_xor_b32 v47, 0x60, v24
  ds_read_b128 a[172:175], v47 offset:32768
  v_xor_b32 v44, 0x80, v24
  ds_read_b128 a[176:179], v44 offset:32768
  v_xor_b32 v45, 0xa0, v24
  ds_read_b128 a[180:183], v45 offset:32768
  v_mfma_f32_32x32x16_bf16 a[64:79], v[192:195], v[120:123], a[64:79]
  v_xor_b32 v46, 0xc0, v24
  ds_read_b128 a[184:187], v46 offset:32768
  v_mfma_f32_32x32x16_bf16 a[80:95], v[196:199], v[120:123], a[80:95]
  v_xor_b32 v47, 0xe0, v24
  ds_read_b128 a[188:191], v47 offset:32768
  v_mfma_f32_32x32x16_bf16 a[96:111], v[160:163], v[120:123], a[96:111]
  v_mfma_f32_32x32x16_bf16 a[112:127], v[164:167], v[120:123], a[112:127]
  s_waitcnt lgkmcnt(0)
  s_branch L_epi
L_tail1:
  s_cmp_eq_u32 s48, 0
  s_cbranch_scc1 L_tailq1
  s_waitcnt lgkmcnt(0)
  s_cmp_lg_u32 s42, 0
  s_cbranch_scc1 L_resc_26
L_ret_27:
  ds_read_b64_tr_b16 v[160:161], v10 offset:32768
  ds_read_b64_tr_b16 v[162:163], v10 offset:36864
  ds_read_b64_tr_b16 v[164:165], v11 offset:32768
  ds_read_b64_tr_b16 v[166:167], v11 offset:36864
  ds_read_b64_tr_b16 v[168:169], v12 offset:32768
  ds_read_b64_tr_b16 v[170:171], v12 offset:36864
  ds_read_b64_tr_b16 v[172:173], v13 offset:32768
  ds_read_b64_tr_b16 v[174:175], v13 offset:36864
  ds_read_b64_tr_b16 v[176:177], v10 offset:33024
  ds_read_b64_tr_b16 v[178:179], v10 offset:37120
  ds_read_b64_tr_b16 v[180:181], v11 offset:33024
  ds_read_b64_tr_b16 v[182:183], v11 offset:37120
  ds_read_b64_tr_b16 v[184:185], v12 offset:33024
  ds_read_b64_tr_b16 v[186:187], v12 offset:37120
  s_waitcnt lgkmcnt(10)
  v_mfma_f32_32x32x16_bf16 a[0:15], v[160:163], v[96:99], a[0:15]
  ds_read_b64_tr_b16 v[188:189], v13 offset:33024
  ds_read_b64_tr_b16 v[190:191], v13 offset:37120
  s_add_u32 m0, s44, 32768
  s_nop 0
  buffer_load_dwordx4 v14, s[8:11], s34 offen offset:0 lds
  v_mfma_f32_32x32x16_bf16 a[16:31], v[164:167], v[96:99], a[16:31]
  ds_read_b64_tr_b16 v[192:193], v10 offset:40960
  v_fma_f32 v112, v112, s30, -v29
  ds_read_b64_tr_b16 v[194:195], v10 offset:45056
  buffer_load_dwordx4 v15, s[8:11], s34 offen offset:1024 lds
  s_waitcnt lgkmcnt(10)
  v_mfma_f32_32x32x16_bf16 a[32:47], v[168:171], v[96:99], a[32:47]
  ds_read_b64_tr_b16 v[196:197], v11 offset:40960
  v_fma_f32 v113, v113, s30, -v29
  ds_read_b64_tr_b16 v[198:199], v11 offset:45056
  buffer_load_dwordx4 v16, s[8:11], s34 offen offset:2048 lds
  v_mfma_f32_32x32x16_bf16 a[48:63], v[172:175], v[96:99], a[48:63]
  ds_read_b64_tr_b16 v[160:161], v12 offset:40960
  ds_read_b64_tr_b16 v[162:163], v12 offset:45056
  buffer_load_dwordx4 v17, s[8:11], s34 offen offset:3072 lds
  s_waitcnt lgkmcnt(10)
  v_mfma_f32_32x32x16_bf16 a[64:79], v[176:179], v[96:99], a[64:79]
  ds_read_b64_tr_b16 v[164:165], v13 offset:40960
  ds_read_b64_tr_b16 v[166:167], v13 offset:45056
  s_add_u32 m0, s44, 36864
  s_nop 0
  buffer_load_dwordx4 v18, s[8:11], s34 offen offset:0 lds
  v_mfma_f32_32x32x16_bf16 a[80:95], v[180:183], v[96:99], a[80:95]
  ds_read_b64_tr_b16 v[168:169], v10 offset:41216
  v_exp_f32 v112, v112
  ds_read_b64_tr_b16 v[170:171], v10 offset:45312
  buffer_load_dwordx4 v19, s[8:11], s34 offen offset:1024 lds
  s_waitcnt lgkmcnt(10)
  v_mfma_f32_32x32x16_bf16 a[96:111], v[184:187], v[96:99], a[96:111]
  ds_read_b64_tr_b16 v[172:173], v11 offset:41216
  ds_read_b64_tr_b16 v[174:175], v11 offset:45312
  buffer_load_dwordx4 v20, s[8:11], s34 offen offset:2048 lds
  v_mfma_f32_32x32x16_bf16 a[112:127], v[188:191], v[96:99], a[112:127]
  ds_read_b64_tr_b16 v[176:177], v12 offset:41216
  v_fma_f32 v114, v114, s30, -v29
  ds_read_b64_tr_b16 v[178:179], v12 offset:45312
  buffer_load_dwordx4 v21, s[8:11], s34 offen offset:3072 lds
  s_waitcnt lgkmcnt(10)
  v_mfma_f32_32x32x16_bf16 a[0:15], v[192:195], v[104:107], a[0:15]
  ds_read_b64_tr_b16 v[180:181], v13 offset:41216
  ds_read_b64_tr_b16 v[182:183], v13 offset:45312
  s_add_u32 s37, s37, 1
  s_add_u32 s34, s34, 0x8000
  s_cmp_eq_u32 s37, s39
  s_cselect_b32 s34, s40, s34
  s_cmp_ge_u32 s37, s41
  s_cselect_b32 s34, s45, s34
  v_mfma_f32_32x32x16_bf16 a[16:31], v[196:199], v[104:107], a[16:31]
  ds_read_b64_tr_b16 v[184:185], v10 offset:49152
  ds_read_b64_tr_b16 v[186:187], v10 offset:53248
  s_add_u32 s36, s35, 0x1000
  s_add_u32 m0, s44, 65536
  s_nop 0
  buffer_load_dwordx4 v22, s[12:15], s35 offen offset:0 lds
  s_waitcnt lgkmcnt(10)
  v_mfma_f32_32x32x16_bf16 a[32:47], v[160:163], v[104:107], a[32:47]
  ds_read_b64_tr_b16 v[188:189], v11 offset:49152
  ds_read_b64_tr_b16 v[190:191], v11 offset:53248
  buffer_load_dwordx4 v23, s[12:15], s35 offen offset:1024 lds
  v_mfma_f32_32x32x16_bf16 a[48:63], v[164:167], v[104:107], a[48:63]
  ds_read_b64_tr_b16 v[192:193], v12 offset:49152
  v_exp_f32 v113, v113
  ds_read_b64_tr_b16 v[194:195], v12 offset:53248
  buffer_load_dwordx4 v22, s[12:15], s35 offen offset:2048 lds
  s_waitcnt lgkmcnt(10)
  v_mfma_f32_32x32x16_bf16 a[64:79], v[168:171], v[104:107], a[64:79]
  ds_read_b64_tr_b16 v[196:197], v13 offset:49152
  v_fma_f32 v115, v115, s30, -v29
  ds_read_b64_tr_b16 v[198:199], v13 offset:53248
  buffer_load_dwordx4 v23, s[12:15], s35 offen offset:3072 lds
  v_mfma_f32_32x32x16_bf16 a[80:95], v[172:175], v[104:107], a[80:95]
  ds_read_b64_tr_b16 v[160:161], v10 offset:49408
  v_exp_f32 v114, v114
  ds_read_b64_tr_b16 v[162:163], v10 offset:53504
  v_add_f32 v30, v30, v112
  s_add_u32 m0, s44, 69632
  s_nop 0
  buffer_load_dwordx4 v22, s[12:15], s36 offen offset:0 lds
  v_fma_f32 v116, v116, s30, -v29
  v_exp_f32 v115, v115
  v_add_f32 v31, v31, v113
  v_cvt_pk_bf16_f32 v112, v112, v113
  v_fma_f32 v117, v117, s30, -v29
  v_exp_f32 v116, v116
  v_add_f32 v32, v32, v114
  v_fma_f32 v118, v118, s30, -v29
  v_exp_f32 v117, v117
  v_add_f32 v33, v33, v115
  v_cvt_pk_bf16_f32 v113, v114, v115
  v_fma_f32 v119, v119, s30, -v29
  v_exp_f32 v118, v118
  v_add_f32 v30, v30, v116
  v_fma_f32 v120, v120, s30, -v29
  v_exp_f32 v119, v119
  v_add_f32 v31, v31, v117
  v_cvt_pk_bf16_f32 v114, v116, v117
  v_fma_f32 v121, v121, s30, -v29
  v_exp_f32 v120, v120
  v_add_f32 v32, v32, v118
  v_fma_f32 v122, v122, s30, -v29
  v_exp_f32 v121, v121
  v_add_f32 v33, v33, v119
  v_cvt_pk_bf16_f32 v115, v118, v119
  s_waitcnt lgkmcnt(10)
  v_mfma_f32_32x32x16_bf16 a[96:111], v[176:179], v[104:107], a[96:111]
  ds_read_b64_tr_b16 v[164:165], v11 offset:49408
  ds_read_b64_tr_b16 v[166:167], v11 offset:53504
  buffer_load_dwordx4 v23, s[12:15], s36 offen offset:1024 lds
  v_mfma_f32_32x32x16_bf16 a[112:127], v[180:183], v[104:107], a[112:127]
  ds_read_b64_tr_b16 v[168:169], v12 offset:49408
  ds_read_b64_tr_b16 v[170:171], v12 offset:53504
  buffer_load_dwordx4 v22, s[12:15], s36 offen offset:2048 lds
  s_waitcnt lgkmcnt(10)
  v_mfma_f32_32x32x16_bf16 a[0:15], v[184:187], v[112:115], a[0:15]
  ds_read_b64_tr_b16 v[172:173], v13 offset:49408
  ds_read_b64_tr_b16 v[174:175], v13 offset:53504
  buffer_load_dwordx4 v23, s[12:15], s36 offen offset:3072 lds
  v_mfma_f32_32x32x16_bf16 a[16:31], v[188:191], v[112:115], a[16:31]
  ds_read_b64_tr_b16 v[176:177], v10 offset:57344
  ds_read_b64_tr_b16 v[178:179], v10 offset:61440
  s_add_u32 s38, s38, 1
  s_add_u32 s35, s35, 0x8000
  s_cmp_eq_u32 s38, s39
  s_cselect_b32 s35, s40, s35
  s_cmp_ge_u32 s38, s41
  s_cselect_b32 s35, s45, s35
  s_waitcnt lgkmcnt(10)
  v_mfma_f32_32x32x16_bf16 a[32:47], v[192:195], v[112:115], a[32:47]
  ds_read_b64_tr_b16 v[180:181], v11 offset:57344
  ds_read_b64_tr_b16 v[182:183], v11 offset:61440
  buffer_load_dword v49, v48, s[68:71], s76 offen
  v_mfma_f32_32x32x16_bf16 a[48:63], v[196:199], v[112:115], a[48:63]
  ds_read_b64_tr_b16 v[184:185], v12 offset:57344
  ds_read_b64_tr_b16 v[186:187], v12 offset:61440
  buffer_load_dword v49, v48, s[72:75], s77 offen
  s_waitcnt lgkmcnt(10)
  v_mfma_f32_32x32x16_bf16 a[64:79], v[160:163], v[112:115], a[64:79]
  ds_read_b64_tr_b16 v[188:189], v13 offset:57344
  ds_read_b64_tr_b16 v[190:191], v13 offset:61440
  v_mfma_f32_32x32x16_bf16 a[80:95], v[164:167], v[112:115], a[80:95]
  ds_read_b64_tr_b16 v[192:193], v10 offset:57600
  v_fma_f32 v123, v123, s30, -v29
  ds_read_b64_tr_b16 v[194:195], v10 offset:61696
  v_exp_f32 v122, v122
  v_add_f32 v30, v30, v120
  v_fma_f32 v124, v124, s30, -v29
  v_exp_f32 v123, v123
  v_add_f32 v31, v31, v121
  v_cvt_pk_bf16_f32 v120, v120, v121
  v_fma_f32 v125, v125, s30, -v29
  v_exp_f32 v124, v124
  v_add_f32 v32, v32, v122
  v_fma_f32 v126, v126, s30, -v29
  v_exp_f32 v125, v125
  v_add_f32 v33, v33, v123
  v_cvt_pk_bf16_f32 v121, v122, v123
  v_fma_f32 v127, v127, s30, -v29
  v_exp_f32 v126, v126
  v_add_f32 v30, v30, v124
  v_exp_f32 v127, v127
  v_add_f32 v31, v31, v125
  v_cvt_pk_bf16_f32 v122, v124, v125
  v_add_f32 v32, v32, v126
  v_add_f32 v33, v33, v127
  v_cvt_pk_bf16_f32 v123, v126, v127
  s_waitcnt lgkmcnt(10)
  v_mfma_f32_32x32x16_bf16 a[96:111], v[168:171], v[112:115], a[96:111]
  ds_read_b64_tr_b16 v[196:197], v11 offset:57600
  ds_read_b64_tr_b16 v[198:199], v11 offset:61696
  v_mfma_f32_32x32x16_bf16 a[112:127], v[172:175], v[112:115], a[112:127]
  ds_read_b64_tr_b16 v[160:161], v12 offset:57600
  ds_read_b64_tr_b16 v[162:163], v12 offset:61696
  s_waitcnt lgkmcnt(10)
  v_mfma_f32_32x32x16_bf16 a[0:15], v[176:179], v[120:123], a[0:15]
  ds_read_b64_tr_b16 v[164:165], v13 offset:57600
  ds_read_b64_tr_b16 v[166:167], v13 offset:61696
  v_mfma_f32_32x32x16_bf16 a[16:31], v[180:183], v[120:123], a[16:31]
  s_waitcnt vmcnt(2) lgkmcnt(0)
  s_barrier
  s_cmp_lg_u32 s43, 0
  s_cbranch_scc0 L_ret_28
  s_call_b64 s[96:97], L_hook
L_ret_28:
  v_mfma_f32_32x32x16_bf16 a[32:47], v[184:187], v[120:123], a[32:47]
  v_mfma_f32_32x32x16_bf16 a[48:63], v[188:191], v[120:123], a[48:63]
  v_mfma_f32_32x32x16_bf16 a[64:79], v[192:195], v[120:123], a[64:79]
  v_mfma_f32_32x32x16_bf16 a[80:95], v[196:199], v[120:123], a[80:95]
  v_mfma_f32_32x32x16_bf16 a[96:111], v[160:163], v[120:123], a[96:111]
  v_mfma_f32_32x32x16_bf16 a[112:127], v[164:167], v[120:123], a[112:127]
L_epi:
  s_nop 15
  s_nop 15
  v_add_f32 v30, v30, v31
  v_add_f32 v32, v32, v33
  v_add_f32 v30, v30, v32
  s_cmp_eq_u32 s48, 1
  s_cbranch_scc1 L_final
  s_cmp_eq_u32 s48, 2
  s_cbranch_scc1 L_merge
  s_lshl_b32 s53, s28, 9
  s_add_u32 s53, s53, s46
  s_add_u32 s53, s53, 0x20000
  v_lshlrev_b32 v39, 3, v1
  v_mov_b32 v40, v27
  v_mov_b32 v41, v30
  buffer_store_dwordx2 v[40:41], v39, s[20:23], s53 offen sc1
  v_accvgpr_read_b32 v64, a0
  v_accvgpr_read_b32 v65, a1
  v_accvgpr_read_b32 v66, a2
  v_accvgpr_read_b32 v67, a3
  v_accvgpr_read_b32 v68, a4
  v_accvgpr_read_b32 v69, a5
  v_accvgpr_read_b32 v70, a6
  v_accvgpr_read_b32 v71, a7
  v_accvgpr_read_b32 v72, a8
  v_accvgpr_read_b32 v73, a9
  v_accvgpr_read_b32 v74, a10
  v_accvgpr_read_b32 v75, a11
  v_accvgpr_read_b32 v76, a12
  v_accvgpr_read_b32 v77, a13
  v_accvgpr_read_b32 v78, a14
  v_accvgpr_read_b32 v79, a15
  v_cvt_pk_bf16_f32 v200, v64, v65
  v_cvt_pk_bf16_f32 v201, v66, v67
  v_cvt_pk_bf16_f32 v202, v68, v69
  v_cvt_pk_bf16_f32 v203, v70, v71
  v_accvgpr_read_b32 v80, a16
  v_accvgpr_read_b32 v81, a17
  v_accvgpr_read_b32 v82, a18
  v_accvgpr_read_b32 v83, a19
  v_accvgpr_read_b32 v84, a20
  v_accvgpr_read_b32 v85, a21
  v_accvgpr_read_b32 v86, a22
  v_accvgpr_read_b32 v87, a23
  v_cvt_pk_bf16_f32 v204, v72, v73
  v_cvt_pk_bf16_f32 v205, v74, v75
  v_cvt_pk_bf16_f32 v206, v76, v77
  v_cvt_pk_bf16_f32 v207, v78, v79
  v_accvgpr_read_b32 v88, a24
  v_accvgpr_read_b32 v89, a25
  v_accvgpr_read_b32 v90, a26
  v_accvgpr_read_b32 v91, a27
  v_accvgpr_read_b32 v92, a28
  v_accvgpr_read_b32 v93, a29
  v_accvgpr_read_b32 v94, a30
  v_accvgpr_read_b32 v95, a31
  v_cvt_pk_bf16_f32 v208, v80, v81
  v_cvt_pk_bf16_f32 v209, v82, v83
  v_cvt_pk_bf16_f32 v210, v84, v85
  v_cvt_pk_bf16_f32 v211, v86, v87
  v_accvgpr_read_b32 v64, a32
  v_accvgpr_read_b32 v65, a33
  v_accvgpr_read_b32 v66, a34
  v_accvgpr_read_b32 v67, a35
  v_accvgpr_read_b32 v68, a36
  v_accvgpr_read_b32 v69, a37
  v_accvgpr_read_b32 v70, a38
  v_accvgpr_read_b32 v71, a39
  v_cvt_pk_bf16_f32 v212, v88, v89
  v_cvt_pk_bf16_f32 v213, v90, v91
  v_cvt_pk_bf16_f32 v214, v92, v93
  v_cvt_pk_bf16_f32 v215, v94, v95
  v_accvgpr_read_b32 v72, a40
  v_accvgpr_read_b32 v73, a41
  v_accvgpr_read_b32 v74, a42
  v_accvgpr_read_b32 v75, a43
  v_accvgpr_read_b32 v76, a44
  v_accvgpr_read_b32 v77, a45
  v_accvgpr_read_b32 v78, a46
  v_accvgpr_read_b32 v79, a47
  v_cvt_pk_bf16_f32 v216, v64, v65
  v_cvt_pk_bf16_f32 v217, v66, v67
  v_cvt_pk_bf16_f32 v218, v68, v69
  v_cvt_pk_bf16_f32 v219, v70, v71
  v_accvgpr_read_b32 v80, a48
  v_accvgpr_read_b32 v81, a49
  v_accvgpr_read_b32 v82, a50
  v_accvgpr_read_b32 v83, a51
  v_accvgpr_read_b32 v84, a52
  v_accvgpr_read_b32 v85, a53
  v_accvgpr_read_b32 v86, a54
  v_accvgpr_read_b32 v87, a55
  v_cvt_pk_bf16_f32 v220, v72, v73
  v_cvt_pk_bf16_f32 v221, v74, v75
  v_cvt_pk_bf16_f32 v222, v76, v77
  v_cvt_pk_bf16_f32 v223, v78, v79
  v_accvgpr_read_b32 v88, a56
  v_accvgpr_read_b32 v89, a57
  v_accvgpr_read_b32 v90, a58
  v_accvgpr_read_b32 v91, a59
  v_accvgpr_read_b32 v92, a60
  v_accvgpr_read_b32 v93, a61
  v_accvgpr_read_b32 v94, a62
  v_accvgpr_read_b32 v95, a63
  v_cvt_pk_bf16_f32 v224, v80, v81
  v_cvt_pk_bf16_f32 v225, v82, v83
  v_cvt_pk_bf16_f32 v226, v84, v85
  v_cvt_pk_bf16_f32 v227, v86, v87
  v_accvgpr_read_b32 v64, a64
  v_accvgpr_read_b32 v65, a65
  v_accvgpr_read_b32 v66, a66
  v_accvgpr_read_b32 v67, a67
  v_accvgpr_read_b32 v68, a68
  v_accvgpr_read_b32 v69, a69
  v_accvgpr_read_b32 v70, a70
  v_accvgpr_read_b32 v71, a71
  v_cvt_pk_bf16_f32 v228, v88, v89
  v_cvt_pk_bf16_f32 v229, v90, v91
  v_cvt_pk_bf16_f32 v230, v92, v93
  v_cvt_pk_bf16_f32 v231, v94, v95
  v_accvgpr_read_b32 v72, a72
  v_accvgpr_read_b32 v73, a73
  v_accvgpr_read_b32 v74, a74
  v_accvgpr_read_b32 v75, a75
  v_accvgpr_read_b32 v76, a76
  v_accvgpr_read_b32 v77, a77
  v_accvgpr_read_b32 v78, a78
  v_accvgpr_read_b32 v79, a79
  v_cvt_pk_bf16_f32 v232, v64, v65
  v_cvt_pk_bf16_f32 v233, v66, v67
  v_cvt_pk_bf16_f32 v234, v68, v69
  v_cvt_pk_bf16_f32 v235, v70, v71
  v_accvgpr_read_b32 v80, a80
  v_accvgpr_read_b32 v81, a81
  v_accvgpr_read_b32 v82, a82
  v_accvgpr_read_b32 v83, a83
  v_accvgpr_read_b32 v84, a84
  v_accvgpr_read_b32 v85, a85
  v_accvgpr_read_b32 v86, a86
  v_accvgpr_read_b32 v87, a87
  v_cvt_pk_bf16_f32 v236, v72, v73
  v_cvt_pk_bf16_f32 v237, v74, v75
  v_cvt_pk_bf16_f32 v238, v76, v77
  v_cvt_pk_bf16_f32 v239, v78, v79
  v_accvgpr_read_b32 v88, a88
  v_accvgpr_read_b32 v89, a89
  v_accvgpr_read_b32 v90, a90
  v_accvgpr_read_b32 v91, a91
  v_accvgpr_read_b32 v92, a92
  v_accvgpr_read_b32 v93, a93
  v_accvgpr_read_b32 v94, a94
  v_accvgpr_read_b32 v95, a95
  v_cvt_pk_bf16_f32 v240, v80, v81
  v_cvt_pk_bf16_f32 v241, v82, v83
  v_cvt_pk_bf16_f32 v242, v84, v85
  v_cvt_pk_bf16_f32 v243, v86, v87
  v_accvgpr_read_b32 v64, a96
  v_accvgpr_read_b32 v65, a97
  v_accvgpr_read_b32 v66, a98
  v_accvgpr_read_b32 v67, a99
  v_accvgpr_read_b32 v68, a100
  v_accvgpr_read_b32 v69, a101
  v_accvgpr_read_b32 v70, a102
  v_accvgpr_read_b32 v71, a103
  v_cvt_pk_bf16_f32 v244, v88, v89
  v_cvt_pk_bf16_f32 v245, v90, v91
  v_cvt_pk_bf16_f32 v246, v92, v93
  v_cvt_pk_bf16_f32 v247, v94, v95
  v_accvgpr_read_b32 v72, a104
  v_accvgpr_read_b32 v73, a105
  v_accvgpr_read_b32 v74, a106
  v_accvgpr_read_b32 v75, a107
  v_accvgpr_read_b32 v76, a108
  v_accvgpr_read_b32 v77, a109
  v_accvgpr_read_b32 v78, a110
  v_accvgpr_read_b32 v79, a111
  v_cvt_pk_bf16_f32 v248, v64, v65
  v_cvt_pk_bf16_f32 v249, v66, v67
  v_cvt_pk_bf16_f32 v250, v68, v69
  v_cvt_pk_bf16_f32 v251, v70, v71
  v_accvgpr_read_b32 v80, a112
  v_accvgpr_read_b32 v81, a113
  v_accvgpr_read_b32 v82, a114
  v_accvgpr_read_b32 v83, a115
  v_accvgpr_read_b32 v84, a116
  v_accvgpr_read_b32 v85, a117
  v_accvgpr_read_b32 v86, a118
  v_accvgpr_read_b32 v87, a119
  v_cvt_pk_bf16_f32 v252, v72, v73
  v_cvt_pk_bf16_f32 v253, v74, v75
  v_cvt_pk_bf16_f32 v254, v76, v77
  v_cvt_pk_bf16_f32 v255, v78, v79
  v_accvgpr_read_b32 v88, a120
  v_accvgpr_read_b32 v89, a121
  v_accvgpr_read_b32 v90, a122
  v_accvgpr_read_b32 v91, a123
  v_accvgpr_read_b32 v92, a124
  v_accvgpr_read_b32 v93, a125
  v_accvgpr_read_b32 v94, a126
  v_accvgpr_read_b32 v95, a127
  v_cvt_pk_bf16_f32 v50, v80, v81
  v_cvt_pk_bf16_f32 v51, v82, v83
  v_cvt_pk_bf16_f32 v52, v84, v85
  v_cvt_pk_bf16_f32 v53, v86, v87
  v_cvt_pk_bf16_f32 v54, v88, v89
  v_cvt_pk_bf16_f32 v55, v90, v91
  v_cvt_pk_bf16_f32 v56, v92, v93
  v_cvt_pk_bf16_f32 v57, v94, v95
  s_cmp_gt_u32 s64, 7
  s_cbranch_scc1 L_copy
  s_lshl_b32 s52, s28, 14
  s_add_u32 s52, s52, s46
  buffer_store_dwordx4 v[200:203], v25, s[20:23], s52 offen offset:0 sc1
  buffer_store_dwordx4 v[204:207], v25, s[20:23], s52 offen offset:1024 sc1
  buffer_store_dwordx4 v[208:211], v25, s[20:23], s52 offen offset:2048 sc1
  buffer_store_dwordx4 v[212:215], v25, s[20:23], s52 offen offset:3072 sc1
  s_add_u32 s52, s52, 0x1000
  buffer_store_dwordx4 v[216:219], v25, s[20:23], s52 offen offset:0 sc1
  buffer_store_dwordx4 v[220:223], v25, s[20:23], s52 offen offset:1024 sc1
  buffer_store_dwordx4 v[224:227], v25, s[20:23], s52 offen offset:2048 sc1
  buffer_store_dwordx4 v[228:231], v25, s[20:23], s52 offen offset:3072 sc1
  s_add_u32 s52, s52, 0x1000
  buffer_store_dwordx4 v[232:235], v25, s[20:23], s52 offen offset:0 sc1
  buffer_store_dwordx4 v[236:239], v25, s[20:23], s52 offen offset:1024 sc1
  buffer_store_dwordx4 v[240:243], v25, s[20:23], s52 offen offset:2048 sc1
  buffer_store_dwordx4 v[244:247], v25, s[20:23], s52 offen offset:3072 sc1
  s_add_u32 s52, s52, 0x1000
  buffer_store_dwordx4 v[248:251], v25, s[20:23], s52 offen offset:0 sc1
  buffer_store_dwordx4 v[252:255], v25, s[20:23], s52 offen offset:1024 sc1
  buffer_store_dwordx4 v[50:53], v25, s[20:23], s52 offen offset:2048 sc1
  buffer_store_dwordx4 v[54:57], v25, s[20:23], s52 offen offset:3072 sc1
  s_bitset1_b32 s43, 0
  s_branch L_sw2
L_copy:
  s_bitset1_b32 s43, 3
  s_mov_b32 s67, 0
L_sw2:
  s_mov_b32 s49, s64
  s_lshl_b32 s33, s64, 1
  s_add_u32 s50, s33, 2
  s_mov_b32 s32, 0
  s_mov_b32 s48, 1
  s_and_b32 s52, s39, 1
  s_cmp_eq_u32 s52, 1
  s_cbranch_scc1 L_pro1
  s_lshl_b32 s52, s49, 7
  s_lshl_b32 s53, s28, 5
  s_add_u32 s52, s52, s53
  v_and_b32 v36, 31, v1
  v_lshrrev_b32 v39, 5, v1
  v_lshlrev_b32 v39, 2, v39
  v_sub_u32 v36, v36, v39
  v_add_u32 v26, s52, v36
  v_mov_b32 v30, 0
  v_mov_b32 v31, 0
  v_mov_b32 v32, 0
  v_mov_b32 v33, 0
  s_mov_b32 s42, 0
  s_sub_u32 s31, s50, 1
  ds_read_b128 v[128:131], v2 offset:0
  ds_read_b128 v[132:135], v3 offset:0
  ds_read_b128 v[136:139], v4 offset:0
  ds_read_b128 v[140:143], v5 offset:0
  ds_read_b128 v[144:147], v6 offset:0
  ds_read_b128 v[148:151], v7 offset:0
  s_waitcnt lgkmcnt(4)
  v_mfma_f32_32x32x16_bf16 v[64:79], v[128:131], a[128:131], 0
  ds_read_b128 v[152:155], v8 offset:0
  v_accvgpr_write_b32 a0, 0
  v_accvgpr_write_b32 a1, 0
  v_accvgpr_write_b32 a2, 0
  v_accvgpr_write_b32 a3, 0
  v_mfma_f32_32x32x16_bf16 v[64:79], v[132:135], a[132:135], v[64:79]
  ds_read_b128 v[156:159], v9 offset:0
  v_accvgpr_write_b32 a4, 0
  v_accvgpr_write_b32 a5, 0
  v_accvgpr_write_b32 a6, 0
  v_accvgpr_write_b32 a7, 0
  s_waitcnt lgkmcnt(4)
  v_mfma_f32_32x32x16_bf16 v[64:79], v[136:139], a[136:139], v[64:79]
  ds_read_b128 v[128:131], v2 offset:256
  v_accvgpr_write_b32 a8, 0
  v_accvgpr_write_b32 a9, 0
  v_accvgpr_write_b32 a10, 0
  v_mfma_f32_32x32x16_bf16 v[64:79], v[140:143], a[140:143], v[64:79]
  ds_read_b128 v[132:135], v3 offset:256
  v_accvgpr_write_b32 a11, 0
  v_accvgpr_write_b32 a12, 0
  v_accvgpr_write_b32 a13, 0
  v_accvgpr_write_b32 a14, 0
  s_waitcnt lgkmcnt(4)
  v_mfma_f32_32x32x16_bf16 v[64:79], v[144:147], a[144:147], v[64:79]
  ds_read_b128 v[136:139], v4 offset:256
  v_accvgpr_write_b32 a15, 0
  v_accvgpr_write_b32 a16, 0
  v_accvgpr_write_b32 a17, 0
  v_accvgpr_write_b32 a18, 0
  v_mfma_f32_32x32x16_bf16 v[64:79], v[148:151], a[148:151], v[64:79]
  ds_read_b128 v[140:143], v5 offset:256
  v_accvgpr_write_b32 a19, 0
  v_accvgpr_write_b32 a20, 0
  v_accvgpr_write_b32 a21, 0
  v_accvgpr_write_b32 a22, 0
  s_waitcnt lgkmcnt(4)
  v_mfma_f32_32x32x16_bf16 v[64:79], v[152:155], a[152:155], v[64:79]
  ds_read_b128 v[144:147], v6 offset:256
  v_accvgpr_write_b32 a23, 0
  v_accvgpr_write_b32 a24, 0
  v_accvgpr_write_b32 a25, 0
  v_accvgpr_write_b32 a26, 0
  v_mfma_f32_32x32x16_bf16 v[64:79], v[156:159], a[156:159], v[64:79]
  ds_read_b128 v[148:151], v7 offset:256
  v_accvgpr_write_b32 a27, 0
  v_accvgpr_write_b32 a28, 0
  v_accvgpr_write_b32 a29, 0
  v_accvgpr_write_b32 a30, 0
  s_waitcnt lgkmcnt(4)
  v_mfma_f32_32x32x16_bf16 v[64:79], v[128:131], a[160:163], v[64:79]
  ds_read_b128 v[152:155], v8 offset:256
  v_accvgpr_write_b32 a31, 0
  v_accvgpr_write_b32 a32, 0
  v_accvgpr_write_b32 a33, 0
  v_mfma_f32_32x32x16_bf16 v[64:79], v[132:135], a[164:167], v[64:79]
  ds_read_b128 v[156:159], v9 offset:256
  v_accvgpr_write_b32 a34, 0
  v_accvgpr_write_b32 a35, 0
  v_accvgpr_write_b32 a36, 0
  v_accvgpr_write_b32 a37, 0
  s_waitcnt lgkmcnt(4)
  v_mfma_f32_32x32x16_bf16 v[64:79], v[136:139], a[168:171], v[64:79]
  ds_read_b128 v[128:131], v2 offset:16384
  v_accvgpr_write_b32 a38, 0
  v_accvgpr_write_b32 a39, 0
  v_accvgpr_write_b32 a40, 0
  v_accvgpr_write_b32 a41, 0
  v_mfma_f32_32x32x16_bf16 v[64:79], v[140:143], a[172:175], v[64:79]
  ds_read_b128 v[132:135], v3 offset:16384
  v_accvgpr_write_b32 a42, 0
  v_accvgpr_write_b32 a43, 0
  v_accvgpr_write_b32 a44, 0
  v_accvgpr_write_b32 a45, 0
  s_waitcnt lgkmcnt(4)
  v_mfma_f32_32x32x16_bf16 v[64:79], v[144:147], a[176:179], v[64:79]
  ds_read_b128 v[136:139], v4 offset:16384
  v_accvgpr_write_b32 a46, 0
  v_accvgpr_write_b32 a47, 0
  v_accvgpr_write_b32 a48, 0
  v_accvgpr_write_b32 a49, 0
  v_mfma_f32_32x32x16_bf16 v[64:79], v[148:151], a[180:183], v[64:79]
  ds_read_b128 v[140:143], v5 offset:16384
  v_accvgpr_write_b32 a50, 0
  v_accvgpr_write_b32 a51, 0
  v_accvgpr_write_b32 a52, 0
  s_waitcnt lgkmcnt(4)
  v_mfma_f32_32x32x16_bf16 v[64:79], v[152:155], a[184:187], v[64:79]
  ds_read_b128 v[144:147], v6 offset:16384
  v_accvgpr_write_b32 a53, 0
  v_accvgpr_write_b32 a54, 0
  v_accvgpr_write_b32 a55, 0
  v_accvgpr_write_b32 a56, 0
  v_mfma_f32_32x32x16_bf16 v[64:79], v[156:159], a[188:191], v[64:79]
  ds_read_b128 v[148:151], v7 offset:16384
  v_accvgpr_write_b32 a57, 0
  v_accvgpr_write_b32 a58, 0
  v_accvgpr_write_b32 a59, 0
  v_accvgpr_write_b32 a60, 0
  s_waitcnt lgkmcnt(4)
  v_mfma_f32_32x32x16_bf16 v[80:95], v[128:131], a[128:131], 0
  ds_read_b128 v[152:155], v8 offset:16384
  v_accvgpr_write_b32 a61, 0
  v_accvgpr_write_b32 a62, 0
  v_accvgpr_write_b32 a63, 0
  v_accvgpr_write_b32 a64, 0
  v_mfma_f32_32x32x16_bf16 v[80:95], v[132:135], a[132:135], v[80:95]
  ds_read_b128 v[156:159], v9 offset:16384
  v_accvgpr_write_b32 a65, 0
  v_accvgpr_write_b32 a66, 0
  v_accvgpr_write_b32 a67, 0
  v_accvgpr_write_b32 a68, 0
  s_waitcnt lgkmcnt(4)
  v_mfma_f32_32x32x16_bf16 v[80:95], v[136:139], a[136:139], v[80:95]
  ds_read_b128 v[128:131], v2 offset:16640
  v_accvgpr_write_b32 a69, 0
  v_accvgpr_write_b32 a70, 0
  v_accvgpr_write_b32 a71, 0
  v_mfma_f32_32x32x16_bf16 v[80:95], v[140:143], a[140:143], v[80:95]
  ds_read_b128 v[132:135], v3 offset:16640
  v_accvgpr_write_b32 a72, 0
  v_accvgpr_write_b32 a73, 0
  v_accvgpr_write_b32 a74, 0
  v_accvgpr_write_b32 a75, 0
  s_waitcnt lgkmcnt(4)
  v_mfma_f32_32x32x16_bf16 v[80:95], v[144:147], a[144:147], v[80:95]
  ds_read_b128 v[136:139], v4 offset:16640
  v_accvgpr_write_b32 a76, 0
  v_accvgpr_write_b32 a77, 0
  v_accvgpr_write_b32 a78, 0
  v_accvgpr_write_b32 a79, 0
  v_mfma_f32_32x32x16_bf16 v[80:95], v[148:151], a[148:151], v[80:95]
  ds_read_b128 v[140:143], v5 offset:16640
  v_accvgpr_write_b32 a80, 0
  v_accvgpr_write_b32 a81, 0
  v_accvgpr_write_b32 a82, 0
  v_accvgpr_write_b32 a83, 0
  s_waitcnt lgkmcnt(4)
  v_mfma_f32_32x32x16_bf16 v[80:95], v[152:155], a[152:155], v[80:95]
  ds_read_b128 v[144:147], v6 offset:16640
  v_accvgpr_write_b32 a84, 0
  v_accvgpr_write_b32 a85, 0
  v_accvgpr_write_b32 a86, 0
  v_accvgpr_write_b32 a87, 0
  v_mfma_f32_32x32x16_bf16 v[80:95], v[156:159], a[156:159], v[80:95]
  ds_read_b128 v[148:151], v7 offset:16640
  v_accvgpr_write_b32 a88, 0
  v_accvgpr_write_b32 a89, 0
  v_accvgpr_write_b32 a90, 0
  v_accvgpr_write_b32 a91, 0
  s_waitcnt lgkmcnt(4)
  v_mfma_f32_32x32x16_bf16 v[80:95], v[128:131], a[160:163], v[80:95]
  ds_read_b128 v[152:155], v8 offset:16640
  v_accvgpr_write_b32 a92, 0
  v_accvgpr_write_b32 a93, 0
  v_accvgpr_write_b32 a94, 0
  v_mfma_f32_32x32x16_bf16 v[80:95], v[132:135], a[164:167], v[80:95]
  ds_read_b128 v[156:159], v9 offset:16640
  v_accvgpr_write_b32 a95, 0
  v_accvgpr_write_b32 a96, 0
  v_accvgpr_write_b32 a97, 0
  v_accvgpr_write_b32 a98, 0
  s_waitcnt lgkmcnt(4)
  v_mfma_f32_32x32x16_bf16 v[80:95], v[136:139], a[168:171], v[80:95]
  v_accvgpr_write_b32 a99, 0
  v_accvgpr_write_b32 a100, 0
  v_accvgpr_write_b32 a101, 0
  v_accvgpr_write_b32 a102, 0
  v_accvgpr_write_b32 a103, 0
  v_mfma_f32_32x32x16_bf16 v[80:95], v[140:143], a[172:175], v[80:95]
  v_accvgpr_write_b32 a104, 0
  v_accvgpr_write_b32 a105, 0
  v_accvgpr_write_b32 a106, 0
  v_accvgpr_write_b32 a107, 0
  v_accvgpr_write_b32 a108, 0
  s_waitcnt lgkmcnt(2)
  v_mfma_f32_32x32x16_bf16 v[80:95], v[144:147], a[176:179], v[80:95]
  v_accvgpr_write_b32 a109, 0
  v_accvgpr_write_b32 a110, 0
  v_accvgpr_write_b32 a111, 0
  v_accvgpr_write_b32 a112, 0
  v_accvgpr_write_b32 a113, 0
  v_mfma_f32_32x32x16_bf16 v[80:95], v[148:151], a[180:183], v[80:95]
  v_accvgpr_write_b32 a114, 0
  v_accvgpr_write_b32 a115, 0
  v_accvgpr_write_b32 a116, 0
  v_accvgpr_write_b32 a117, 0
  s_waitcnt lgkmcnt(0)
  v_mfma_f32_32x32x16_bf16 v[80:95], v[152:155], a[184:187], v[80:95]
  v_accvgpr_write_b32 a118, 0
  v_accvgpr_write_b32 a119, 0
  v_accvgpr_write_b32 a120, 0
  v_accvgpr_write_b32 a121, 0
  v_accvgpr_write_b32 a122, 0
  v_mfma_f32_32x32x16_bf16 v[80:95], v[156:159], a[188:191], v[80:95]
  v_accvgpr_write_b32 a123, 0
  v_accvgpr_write_b32 a124, 0
  v_accvgpr_write_b32 a125, 0
  v_accvgpr_write_b32 a126, 0
  v_accvgpr_write_b32 a127, 0
  s_waitcnt vmcnt(0) lgkmcnt(0)
  s_barrier
  s_cmp_lg_u32 s43, 0
  s_cbranch_scc0 L_ret_35
  s_call_b64 s[96:97], L_hook
L_ret_35:
  ds_read_b128 v[128:131], v2 offset:32768
  ds_read_b128 v[132:135], v3 offset:32768
  ds_read_b128 v[136:139], v4 offset:32768
  ds_read_b128 v[140:143], v5 offset:32768
  ds_read_b128 v[144:147], v6 offset:32768
  ds_read_b128 v[148:151], v7 offset:32768
  s_nop 7
  s_cmp_ge_u32 s32, s33
  s_cbranch_scc1 L_mask0_36
L_ret_37:
  s_cmp_ge_u32 s32, s33
  s_cbranch_scc1 L_mask1_38
L_ret_39:
  v_max3_f32 v35, v64, v65, v66
  v_max3_f32 v35, v35, v67, v68
  v_max3_f32 v35, v35, v69, v70
  v_max3_f32 v35, v35, v71, v72
  v_max3_f32 v35, v35, v73, v74
  v_max3_f32 v35, v35, v75, v76
  v_max3_f32 v35, v35, v77, v78
  v_max_f32 v35, v35, v79
  v_max3_f32 v35, v35, v80, v81
  v_max3_f32 v35, v35, v82, v83
  v_max3_f32 v35, v35, v84, v85
  v_max3_f32 v35, v35, v86, v87
  v_max3_f32 v35, v35, v88, v89
  v_max3_f32 v35, v35, v90, v91
  v_max3_f32 v35, v35, v92, v93
  v_max3_f32 v35, v35, v94, v95
  v_mov_b32 v36, v35
  s_nop 1
  v_permlane32_swap_b32 v36, v35
  v_max_f32 v35, v35, v36
  v_mov_b32 v27, v35
  v_add_f32 v28, 0x42b17218, v35
  v_mul_f32 v29, s30, v35
  s_add_u32 s32, s32, 1
  v_fma_f32 v64, v64, s30, -v29
  v_fma_f32 v65, v65, s30, -v29
  v_exp_f32 v64, v64
  v_fma_f32 v66, v66, s30, -v29
  v_exp_f32 v65, v65
  v_fma_f32 v67, v67, s30, -v29
  v_exp_f32 v66, v66
  v_add_f32 v30, v30, v64
  v_fma_f32 v68, v68, s30, -v29
  v_exp_f32 v67, v67
  v_add_f32 v31, v31, v65
  v_cvt_pk_bf16_f32 v64, v64, v65
  v_fma_f32 v69, v69, s30, -v29
  v_exp_f32 v68, v68
  v_add_f32 v32, v32, v66
  v_fma_f32 v70, v70, s30, -v29
  v_exp_f32 v69, v69
  v_add_f32 v33, v33, v67
  v_cvt_pk_bf16_f32 v65, v66, v67
  v_fma_f32 v71, v71, s30, -v29
  v_exp_f32 v70, v70
  v_add_f32 v30, v30, v68
  v_fma_f32 v72, v72, s30, -v29
  v_exp_f32 v71, v71
  v_add_f32 v31, v31, v69
  v_cvt_pk_bf16_f32 v66, v68, v69
  v_fma_f32 v73, v73, s30, -v29
  v_exp_f32 v72, v72
  v_add_f32 v32, v32, v70
  v_fma_f32 v74, v74, s30, -v29
  v_exp_f32 v73, v73
  v_add_f32 v33, v33, v71
  v_cvt_pk_bf16_f32 v67, v70, v71
  v_fma_f32 v75, v75, s30, -v29
  v_exp_f32 v74, v74
  v_add_f32 v30, v30, v72
  v_fma_f32 v76, v76, s30, -v29
  v_exp_f32 v75, v75
  v_add_f32 v31, v31, v73
  v_cvt_pk_bf16_f32 v72, v72, v73
  v_fma_f32 v77, v77, s30, -v29
  v_exp_f32 v76, v76
  v_add_f32 v32, v32, v74
  v_fma_f32 v78, v78, s30, -v29
  v_exp_f32 v77, v77
  v_add_f32 v33, v33, v75
  v_cvt_pk_bf16_f32 v73, v74, v75
  v_fma_f32 v79, v79, s30, -v29
  v_exp_f32 v78, v78
  v_add_f32 v30, v30, v76
  v_exp_f32 v79, v79
  v_add_f32 v31, v31, v77
  v_cvt_pk_bf16_f32 v74, v76, v77
  v_add_f32 v32, v32, v78
  v_add_f32 v33, v33, v79
  v_cvt_pk_bf16_f32 v75, v78, v79
  s_branch L_after_pro0
L_pro1:
  s_lshl_b32 s52, s49, 7
  s_lshl_b32 s53, s28, 5
  s_add_u32 s52, s52, s53
  v_and_b32 v36, 31, v1
  v_lshrrev_b32 v39, 5, v1
  v_lshlrev_b32 v39, 2, v39
  v_sub_u32 v36, v36, v39
  v_add_u32 v26, s52, v36
  v_mov_b32 v30, 0
  v_mov_b32 v31, 0
  v_mov_b32 v32, 0
  v_mov_b32 v33, 0
  s_mov_b32 s42, 0
  s_sub_u32 s31, s50, 1
  ds_read_b128 v[128:131], v2 offset:32768
  ds_read_b128 v[132:135], v3 offset:32768
  ds_read_b128 v[136:139], v4 offset:32768
  ds_read_b128 v[140:143], v5 offset:32768
  ds_read_b128 v[144:147], v6 offset:32768
  ds_read_b128 v[148:151], v7 offset:32768
  s_waitcnt lgkmcnt(4)
  v_mfma_f32_32x32x16_bf16 v[96:111], v[128:131], a[128:131], 0
  ds_read_b128 v[152:155], v8 offset:32768
  v_accvgpr_write_b32 a0, 0
  v_accvgpr_write_b32 a1, 0
  v_accvgpr_write_b32 a2, 0
  v_accvgpr_write_b32 a3, 0
  v_mfma_f32_32x32x16_bf16 v[96:111], v[132:135], a[132:135], v[96:111]
  ds_read_b128 v[156:159], v9 offset:32768
  v_accvgpr_write_b32 a4, 0
  v_accvgpr_write_b32 a5, 0
  v_accvgpr_write_b32 a6, 0
  v_accvgpr_write_b32 a7, 0
  s_waitcnt lgkmcnt(4)
  v_mfma_f32_32x32x16_bf16 v[96:111], v[136:139], a[136:139], v[96:111]
  ds_read_b128 v[128:131], v2 offset:33024
  v_accvgpr_write_b32 a8, 0
  v_accvgpr_write_b32 a9, 0
  v_accvgpr_write_b32 a10, 0
  v_mfma_f32_32x32x16_bf16 v[96:111], v[140:143], a[140:143], v[96:111]
  ds_read_b128 v[132:135], v3 offset:33024
  v_accvgpr_write_b32 a11, 0
  v_accvgpr_write_b32 a12, 0
  v_accvgpr_write_b32 a13, 0
  v_accvgpr_write_b32 a14, 0
  s_waitcnt lgkmcnt(4)
  v_mfma_f32_32x32x16_bf16 v[96:111], v[144:147], a[144:147], v[96:111]
  ds_read_b128 v[136:139], v4 offset:33024
  v_accvgpr_write_b32 a15, 0
  v_accvgpr_write_b32 a16, 0
  v_accvgpr_write_b32 a17, 0
  v_accvgpr_write_b32 a18, 0
  v_mfma_f32_32x32x16_bf16 v[96:111], v[148:151], a[148:151], v[96:111]
  ds_read_b128 v[140:143], v5 offset:33024
  v_accvgpr_write_b32 a19, 0
  v_accvgpr_write_b32 a20, 0
  v_accvgpr_write_b32 a21, 0
  v_accvgpr_write_b32 a22, 0
  s_waitcnt lgkmcnt(4)
  v_mfma_f32_32x32x16_bf16 v[96:111], v[152:155], a[152:155], v[96:111]
  ds_read_b128 v[144:147], v6 offset:33024
  v_accvgpr_write_b32 a23, 0
  v_accvgpr_write_b32 a24, 0
  v_accvgpr_write_b32 a25, 0
  v_accvgpr_write_b32 a26, 0
  v_mfma_f32_32x32x16_bf16 v[96:111], v[156:159], a[156:159], v[96:111]
  ds_read_b128 v[148:151], v7 offset:33024
  v_accvgpr_write_b32 a27, 0
  v_accvgpr_write_b32 a28, 0
  v_accvgpr_write_b32 a29, 0
  v_accvgpr_write_b32 a30, 0
  s_waitcnt lgkmcnt(4)
  v_mfma_f32_32x32x16_bf16 v[96:111], v[128:131], a[160:163], v[96:111]
  ds_read_b128 v[152:155], v8 offset:33024
  v_accvgpr_write_b32 a31, 0
  v_accvgpr_write_b32 a32, 0
  v_accvgpr_write_b32 a33, 0
  v_mfma_f32_32x32x16_bf16 v[96:111], v[132:135], a[164:167], v[96:111]
  ds_read_b128 v[156:159], v9 offset:33024
  v_accvgpr_write_b32 a34, 0
  v_accvgpr_write_b32 a35, 0
  v_accvgpr_write_b32 a36, 0
  v_accvgpr_write_b32 a37, 0
  s_waitcnt lgkmcnt(4)
  v_mfma_f32_32x32x16_bf16 v[96:111], v[136:139], a[168:171], v[96:111]
  ds_read_b128 v[128:131], v2 offset:49152
  v_accvgpr_write_b32 a38, 0
  v_accvgpr_write_b32 a39, 0
  v_accvgpr_write_b32 a40, 0
  v_accvgpr_write_b32 a41, 0
  v_mfma_f32_32x32x16_bf16 v[96:111], v[140:143], a[172:175], v[96:111]
  ds_read_b128 v[132:135], v3 offset:49152
  v_accvgpr_write_b32 a42, 0
  v_accvgpr_write_b32 a43, 0
  v_accvgpr_write_b32 a44, 0
  v_accvgpr_write_b32 a45, 0
  s_waitcnt lgkmcnt(4)
  v_mfma_f32_32x32x16_bf16 v[96:111], v[144:147], a[176:179], v[96:111]
  ds_read_b128 v[136:139], v4 offset:49152
  v_accvgpr_write_b32 a46, 0
  v_accvgpr_write_b32 a47, 0
  v_accvgpr_write_b32 a48, 0
  v_accvgpr_write_b32 a49, 0
  v_mfma_f32_32x32x16_bf16 v[96:111], v[148:151], a[180:183], v[96:111]
  ds_read_b128 v[140:143], v5 offset:49152
  v_accvgpr_write_b32 a50, 0
  v_accvgpr_write_b32 a51, 0
  v_accvgpr_write_b32 a52, 0
  s_waitcnt lgkmcnt(4)
  v_mfma_f32_32x32x16_bf16 v[96:111], v[152:155], a[184:187], v[96:111]
  ds_read_b128 v[144:147], v6 offset:49152
  v_accvgpr_write_b32 a53, 0
  v_accvgpr_write_b32 a54, 0
  v_accvgpr_write_b32 a55, 0
  v_accvgpr_write_b32 a56, 0
  v_mfma_f32_32x32x16_bf16 v[96:111], v[156:159], a[188:191], v[96:111]
  ds_read_b128 v[148:151], v7 offset:49152
  v_accvgpr_write_b32 a57, 0
  v_accvgpr_write_b32 a58, 0
  v_accvgpr_write_b32 a59, 0
  v_accvgpr_write_b32 a60, 0
  s_waitcnt lgkmcnt(4)
  v_mfma_f32_32x32x16_bf16 v[112:127], v[128:131], a[128:131], 0
  ds_read_b128 v[152:155], v8 offset:49152
  v_accvgpr_write_b32 a61, 0
  v_accvgpr_write_b32 a62, 0
  v_accvgpr_write_b32 a63, 0
  v_accvgpr_write_b32 a64, 0
  v_mfma_f32_32x32x16_bf16 v[112:127], v[132:135], a[132:135], v[112:127]
  ds_read_b128 v[156:159], v9 offset:49152
  v_accvgpr_write_b32 a65, 0
  v_accvgpr_write_b32 a66, 0
  v_accvgpr_write_b32 a67, 0
  v_accvgpr_write_b32 a68, 0
  s_waitcnt lgkmcnt(4)
  v_mfma_f32_32x32x16_bf16 v[112:127], v[136:139], a[136:139], v[112:127]
  ds_read_b128 v[128:131], v2 offset:49408
  v_accvgpr_write_b32 a69, 0
  v_accvgpr_write_b32 a70, 0
  v_accvgpr_write_b32 a71, 0
  v_mfma_f32_32x32x16_bf16 v[112:127], v[140:143], a[140:143], v[112:127]
  ds_read_b128 v[132:135], v3 offset:49408
  v_accvgpr_write_b32 a72, 0
  v_accvgpr_write_b32 a73, 0
  v_accvgpr_write_b32 a74, 0
  v_accvgpr_write_b32 a75, 0
  s_waitcnt lgkmcnt(4)
  v_mfma_f32_32x32x16_bf16 v[112:127], v[144:147], a[144:147], v[112:127]
  ds_read_b128 v[136:139], v4 offset:49408
  v_accvgpr_write_b32 a76, 0
  v_accvgpr_write_b32 a77, 0
  v_accvgpr_write_b32 a78, 0
  v_accvgpr_write_b32 a79, 0
  v_mfma_f32_32x32x16_bf16 v[112:127], v[148:151], a[148:151], v[112:127]
  ds_read_b128 v[140:143], v5 offset:49408
  v_accvgpr_write_b32 a80, 0
  v_accvgpr_write_b32 a81, 0
  v_accvgpr_write_b32 a82, 0
  v_accvgpr_write_b32 a83, 0
  s_waitcnt lgkmcnt(4)
  v_mfma_f32_32x32x16_bf16 v[112:127], v[152:155], a[152:155], v[112:127]
  ds_read_b128 v[144:147], v6 offset:49408
  v_accvgpr_write_b32 a84, 0
  v_accvgpr_write_b32 a85, 0
  v_accvgpr_write_b32 a86, 0
  v_accvgpr_write_b32 a87, 0
  v_mfma_f32_32x32x16_bf16 v[112:127], v[156:159], a[156:159], v[112:127]
  ds_read_b128 v[148:151], v7 offset:49408
  v_accvgpr_write_b32 a88, 0
  v_accvgpr_write_b32 a89, 0
  v_accvgpr_write_b32 a90, 0
  v_accvgpr_write_b32 a91, 0
  s_waitcnt lgkmcnt(4)
  v_mfma_f32_32x32x16_bf16 v[112:127], v[128:131], a[160:163], v[112:127]
  ds_read_b128 v[152:155], v8 offset:49408
  v_accvgpr_write_b32 a92, 0
  v_accvgpr_write_b32 a93, 0
  v_accvgpr_write_b32 a94, 0
  v_mfma_f32_32x32x16_bf16 v[112:127], v[132:135], a[164:167], v[112:127]
  ds_read_b128 v[156:159], v9 offset:49408
  v_accvgpr_write_b32 a95, 0
  v_accvgpr_write_b32 a96, 0
  v_accvgpr_write_b32 a97, 0
  v_accvgpr_write_b32 a98, 0
  s_waitcnt lgkmcnt(4)
  v_mfma_f32_32x32x16_bf16 v[112:127], v[136:139], a[168:171], v[112:127]
  v_accvgpr_write_b32 a99, 0
  v_accvgpr_write_b32 a100, 0
  v_accvgpr_write_b32 a101, 0
  v_accvgpr_write_b32 a102, 0
  v_accvgpr_write_b32 a103, 0
  v_mfma_f32_32x32x16_bf16 v[112:127], v[140:143], a[172:175], v[112:127]
  v_accvgpr_write_b32 a104, 0
  v_accvgpr_write_b32 a105, 0
  v_accvgpr_write_b32 a106, 0
  v_accvgpr_write_b32 a107, 0
  v_accvgpr_write_b32 a108, 0
  s_waitcnt lgkmcnt(2)
  v_mfma_f32_32x32x16_bf16 v[112:127], v[144:147], a[176:179], v[112:127]
  v_accvgpr_write_b32 a109, 0
  v_accvgpr_write_b32 a110, 0
  v_accvgpr_write_b32 a111, 0
  v_accvgpr_write_b32 a112, 0
  v_accvgpr_write_b32 a113, 0
  v_mfma_f32_32x32x16_bf16 v[112:127], v[148:151], a[180:183], v[112:127]
  v_accvgpr_write_b32 a114, 0
  v_accvgpr_write_b32 a115, 0
  v_accvgpr_write_b32 a116, 0
  v_accvgpr_write_b32 a117, 0
  s_waitcnt lgkmcnt(0)
  v_mfma_f32_32x32x16_bf16 v[112:127], v[152:155], a[184:187], v[112:127]
  v_accvgpr_write_b32 a118, 0
  v_accvgpr_write_b32 a119, 0
  v_accvgpr_write_b32 a120, 0
  v_accvgpr_write_b32 a121, 0
  v_accvgpr_write_b32 a122, 0
  v_mfma_f32_32x32x16_bf16 v[112:127], v[156:159], a[188:191], v[112:127]
  v_accvgpr_write_b32 a123, 0
  v_accvgpr_write_b32 a124, 0
  v_accvgpr_write_b32 a125, 0
  v_accvgpr_write_b32 a126, 0
  v_accvgpr_write_b32 a127, 0
  s_waitcnt vmcnt(0) lgkmcnt(0)
  s_barrier
  s_cmp_lg_u32 s43, 0
  s_cbranch_scc0 L_ret_40
  s_call_b64 s[96:97], L_hook
L_ret_40:
  ds_read_b128 v[128:131], v2 offset:0
  ds_read_b128 v[132:135], v3 offset:0
  ds_read_b128 v[136:139], v4 offset:0
  ds_read_b128 v[140:143], v5 offset:0
  ds_read_b128 v[144:147], v6 offset:0
  ds_read_b128 v[148:151], v7 offset:0
  s_nop 7
  s_cmp_ge_u32 s32, s33
  s_cbranch_scc1 L_mask0_41
L_ret_42:
  s_cmp_ge_u32 s32, s33
  s_cbranch_scc1 L_mask1_43
L_ret_44:
  v_max3_f32 v35, v96, v97, v98
  v_max3_f32 v35, v35, v99, v100
  v_max3_f32 v35, v35, v101, v102
  v_max3_f32 v35, v35, v103, v104
  v_max3_f32 v35, v35, v105, v106
  v_max3_f32 v35, v35, v107, v108
  v_max3_f32 v35, v35, v109, v110
  v_max_f32 v35, v35, v111
  v_max3_f32 v35, v35, v112, v113
  v_max3_f32 v35, v35, v114, v115
  v_max3_f32 v35, v35, v116, v117
  v_max3_f32 v35, v35, v118, v119
  v_max3_f32 v35, v35, v120, v121
  v_max3_f32 v35, v35, v122, v123
  v_max3_f32 v35, v35, v124, v125
  v_max3_f32 v35, v35, v126, v127
  v_mov_b32 v36, v35
  s_nop 1
  v_permlane32_swap_b32 v36, v35
  v_max_f32 v35, v35, v36
  v_mov_b32 v27, v35
  v_add_f32 v28, 0x42b17218, v35
  v_mul_f32 v29, s30, v35
  s_add_u32 s32, s32, 1
  v_fma_f32 v96, v96, s30, -v29
  v_fma_f32 v97, v97, s30, -v29
  v_exp_f32 v96, v96
  v_fma_f32 v98, v98, s30, -v29
  v_exp_f32 v97, v97
  v_fma_f32 v99, v99, s30, -v29
  v_exp_f32 v98, v98
  v_add_f32 v30, v30, v96
  v_fma_f32 v100, v100, s30, -v29
  v_exp_f32 v99, v99
  v_add_f32 v31, v31, v97
  v_cvt_pk_bf16_f32 v96, v96, v97
  v_fma_f32 v101, v101, s30, -v29
  v_exp_f32 v100, v100
  v_add_f32 v32, v32, v98
  v_fma_f32 v102, v102, s30, -v29
  v_exp_f32 v101, v101
  v_add_f32 v33, v33, v99
  v_cvt_pk_bf16_f32 v97, v98, v99
  v_fma_f32 v103, v103, s30, -v29
  v_exp_f32 v102, v102
  v_add_f32 v30, v30, v100
  v_fma_f32 v104, v104, s30, -v29
  v_exp_f32 v103, v103
  v_add_f32 v31, v31, v101
  v_cvt_pk_bf16_f32 v98, v100, v101
  v_fma_f32 v105, v105, s30, -v29
  v_exp_f32 v104, v104
  v_add_f32 v32, v32, v102
  v_fma_f32 v106, v106, s30, -v29
  v_exp_f32 v105, v105
  v_add_f32 v33, v33, v103
  v_cvt_pk_bf16_f32 v99, v102, v103
  v_fma_f32 v107, v107, s30, -v29
  v_exp_f32 v106, v106
  v_add_f32 v30, v30, v104
  v_fma_f32 v108, v108, s30, -v29
  v_exp_f32 v107, v107
  v_add_f32 v31, v31, v105
  v_cvt_pk_bf16_f32 v104, v104, v105
  v_fma_f32 v109, v109, s30, -v29
  v_exp_f32 v108, v108
  v_add_f32 v32, v32, v106
  v_fma_f32 v110, v110, s30, -v29
  v_exp_f32 v109, v109
  v_add_f32 v33, v33, v107
  v_cvt_pk_bf16_f32 v105, v106, v107
  v_fma_f32 v111, v111, s30, -v29
  v_exp_f32 v110, v110
  v_add_f32 v30, v30, v108
  v_exp_f32 v111, v111
  v_add_f32 v31, v31, v109
  v_cvt_pk_bf16_f32 v106, v108, v109
  v_add_f32 v32, v32, v110
  v_add_f32 v33, v33, v111
  v_cvt_pk_bf16_f32 v107, v110, v111
  s_branch L_after_pro1
L_final:
  s_and_b32 s43, s43, 9
  s_cbranch_scc0 L_final2
L_flushB:
  s_bitcmp1_b32 s43, 3
  s_cbranch_scc0 L_flushB2
  s_call_b64 s[96:97], L_hook
  s_bitset0_b32 s43, 0
  s_branch L_flushB
L_flushB2:
  s_waitcnt vmcnt(0)
  s_barrier
  s_mov_b32 s43, 1
  s_call_b64 s[96:97], L_hook
L_final2:
  v_mov_b32 v36, v30
  s_nop 1
  v_permlane32_swap_b32 v36, v30
  v_add_f32 v30, v30, v36
  v_rcp_f32 v44, v30
  s_nop 0
  v_mov_b32 v45, v44
  s_lshl_b32 s52, s49, 16
  s_add_u32 s52, s52, s29
  s_lshl_b32 s53, s28, 14
  s_add_u32 s52, s52, s53
  v_and_b32 v41, 31, v1
  v_lshrrev_b32 v42, 5, v1
  v_lshlrev_b32 v40, 9, v41
  v_lshl_add_u32 v40, v42, 3, v40
  v_add_u32 v40, s53, v40
  v_lshlrev_b32 v41, 4, v41
  v_and_b32 v43, 31, v1
  v_xor_b32 v43, v43, v42
  v_lshlrev_b32 v43, 4, v43
  v_lshl_add_u32 v43, v42, 9, v43
  v_add_u32 v43, s53, v43
  v_accvgpr_read_b32 v64, a0
  v_accvgpr_read_b32 v65, a1
  v_accvgpr_read_b32 v66, a2
  v_accvgpr_read_b32 v67, a3
  v_accvgpr_read_b32 v68, a4
  v_accvgpr_read_b32 v69, a5
  v_accvgpr_read_b32 v70, a6
  v_accvgpr_read_b32 v71, a7
  v_xor_b32 v76, 0x0, v41
  v_xor_b32 v77, 0x10, v41
  v_add_u32 v76, v76, v40
  v_add_u32 v77, v77, v40
  v_pk_mul_f32 v[64:65], v[64:65], v[44:45]
  v_accvgpr_read_b32 v96, a8
  v_pk_mul_f32 v[66:67], v[66:67], v[44:45]
  v_accvgpr_read_b32 v97, a9
  v_pk_mul_f32 v[68:69], v[68:69], v[44:45]
  v_accvgpr_read_b32 v98, a10
  v_pk_mul_f32 v[70:71], v[70:71], v[44:45]
  v_accvgpr_read_b32 v99, a11
  v_cvt_pk_bf16_f32 v72, v64, v65
  v_accvgpr_read_b32 v100, a12
  v_cvt_pk_bf16_f32 v73, v66, v67
  v_accvgpr_read_b32 v101, a13
  v_cvt_pk_bf16_f32 v74, v68, v69
  v_accvgpr_read_b32 v102, a14
  v_cvt_pk_bf16_f32 v75, v70, v71
  v_accvgpr_read_b32 v103, a15
  ds_write_b64 v76, v[72:73]
  v_xor_b32 v108, 0x20, v41
  ds_write_b64 v77, v[74:75]
  v_xor_b32 v109, 0x30, v41
  v_add_u32 v108, v108, v40
  v_add_u32 v109, v109, v40
  v_pk_mul_f32 v[96:97], v[96:97], v[44:45]
  v_accvgpr_read_b32 v64, a16
  v_pk_mul_f32 v[98:99], v[98:99], v[44:45]
  v_accvgpr_read_b32 v65, a17
  v_pk_mul_f32 v[100:101], v[100:101], v[44:45]
  v_accvgpr_read_b32 v66, a18
  v_pk_mul_f32 v[102:103], v[102:103], v[44:45]
  v_accvgpr_read_b32 v67, a19
  v_cvt_pk_bf16_f32 v104, v96, v97
  v_accvgpr_read_b32 v68, a20
  v_cvt_pk_bf16_f32 v105, v98, v99
  v_accvgpr_read_b32 v69, a21
  v_cvt_pk_bf16_f32 v106, v100, v101
  v_accvgpr_read_b32 v70, a22
  v_cvt_pk_bf16_f32 v107, v102, v103
  v_accvgpr_read_b32 v71, a23
  ds_write_b64 v108, v[104:105]
  v_xor_b32 v76, 0x40, v41
  ds_write_b64 v109, v[106:107]
  v_xor_b32 v77, 0x50, v41
  v_add_u32 v76, v76, v40
  v_add_u32 v77, v77, v40
  v_pk_mul_f32 v[64:65], v[64:65], v[44:45]
  v_accvgpr_read_b32 v96, a24
  v_pk_mul_f32 v[66:67], v[66:67], v[44:45]
  v_accvgpr_read_b32 v97, a25
  v_pk_mul_f32 v[68:69], v[68:69], v[44:45]
  v_accvgpr_read_b32 v98, a26
  v_pk_mul_f32 v[70:71], v[70:71], v[44:45]
  v_accvgpr_read_b32 v99, a27
  v_cvt_pk_bf16_f32 v72, v64, v65
  v_accvgpr_read_b32 v100, a28
  v_cvt_pk_bf16_f32 v73, v66, v67
  v_accvgpr_read_b32 v101, a29
  v_cvt_pk_bf16_f32 v74, v68, v69
  v_accvgpr_read_b32 v102, a30
  v_cvt_pk_bf16_f32 v75, v70, v71
  v_accvgpr_read_b32 v103, a31
  ds_write_b64 v76, v[72:73]
  v_xor_b32 v108, 0x60, v41
  ds_write_b64 v77, v[74:75]
  v_xor_b32 v109, 0x70, v41
  v_add_u32 v108, v108, v40
  v_add_u32 v109, v109, v40
  v_pk_mul_f32 v[96:97], v[96:97], v[44:45]
  v_accvgpr_read_b32 v64, a32
  v_pk_mul_f32 v[98:99], v[98:99], v[44:45]
  v_accvgpr_read_b32 v65, a33
  v_pk_mul_f32 v[100:101], v[100:101], v[44:45]
  v_accvgpr_read_b32 v66, a34
  v_pk_mul_f32 v[102:103], v[102:103], v[44:45]
  v_accvgpr_read_b32 v67, a35
  v_cvt_pk_bf16_f32 v104, v96, v97
  v_accvgpr_read_b32 v68, a36
  v_cvt_pk_bf16_f32 v105, v98, v99
  v_accvgpr_read_b32 v69, a37
  v_cvt_pk_bf16_f32 v106, v100, v101
  v_accvgpr_read_b32 v70, a38
  v_cvt_pk_bf16_f32 v107, v102, v103
  v_accvgpr_read_b32 v71, a39
  ds_write_b64 v108, v[104:105]
  v_xor_b32 v76, 0x80, v41
  ds_write_b64 v109, v[106:107]
  v_xor_b32 v77, 0x90, v41
  v_add_u32 v76, v76, v40
  v_add_u32 v77, v77, v40
  v_pk_mul_f32 v[64:65], v[64:65], v[44:45]
  v_accvgpr_read_b32 v96, a40
  v_pk_mul_f32 v[66:67], v[66:67], v[44:45]
  v_accvgpr_read_b32 v97, a41
  v_pk_mul_f32 v[68:69], v[68:69], v[44:45]
  v_accvgpr_read_b32 v98, a42
  v_pk_mul_f32 v[70:71], v[70:71], v[44:45]
  v_accvgpr_read_b32 v99, a43
  v_cvt_pk_bf16_f32 v72, v64, v65
  v_accvgpr_read_b32 v100, a44
  v_cvt_pk_bf16_f32 v73, v66, v67
  v_accvgpr_read_b32 v101, a45
  v_cvt_pk_bf16_f32 v74, v68, v69
  v_accvgpr_read_b32 v102, a46
  v_cvt_pk_bf16_f32 v75, v70, v71
  v_accvgpr_read_b32 v103, a47
  ds_write_b64 v76, v[72:73]
  v_xor_b32 v108, 0xa0, v41
  ds_write_b64 v77, v[74:75]
  v_xor_b32 v109, 0xb0, v41
  v_add_u32 v108, v108, v40
  v_add_u32 v109, v109, v40
  v_pk_mul_f32 v[96:97], v[96:97], v[44:45]
  v_accvgpr_read_b32 v64, a48
  v_pk_mul_f32 v[98:99], v[98:99], v[44:45]
  v_accvgpr_read_b32 v65, a49
  v_pk_mul_f32 v[100:101], v[100:101], v[44:45]
  v_accvgpr_read_b32 v66, a50
  v_pk_mul_f32 v[102:103], v[102:103], v[44:45]
  v_accvgpr_read_b32 v67, a51
  v_cvt_pk_bf16_f32 v104, v96, v97
  v_accvgpr_read_b32 v68, a52
  v_cvt_pk_bf16_f32 v105, v98, v99
  v_accvgpr_read_b32 v69, a53
  v_cvt_pk_bf16_f32 v106, v100, v101
  v_accvgpr_read_b32 v70, a54
  v_cvt_pk_bf16_f32 v107, v102, v103
  v_accvgpr_read_b32 v71, a55
  ds_write_b64 v108, v[104:105]
  v_xor_b32 v76, 0xc0, v41
  ds_write_b64 v109, v[106:107]
  v_xor_b32 v77, 0xd0, v41
  v_add_u32 v76, v76, v40
  v_add_u32 v77, v77, v40
  v_pk_mul_f32 v[64:65], v[64:65], v[44:45]
  v_accvgpr_read_b32 v96, a56
  v_pk_mul_f32 v[66:67], v[66:67], v[44:45]
  v_accvgpr_read_b32 v97, a57
  v_pk_mul_f32 v[68:69], v[68:69], v[44:45]
  v_accvgpr_read_b32 v98, a58
  v_pk_mul_f32 v[70:71], v[70:71], v[44:45]
  v_accvgpr_read_b32 v99, a59
  v_cvt_pk_bf16_f32 v72, v64, v65
  v_accvgpr_read_b32 v100, a60
  v_cvt_pk_bf16_f32 v73, v66, v67
  v_accvgpr_read_b32 v101, a61
  v_cvt_pk_bf16_f32 v74, v68, v69
  v_accvgpr_read_b32 v102, a62
  v_cvt_pk_bf16_f32 v75, v70, v71
  v_accvgpr_read_b32 v103, a63
  ds_write_b64 v76, v[72:73]
  v_xor_b32 v108, 0xe0, v41
  ds_write_b64 v77, v[74:75]
  v_xor_b32 v109, 0xf0, v41
  v_add_u32 v108, v108, v40
  v_add_u32 v109, v109, v40
  v_pk_mul_f32 v[96:97], v[96:97], v[44:45]
  v_accvgpr_read_b32 v64, a64
  v_pk_mul_f32 v[98:99], v[98:99], v[44:45]
  v_accvgpr_read_b32 v65, a65
  v_pk_mul_f32 v[100:101], v[100:101], v[44:45]
  v_accvgpr_read_b32 v66, a66
  v_pk_mul_f32 v[102:103], v[102:103], v[44:45]
  v_accvgpr_read_b32 v67, a67
  v_cvt_pk_bf16_f32 v104, v96, v97
  v_accvgpr_read_b32 v68, a68
  v_cvt_pk_bf16_f32 v105, v98, v99
  v_accvgpr_read_b32 v69, a69
  v_cvt_pk_bf16_f32 v106, v100, v101
  v_accvgpr_read_b32 v70, a70
  v_cvt_pk_bf16_f32 v107, v102, v103
  v_accvgpr_read_b32 v71, a71
  ds_write_b64 v108, v[104:105]
  v_xor_b32 v76, 0x100, v41
  ds_write_b64 v109, v[106:107]
  v_xor_b32 v77, 0x110, v41
  v_add_u32 v76, v76, v40
  v_add_u32 v77, v77, v40
  v_pk_mul_f32 v[64:65], v[64:65], v[44:45]
  v_accvgpr_read_b32 v96, a72
  v_pk_mul_f32 v[66:67], v[66:67], v[44:45]
  v_accvgpr_read_b32 v97, a73
  v_pk_mul_f32 v[68:69], v[68:69], v[44:45]
  v_accvgpr_read_b32 v98, a74
  v_pk_mul_f32 v[70:71], v[70:71], v[44:45]
  v_accvgpr_read_b32 v99, a75
  v_cvt_pk_bf16_f32 v72, v64, v65
  v_accvgpr_read_b32 v100, a76
  v_cvt_pk_bf16_f32 v73, v66, v67
  v_accvgpr_read_b32 v101, a77
  v_cvt_pk_bf16_f32 v74, v68, v69
  v_accvgpr_read_b32 v102, a78
  v_cvt_pk_bf16_f32 v75, v70, v71
  v_accvgpr_read_b32 v103, a79
  ds_write_b64 v76, v[72:73]
  v_xor_b32 v108, 0x120, v41
  ds_write_b64 v77, v[74:75]
  v_xor_b32 v109, 0x130, v41
  v_add_u32 v108, v108, v40
  v_add_u32 v109, v109, v40
  v_pk_mul_f32 v[96:97], v[96:97], v[44:45]
  v_accvgpr_read_b32 v64, a80
  v_pk_mul_f32 v[98:99], v[98:99], v[44:45]
  v_accvgpr_read_b32 v65, a81
  v_pk_mul_f32 v[100:101], v[100:101], v[44:45]
  v_accvgpr_read_b32 v66, a82
  v_pk_mul_f32 v[102:103], v[102:103], v[44:45]
  v_accvgpr_read_b32 v67, a83
  v_cvt_pk_bf16_f32 v104, v96, v97
  v_accvgpr_read_b32 v68, a84
  v_cvt_pk_bf16_f32 v105, v98, v99
  v_accvgpr_read_b32 v69, a85
  v_cvt_pk_bf16_f32 v106, v100, v101
  v_accvgpr_read_b32 v70, a86
  v_cvt_pk_bf16_f32 v107, v102, v103
  v_accvgpr_read_b32 v71, a87
  ds_write_b64 v108, v[104:105]
  v_xor_b32 v76, 0x140, v41
  ds_write_b64 v109, v[106:107]
  v_xor_b32 v77, 0x150, v41
  v_add_u32 v76, v76, v40
  v_add_u32 v77, v77, v40
  v_pk_mul_f32 v[64:65], v[64:65], v[44:45]
  v_accvgpr_read_b32 v96, a88
  v_pk_mul_f32 v[66:67], v[66:67], v[44:45]
  v_accvgpr_read_b32 v97, a89
  v_pk_mul_f32 v[68:69], v[68:69], v[44:45]
  v_accvgpr_read_b32 v98, a90
  v_pk_mul_f32 v[70:71], v[70:71], v[44:45]
  v_accvgpr_read_b32 v99, a91
  v_cvt_pk_bf16_f32 v72, v64, v65
  v_accvgpr_read_b32 v100, a92
  v_cvt_pk_bf16_f32 v73, v66, v67
  v_accvgpr_read_b32 v101, a93
  v_cvt_pk_bf16_f32 v74, v68, v69
  v_accvgpr_read_b32 v102, a94
  v_cvt_pk_bf16_f32 v75, v70, v71
  v_accvgpr_read_b32 v103, a95
  ds_write_b64 v76, v[72:73]
  v_xor_b32 v108, 0x160, v41
  ds_write_b64 v77, v[74:75]
  v_xor_b32 v109, 0x170, v41
  v_add_u32 v108, v108, v40
  v_add_u32 v109, v109, v40
  v_pk_mul_f32 v[96:97], v[96:97], v[44:45]
  v_accvgpr_read_b32 v64, a96
  v_pk_mul_f32 v[98:99], v[98:99], v[44:45]
  v_accvgpr_read_b32 v65, a97
  v_pk_mul_f32 v[100:101], v[100:101], v[44:45]
  v_accvgpr_read_b32 v66, a98
  v_pk_mul_f32 v[102:103], v[102:103], v[44:45]
  v_accvgpr_read_b32 v67, a99
  v_cvt_pk_bf16_f32 v104, v96, v97
  v_accvgpr_read_b32 v68, a100
  v_cvt_pk_bf16_f32 v105, v98, v99
  v_accvgpr_read_b32 v69, a101
  v_cvt_pk_bf16_f32 v106, v100, v101
  v_accvgpr_read_b32 v70, a102
  v_cvt_pk_bf16_f32 v107, v102, v103
  v_accvgpr_read_b32 v71, a103
  ds_write_b64 v108, v[104:105]
  v_xor_b32 v76, 0x180, v41
  ds_write_b64 v109, v[106:107]
  v_xor_b32 v77, 0x190, v41
  v_add_u32 v76, v76, v40
  v_add_u32 v77, v77, v40
  v_pk_mul_f32 v[64:65], v[64:65], v[44:45]
  v_accvgpr_read_b32 v96, a104
  v_pk_mul_f32 v[66:67], v[66:67], v[44:45]
  v_accvgpr_read_b32 v97, a105
  v_pk_mul_f32 v[68:69], v[68:69], v[44:45]
  v_accvgpr_read_b32 v98, a106
  v_pk_mul_f32 v[70:71], v[70:71], v[44:45]
  v_accvgpr_read_b32 v99, a107
  v_cvt_pk_bf16_f32 v72, v64, v65
  v_accvgpr_read_b32 v100, a108
  v_cvt_pk_bf16_f32 v73, v66, v67
  v_accvgpr_read_b32 v101, a109
  v_cvt_pk_bf16_f32 v74, v68, v69
  v_accvgpr_read_b32 v102, a110
  v_cvt_pk_bf16_f32 v75, v70, v71
  v_accvgpr_read_b32 v103, a111
  ds_write_b64 v76, v[72:73]
  v_xor_b32 v108, 0x1a0, v41
  ds_write_b64 v77, v[74:75]
  v_xor_b32 v109, 0x1b0, v41
  v_add_u32 v108, v108, v40
  v_add_u32 v109, v109, v40
  v_pk_mul_f32 v[96:97], v[96:97], v[44:45]
  v_accvgpr_read_b32 v64, a112
  v_pk_mul_f32 v[98:99], v[98:99], v[44:45]
  v_accvgpr_read_b32 v65, a113
  v_pk_mul_f32 v[100:101], v[100:101], v[44:45]
  v_accvgpr_read_b32 v66, a114
  v_pk_mul_f32 v[102:103], v[102:103], v[44:45]
  v_accvgpr_read_b32 v67, a115
  v_cvt_pk_bf16_f32 v104, v96, v97
  v_accvgpr_read_b32 v68, a116
  v_cvt_pk_bf16_f32 v105, v98, v99
  v_accvgpr_read_b32 v69, a117
  v_cvt_pk_bf16_f32 v106, v100, v101
  v_accvgpr_read_b32 v70, a118
  v_cvt_pk_bf16_f32 v107, v102, v103
  v_accvgpr_read_b32 v71, a119
  ds_write_b64 v108, v[104:105]
  v_xor_b32 v76, 0x1c0, v41
  ds_write_b64 v109, v[106:107]
  v_xor_b32 v77, 0x1d0, v41
  v_add_u32 v76, v76, v40
  v_add_u32 v77, v77, v40
  v_pk_mul_f32 v[64:65], v[64:65], v[44:45]
  v_accvgpr_read_b32 v96, a120
  v_pk_mul_f32 v[66:67], v[66:67], v[44:45]
  v_accvgpr_read_b32 v97, a121
  v_pk_mul_f32 v[68:69], v[68:69], v[44:45]
  v_accvgpr_read_b32 v98, a122
  v_pk_mul_f32 v[70:71], v[70:71], v[44:45]
  v_accvgpr_read_b32 v99, a123
  v_cvt_pk_bf16_f32 v72, v64, v65
  v_accvgpr_read_b32 v100, a124
  v_cvt_pk_bf16_f32 v73, v66, v67
  v_accvgpr_read_b32 v101, a125
  v_cvt_pk_bf16_f32 v74, v68, v69
  v_accvgpr_read_b32 v102, a126
  v_cvt_pk_bf16_f32 v75, v70, v71
  v_accvgpr_read_b32 v103, a127
  ds_write_b64 v76, v[72:73]
  v_xor_b32 v108, 0x1e0, v41
  ds_write_b64 v77, v[74:75]
  v_xor_b32 v109, 0x1f0, v41
  v_add_u32 v108, v108, v40
  v_add_u32 v109, v109, v40
  v_pk_mul_f32 v[96:97], v[96:97], v[44:45]
  v_pk_mul_f32 v[98:99], v[98:99], v[44:45]
  v_pk_mul_f32 v[100:101], v[100:101], v[44:45]
  v_pk_mul_f32 v[102:103], v[102:103], v[44:45]
  v_cvt_pk_bf16_f32 v104, v96, v97
  v_cvt_pk_bf16_f32 v105, v98, v99
  v_cvt_pk_bf16_f32 v106, v100, v101
  v_cvt_pk_bf16_f32 v107, v102, v103
  ds_write_b64 v108, v[104:105]
  ds_write_b64 v109, v[106:107]
  s_waitcnt lgkmcnt(0)
  v_xor_b32 v128, 0x0, v43
  ds_read_b128 v[64:67], v128 offset:0
  v_xor_b32 v129, 0x20, v43
  ds_read_b128 v[68:71], v129 offset:1024
  v_xor_b32 v130, 0x40, v43
  ds_read_b128 v[72:75], v130 offset:2048
  v_xor_b32 v131, 0x60, v43
  ds_read_b128 v[76:79], v131 offset:3072
  v_xor_b32 v132, 0x80, v43
  ds_read_b128 v[80:83], v132 offset:4096
  v_xor_b32 v133, 0xa0, v43
  ds_read_b128 v[84:87], v133 offset:5120
  v_xor_b32 v134, 0xc0, v43
  ds_read_b128 v[88:91], v134 offset:6144
  v_xor_b32 v135, 0xe0, v43
  ds_read_b128 v[92:95], v135 offset:7168
  v_xor_b32 v136, 0x100, v43
  ds_read_b128 v[96:99], v136 offset:8192
  v_xor_b32 v137, 0x120, v43
  ds_read_b128 v[100:103], v137 offset:9216
  v_xor_b32 v138, 0x140, v43
  ds_read_b128 v[104:107], v138 offset:10240
  v_xor_b32 v139, 0x160, v43
  ds_read_b128 v[108:111], v139 offset:11264
  v_xor_b32 v140, 0x180, v43
  ds_read_b128 v[112:115], v140 offset:12288
  v_xor_b32 v141, 0x1a0, v43
  ds_read_b128 v[116:119], v141 offset:13312
  v_xor_b32 v142, 0x1c0, v43
  ds_read_b128 v[120:123], v142 offset:14336
  v_xor_b32 v143, 0x1e0, v43
  ds_read_b128 v[124:127], v143 offset:15360
  s_waitcnt lgkmcnt(15)
  buffer_store_dwordx4 v[64:67], v25, s[16:19], s52 offen offset:0 sc1
  s_waitcnt lgkmcnt(14)
  buffer_store_dwordx4 v[68:71], v25, s[16:19], s52 offen offset:1024 sc1
  s_waitcnt lgkmcnt(13)
  buffer_store_dwordx4 v[72:75], v25, s[16:19], s52 offen offset:2048 sc1
  s_waitcnt lgkmcnt(12)
  buffer_store_dwordx4 v[76:79], v25, s[16:19], s52 offen offset:3072 sc1
  s_add_u32 s52, s52, 0x1000
  s_waitcnt lgkmcnt(11)
  buffer_store_dwordx4 v[80:83], v25, s[16:19], s52 offen offset:0 sc1
  s_waitcnt lgkmcnt(10)
  buffer_store_dwordx4 v[84:87], v25, s[16:19], s52 offen offset:1024 sc1
  s_waitcnt lgkmcnt(9)
  buffer_store_dwordx4 v[88:91], v25, s[16:19], s52 offen offset:2048 sc1
  s_waitcnt lgkmcnt(8)
  buffer_store_dwordx4 v[92:95], v25, s[16:19], s52 offen offset:3072 sc1
  s_add_u32 s52, s52, 0x1000
  s_waitcnt lgkmcnt(7)
  buffer_store_dwordx4 v[96:99], v25, s[16:19], s52 offen offset:0 sc1
  s_waitcnt lgkmcnt(6)
  buffer_store_dwordx4 v[100:103], v25, s[16:19], s52 offen offset:1024 sc1
  s_waitcnt lgkmcnt(5)
  buffer_store_dwordx4 v[104:107], v25, s[16:19], s52 offen offset:2048 sc1
  s_waitcnt lgkmcnt(4)
  buffer_store_dwordx4 v[108:111], v25, s[16:19], s52 offen offset:3072 sc1
  s_add_u32 s52, s52, 0x1000
  s_waitcnt lgkmcnt(3)
  buffer_store_dwordx4 v[112:115], v25, s[16:19], s52 offen offset:0 sc1
  s_waitcnt lgkmcnt(2)
  buffer_store_dwordx4 v[116:119], v25, s[16:19], s52 offen offset:1024 sc1
  s_waitcnt lgkmcnt(1)
  buffer_store_dwordx4 v[120:123], v25, s[16:19], s52 offen offset:2048 sc1
  s_waitcnt lgkmcnt(0)
  buffer_store_dwordx4 v[124:127], v25, s[16:19], s52 offen offset:3072 sc1
  s_endpgm
L_merge:
  s_cmp_eq_u32 s99, 0
  s_cselect_b32 s54, 4, 0
  s_or_b32 s43, s43, s54
  s_mov_b32 s54, 0x400000
L_flushA:
  s_and_b32 s43, s43, 0x14
  s_cbranch_scc0 L_have
  s_waitcnt vmcnt(0)
  s_call_b64 s[96:97], L_hook
  s_sub_u32 s54, s54, 1
  s_cmp_lg_u32 s54, 0
  s_cbranch_scc1 L_flushA
L_have:
  s_waitcnt vmcnt(0)
  v_max_f32 v36, v27, v58
  v_sub_f32 v27, v27, v36
  v_sub_f32 v58, v58, v36
  v_mul_f32 v27, s30, v27
  v_mul_f32 v58, s30, v58
  v_exp_f32 v27, v27
  v_exp_f32 v58, v58
  s_nop 0
  v_mul_f32 v30, v30, v27
  v_fma_f32 v30, v59, v58, v30
  v_mov_b32 v36, v30
  s_nop 1
  v_permlane32_swap_b32 v36, v30
  v_add_f32 v30, v30, v36
  v_rcp_f32 v30, v30
  s_nop 0
  v_mul_f32 v44, v27, v30
  v_mul_f32 v46, v58, v30
  v_mov_b32 v45, v44
  v_mov_b32 v47, v46
  s_lshl_b32 s52, s49, 16
  s_add_u32 s52, s52, s29
  s_lshl_b32 s53, s28, 14
  s_add_u32 s52, s52, s53
  v_and_b32 v41, 31, v1
  v_lshrrev_b32 v42, 5, v1
  v_lshlrev_b32 v40, 9, v41
  v_lshl_add_u32 v40, v42, 3, v40
  v_add_u32 v40, s53, v40
  v_lshlrev_b32 v41, 4, v41
  v_and_b32 v43, 31, v1
  v_xor_b32 v43, v43, v42
  v_lshlrev_b32 v43, 4, v43
  v_lshl_add_u32 v43, v42, 9, v43
  v_add_u32 v43, s53, v43
  v_accvgpr_read_b32 v64, a0
  v_accvgpr_read_b32 v65, a1
  v_accvgpr_read_b32 v66, a2
  v_accvgpr_read_b32 v67, a3
  v_accvgpr_read_b32 v68, a4
  v_accvgpr_read_b32 v69, a5
  v_accvgpr_read_b32 v70, a6
  v_accvgpr_read_b32 v71, a7
  v_lshlrev_b32 v80, 16, v200
  v_and_b32 v81, 0xffff0000, v200
  v_lshlrev_b32 v82, 16, v201
  v_and_b32 v83, 0xffff0000, v201
  v_lshlrev_b32 v84, 16, v202
  v_and_b32 v85, 0xffff0000, v202
  v_lshlrev_b32 v86, 16, v203
  v_and_b32 v87, 0xffff0000, v203
  v_xor_b32 v76, 0x0, v41
  v_xor_b32 v77, 0x10, v41
  v_add_u32 v76, v76, v40
  v_add_u32 v77, v77, v40
  v_pk_mul_f32 v[64:65], v[64:65], v[44:45]
  v_accvgpr_read_b32 v96, a8
  v_pk_mul_f32 v[66:67], v[66:67], v[44:45]
  v_accvgpr_read_b32 v97, a9
  v_pk_mul_f32 v[68:69], v[68:69], v[44:45]
  v_accvgpr_read_b32 v98, a10
  v_pk_mul_f32 v[70:71], v[70:71], v[44:45]
  v_accvgpr_read_b32 v99, a11
  v_pk_fma_f32 v[64:65], v[80:81], v[46:47], v[64:65]
  v_accvgpr_read_b32 v100, a12
  v_pk_fma_f32 v[66:67], v[82:83], v[46:47], v[66:67]
  v_accvgpr_read_b32 v101, a13
  v_pk_fma_f32 v[68:69], v[84:85], v[46:47], v[68:69]
  v_accvgpr_read_b32 v102, a14
  v_pk_fma_f32 v[70:71], v[86:87], v[46:47], v[70:71]
  v_accvgpr_read_b32 v103, a15
  v_cvt_pk_bf16_f32 v72, v64, v65
  v_lshlrev_b32 v112, 16, v204
  v_cvt_pk_bf16_f32 v73, v66, v67
  v_and_b32 v113, 0xffff0000, v204
  v_cvt_pk_bf16_f32 v74, v68, v69
  v_lshlrev_b32 v114, 16, v205
  v_cvt_pk_bf16_f32 v75, v70, v71
  v_and_b32 v115, 0xffff0000, v205
  ds_write_b64 v76, v[72:73]
  v_lshlrev_b32 v116, 16, v206
  ds_write_b64 v77, v[74:75]
  v_and_b32 v117, 0xffff0000, v206
  v_lshlrev_b32 v118, 16, v207
  v_and_b32 v119, 0xffff0000, v207
  v_xor_b32 v108, 0x20, v41
  v_xor_b32 v109, 0x30, v41
  v_add_u32 v108, v108, v40
  v_add_u32 v109, v109, v40
  v_pk_mul_f32 v[96:97], v[96:97], v[44:45]
  v_accvgpr_read_b32 v64, a16
  v_pk_mul_f32 v[98:99], v[98:99], v[44:45]
  v_accvgpr_read_b32 v65, a17
  v_pk_mul_f32 v[100:101], v[100:101], v[44:45]
  v_accvgpr_read_b32 v66, a18
  v_pk_mul_f32 v[102:103], v[102:103], v[44:45]
  v_accvgpr_read_b32 v67, a19
  v_pk_fma_f32 v[96:97], v[112:113], v[46:47], v[96:97]
  v_accvgpr_read_b32 v68, a20
  v_pk_fma_f32 v[98:99], v[114:115], v[46:47], v[98:99]
  v_accvgpr_read_b32 v69, a21
  v_pk_fma_f32 v[100:101], v[116:117], v[46:47], v[100:101]
  v_accvgpr_read_b32 v70, a22
  v_pk_fma_f32 v[102:103], v[118:119], v[46:47], v[102:103]
  v_accvgpr_read_b32 v71, a23
  v_cvt_pk_bf16_f32 v104, v96, v97
  v_lshlrev_b32 v80, 16, v208
  v_cvt_pk_bf16_f32 v105, v98, v99
  v_and_b32 v81, 0xffff0000, v208
  v_cvt_pk_bf16_f32 v106, v100, v101
  v_lshlrev_b32 v82, 16, v209
  v_cvt_pk_bf16_f32 v107, v102, v103
  v_and_b32 v83, 0xffff0000, v209
  ds_write_b64 v108, v[104:105]
  v_lshlrev_b32 v84, 16, v210
  ds_write_b64 v109, v[106:107]
  v_and_b32 v85, 0xffff0000, v210
  v_lshlrev_b32 v86, 16, v211
  v_and_b32 v87, 0xffff0000, v211
  v_xor_b32 v76, 0x40, v41
  v_xor_b32 v77, 0x50, v41
  v_add_u32 v76, v76, v40
  v_add_u32 v77, v77, v40
  v_pk_mul_f32 v[64:65], v[64:65], v[44:45]
  v_accvgpr_read_b32 v96, a24
  v_pk_mul_f32 v[66:67], v[66:67], v[44:45]
  v_accvgpr_read_b32 v97, a25
  v_pk_mul_f32 v[68:69], v[68:69], v[44:45]
  v_accvgpr_read_b32 v98, a26
  v_pk_mul_f32 v[70:71], v[70:71], v[44:45]
  v_accvgpr_read_b32 v99, a27
  v_pk_fma_f32 v[64:65], v[80:81], v[46:47], v[64:65]
  v_accvgpr_read_b32 v100, a28
  v_pk_fma_f32 v[66:67], v[82:83], v[46:47], v[66:67]
  v_accvgpr_read_b32 v101, a29
  v_pk_fma_f32 v[68:69], v[84:85], v[46:47], v[68:69]
  v_accvgpr_read_b32 v102, a30
  v_pk_fma_f32 v[70:71], v[86:87], v[46:47], v[70:71]
  v_accvgpr_read_b32 v103, a31
  v_cvt_pk_bf16_f32 v72, v64, v65
  v_lshlrev_b32 v112, 16, v212
  v_cvt_pk_bf16_f32 v73, v66, v67
  v_and_b32 v113, 0xffff0000, v212
  v_cvt_pk_bf16_f32 v74, v68, v69
  v_lshlrev_b32 v114, 16, v213
  v_cvt_pk_bf16_f32 v75, v70, v71
  v_and_b32 v115, 0xffff0000, v213
  ds_write_b64 v76, v[72:73]
  v_lshlrev_b32 v116, 16, v214
  ds_write_b64 v77, v[74:75]
  v_and_b32 v117, 0xffff0000, v214
  v_lshlrev_b32 v118, 16, v215
  v_and_b32 v119, 0xffff0000, v215
  v_xor_b32 v108, 0x60, v41
  v_xor_b32 v109, 0x70, v41
  v_add_u32 v108, v108, v40
  v_add_u32 v109, v109, v40
  v_pk_mul_f32 v[96:97], v[96:97], v[44:45]
  v_accvgpr_read_b32 v64, a32
  v_pk_mul_f32 v[98:99], v[98:99], v[44:45]
  v_accvgpr_read_b32 v65, a33
  v_pk_mul_f32 v[100:101], v[100:101], v[44:45]
  v_accvgpr_read_b32 v66, a34
  v_pk_mul_f32 v[102:103], v[102:103], v[44:45]
  v_accvgpr_read_b32 v67, a35
  v_pk_fma_f32 v[96:97], v[112:113], v[46:47], v[96:97]
  v_accvgpr_read_b32 v68, a36
  v_pk_fma_f32 v[98:99], v[114:115], v[46:47], v[98:99]
  v_accvgpr_read_b32 v69, a37
  v_pk_fma_f32 v[100:101], v[116:117], v[46:47], v[100:101]
  v_accvgpr_read_b32 v70, a38
  v_pk_fma_f32 v[102:103], v[118:119], v[46:47], v[102:103]
  v_accvgpr_read_b32 v71, a39
  v_cvt_pk_bf16_f32 v104, v96, v97
  v_lshlrev_b32 v80, 16, v216
  v_cvt_pk_bf16_f32 v105, v98, v99
  v_and_b32 v81, 0xffff0000, v216
  v_cvt_pk_bf16_f32 v106, v100, v101
  v_lshlrev_b32 v82, 16, v217
  v_cvt_pk_bf16_f32 v107, v102, v103
  v_and_b32 v83, 0xffff0000, v217
  ds_write_b64 v108, v[104:105]
  v_lshlrev_b32 v84, 16, v218
  ds_write_b64 v109, v[106:107]
  v_and_b32 v85, 0xffff0000, v218
  v_lshlrev_b32 v86, 16, v219
  v_and_b32 v87, 0xffff0000, v219
  v_xor_b32 v76, 0x80, v41
  v_xor_b32 v77, 0x90, v41
  v_add_u32 v76, v76, v40
  v_add_u32 v77, v77, v40
  v_pk_mul_f32 v[64:65], v[64:65], v[44:45]
  v_accvgpr_read_b32 v96, a40
  v_pk_mul_f32 v[66:67], v[66:67], v[44:45]
  v_accvgpr_read_b32 v97, a41
  v_pk_mul_f32 v[68:69], v[68:69], v[44:45]
  v_accvgpr_read_b32 v98, a42
  v_pk_mul_f32 v[70:71], v[70:71], v[44:45]
  v_accvgpr_read_b32 v99, a43
  v_pk_fma_f32 v[64:65], v[80:81], v[46:47], v[64:65]
  v_accvgpr_read_b32 v100, a44
  v_pk_fma_f32 v[66:67], v[82:83], v[46:47], v[66:67]
  v_accvgpr_read_b32 v101, a45
  v_pk_fma_f32 v[68:69], v[84:85], v[46:47], v[68:69]
  v_accvgpr_read_b32 v102, a46
  v_pk_fma_f32 v[70:71], v[86:87], v[46:47], v[70:71]
  v_accvgpr_read_b32 v103, a47
  v_cvt_pk_bf16_f32 v72, v64, v65
  v_lshlrev_b32 v112, 16, v220
  v_cvt_pk_bf16_f32 v73, v66, v67
  v_and_b32 v113, 0xffff0000, v220
  v_cvt_pk_bf16_f32 v74, v68, v69
  v_lshlrev_b32 v114, 16, v221
  v_cvt_pk_bf16_f32 v75, v70, v71
  v_and_b32 v115, 0xffff0000, v221
  ds_write_b64 v76, v[72:73]
  v_lshlrev_b32 v116, 16, v222
  ds_write_b64 v77, v[74:75]
  v_and_b32 v117, 0xffff0000, v222
  v_lshlrev_b32 v118, 16, v223
  v_and_b32 v119, 0xffff0000, v223
  v_xor_b32 v108, 0xa0, v41
  v_xor_b32 v109, 0xb0, v41
  v_add_u32 v108, v108, v40
  v_add_u32 v109, v109, v40
  v_pk_mul_f32 v[96:97], v[96:97], v[44:45]
  v_accvgpr_read_b32 v64, a48
  v_pk_mul_f32 v[98:99], v[98:99], v[44:45]
  v_accvgpr_read_b32 v65, a49
  v_pk_mul_f32 v[100:101], v[100:101], v[44:45]
  v_accvgpr_read_b32 v66, a50
  v_pk_mul_f32 v[102:103], v[102:103], v[44:45]
  v_accvgpr_read_b32 v67, a51
  v_pk_fma_f32 v[96:97], v[112:113], v[46:47], v[96:97]
  v_accvgpr_read_b32 v68, a52
  v_pk_fma_f32 v[98:99], v[114:115], v[46:47], v[98:99]
  v_accvgpr_read_b32 v69, a53
  v_pk_fma_f32 v[100:101], v[116:117], v[46:47], v[100:101]
  v_accvgpr_read_b32 v70, a54
  v_pk_fma_f32 v[102:103], v[118:119], v[46:47], v[102:103]
  v_accvgpr_read_b32 v71, a55
  v_cvt_pk_bf16_f32 v104, v96, v97
  v_lshlrev_b32 v80, 16, v224
  v_cvt_pk_bf16_f32 v105, v98, v99
  v_and_b32 v81, 0xffff0000, v224
  v_cvt_pk_bf16_f32 v106, v100, v101
  v_lshlrev_b32 v82, 16, v225
  v_cvt_pk_bf16_f32 v107, v102, v103
  v_and_b32 v83, 0xffff0000, v225
  ds_write_b64 v108, v[104:105]
  v_lshlrev_b32 v84, 16, v226
  ds_write_b64 v109, v[106:107]
  v_and_b32 v85, 0xffff0000, v226
  v_lshlrev_b32 v86, 16, v227
  v_and_b32 v87, 0xffff0000, v227
  v_xor_b32 v76, 0xc0, v41
  v_xor_b32 v77, 0xd0, v41
  v_add_u32 v76, v76, v40
  v_add_u32 v77, v77, v40
  v_pk_mul_f32 v[64:65], v[64:65], v[44:45]
  v_accvgpr_read_b32 v96, a56
  v_pk_mul_f32 v[66:67], v[66:67], v[44:45]
  v_accvgpr_read_b32 v97, a57
  v_pk_mul_f32 v[68:69], v[68:69], v[44:45]
  v_accvgpr_read_b32 v98, a58
  v_pk_mul_f32 v[70:71], v[70:71], v[44:45]
  v_accvgpr_read_b32 v99, a59
  v_pk_fma_f32 v[64:65], v[80:81], v[46:47], v[64:65]
  v_accvgpr_read_b32 v100, a60
  v_pk_fma_f32 v[66:67], v[82:83], v[46:47], v[66:67]
  v_accvgpr_read_b32 v101, a61
  v_pk_fma_f32 v[68:69], v[84:85], v[46:47], v[68:69]
  v_accvgpr_read_b32 v102, a62
  v_pk_fma_f32 v[70:71], v[86:87], v[46:47], v[70:71]
  v_accvgpr_read_b32 v103, a63
  v_cvt_pk_bf16_f32 v72, v64, v65
  v_lshlrev_b32 v112, 16, v228
  v_cvt_pk_bf16_f32 v73, v66, v67
  v_and_b32 v113, 0xffff0000, v228
  v_cvt_pk_bf16_f32 v74, v68, v69
  v_lshlrev_b32 v114, 16, v229
  v_cvt_pk_bf16_f32 v75, v70, v71
  v_and_b32 v115, 0xffff0000, v229
  ds_write_b64 v76, v[72:73]
  v_lshlrev_b32 v116, 16, v230
  ds_write_b64 v77, v[74:75]
  v_and_b32 v117, 0xffff0000, v230
  v_lshlrev_b32 v118, 16, v231
  v_and_b32 v119, 0xffff0000, v231
  v_xor_b32 v108, 0xe0, v41
  v_xor_b32 v109, 0xf0, v41
  v_add_u32 v108, v108, v40
  v_add_u32 v109, v109, v40
  v_pk_mul_f32 v[96:97], v[96:97], v[44:45]
  v_accvgpr_read_b32 v64, a64
  v_pk_mul_f32 v[98:99], v[98:99], v[44:45]
  v_accvgpr_read_b32 v65, a65
  v_pk_mul_f32 v[100:101], v[100:101], v[44:45]
  v_accvgpr_read_b32 v66, a66
  v_pk_mul_f32 v[102:103], v[102:103], v[44:45]
  v_accvgpr_read_b32 v67, a67
  v_pk_fma_f32 v[96:97], v[112:113], v[46:47], v[96:97]
  v_accvgpr_read_b32 v68, a68
  v_pk_fma_f32 v[98:99], v[114:115], v[46:47], v[98:99]
  v_accvgpr_read_b32 v69, a69
  v_pk_fma_f32 v[100:101], v[116:117], v[46:47], v[100:101]
  v_accvgpr_read_b32 v70, a70
  v_pk_fma_f32 v[102:103], v[118:119], v[46:47], v[102:103]
  v_accvgpr_read_b32 v71, a71
  v_cvt_pk_bf16_f32 v104, v96, v97
  v_lshlrev_b32 v80, 16, v232
  v_cvt_pk_bf16_f32 v105, v98, v99
  v_and_b32 v81, 0xffff0000, v232
  v_cvt_pk_bf16_f32 v106, v100, v101
  v_lshlrev_b32 v82, 16, v233
  v_cvt_pk_bf16_f32 v107, v102, v103
  v_and_b32 v83, 0xffff0000, v233
  ds_write_b64 v108, v[104:105]
  v_lshlrev_b32 v84, 16, v234
  ds_write_b64 v109, v[106:107]
  v_and_b32 v85, 0xffff0000, v234
  v_lshlrev_b32 v86, 16, v235
  v_and_b32 v87, 0xffff0000, v235
  v_xor_b32 v76, 0x100, v41
  v_xor_b32 v77, 0x110, v41
  v_add_u32 v76, v76, v40
  v_add_u32 v77, v77, v40
  v_pk_mul_f32 v[64:65], v[64:65], v[44:45]
  v_accvgpr_read_b32 v96, a72
  v_pk_mul_f32 v[66:67], v[66:67], v[44:45]
  v_accvgpr_read_b32 v97, a73
  v_pk_mul_f32 v[68:69], v[68:69], v[44:45]
  v_accvgpr_read_b32 v98, a74
  v_pk_mul_f32 v[70:71], v[70:71], v[44:45]
  v_accvgpr_read_b32 v99, a75
  v_pk_fma_f32 v[64:65], v[80:81], v[46:47], v[64:65]
  v_accvgpr_read_b32 v100, a76
  v_pk_fma_f32 v[66:67], v[82:83], v[46:47], v[66:67]
  v_accvgpr_read_b32 v101, a77
  v_pk_fma_f32 v[68:69], v[84:85], v[46:47], v[68:69]
  v_accvgpr_read_b32 v102, a78
  v_pk_fma_f32 v[70:71], v[86:87], v[46:47], v[70:71]
  v_accvgpr_read_b32 v103, a79
  v_cvt_pk_bf16_f32 v72, v64, v65
  v_lshlrev_b32 v112, 16, v236
  v_cvt_pk_bf16_f32 v73, v66, v67
  v_and_b32 v113, 0xffff0000, v236
  v_cvt_pk_bf16_f32 v74, v68, v69
  v_lshlrev_b32 v114, 16, v237
  v_cvt_pk_bf16_f32 v75, v70, v71
  v_and_b32 v115, 0xffff0000, v237
  ds_write_b64 v76, v[72:73]
  v_lshlrev_b32 v116, 16, v238
  ds_write_b64 v77, v[74:75]
  v_and_b32 v117, 0xffff0000, v238
  v_lshlrev_b32 v118, 16, v239
  v_and_b32 v119, 0xffff0000, v239
  v_xor_b32 v108, 0x120, v41
  v_xor_b32 v109, 0x130, v41
  v_add_u32 v108, v108, v40
  v_add_u32 v109, v109, v40
  v_pk_mul_f32 v[96:97], v[96:97], v[44:45]
  v_accvgpr_read_b32 v64, a80
  v_pk_mul_f32 v[98:99], v[98:99], v[44:45]
  v_accvgpr_read_b32 v65, a81
  v_pk_mul_f32 v[100:101], v[100:101], v[44:45]
  v_accvgpr_read_b32 v66, a82
  v_pk_mul_f32 v[102:103], v[102:103], v[44:45]
  v_accvgpr_read_b32 v67, a83
  v_pk_fma_f32 v[96:97], v[112:113], v[46:47], v[96:97]
  v_accvgpr_read_b32 v68, a84
  v_pk_fma_f32 v[98:99], v[114:115], v[46:47], v[98:99]
  v_accvgpr_read_b32 v69, a85
  v_pk_fma_f32 v[100:101], v[116:117], v[46:47], v[100:101]
  v_accvgpr_read_b32 v70, a86
  v_pk_fma_f32 v[102:103], v[118:119], v[46:47], v[102:103]
  v_accvgpr_read_b32 v71, a87
  v_cvt_pk_bf16_f32 v104, v96, v97
  v_lshlrev_b32 v80, 16, v240
  v_cvt_pk_bf16_f32 v105, v98, v99
  v_and_b32 v81, 0xffff0000, v240
  v_cvt_pk_bf16_f32 v106, v100, v101
  v_lshlrev_b32 v82, 16, v241
  v_cvt_pk_bf16_f32 v107, v102, v103
  v_and_b32 v83, 0xffff0000, v241
  ds_write_b64 v108, v[104:105]
  v_lshlrev_b32 v84, 16, v242
  ds_write_b64 v109, v[106:107]
  v_and_b32 v85, 0xffff0000, v242
  v_lshlrev_b32 v86, 16, v243
  v_and_b32 v87, 0xffff0000, v243
  v_xor_b32 v76, 0x140, v41
  v_xor_b32 v77, 0x150, v41
  v_add_u32 v76, v76, v40
  v_add_u32 v77, v77, v40
  v_pk_mul_f32 v[64:65], v[64:65], v[44:45]
  v_accvgpr_read_b32 v96, a88
  v_pk_mul_f32 v[66:67], v[66:67], v[44:45]
  v_accvgpr_read_b32 v97, a89
  v_pk_mul_f32 v[68:69], v[68:69], v[44:45]
  v_accvgpr_read_b32 v98, a90
  v_pk_mul_f32 v[70:71], v[70:71], v[44:45]
  v_accvgpr_read_b32 v99, a91
  v_pk_fma_f32 v[64:65], v[80:81], v[46:47], v[64:65]
  v_accvgpr_read_b32 v100, a92
  v_pk_fma_f32 v[66:67], v[82:83], v[46:47], v[66:67]
  v_accvgpr_read_b32 v101, a93
  v_pk_fma_f32 v[68:69], v[84:85], v[46:47], v[68:69]
  v_accvgpr_read_b32 v102, a94
  v_pk_fma_f32 v[70:71], v[86:87], v[46:47], v[70:71]
  v_accvgpr_read_b32 v103, a95
  v_cvt_pk_bf16_f32 v72, v64, v65
  v_lshlrev_b32 v112, 16, v244
  v_cvt_pk_bf16_f32 v73, v66, v67
  v_and_b32 v113, 0xffff0000, v244
  v_cvt_pk_bf16_f32 v74, v68, v69
  v_lshlrev_b32 v114, 16, v245
  v_cvt_pk_bf16_f32 v75, v70, v71
  v_and_b32 v115, 0xffff0000, v245
  ds_write_b64 v76, v[72:73]
  v_lshlrev_b32 v116, 16, v246
  ds_write_b64 v77, v[74:75]
  v_and_b32 v117, 0xffff0000, v246
  v_lshlrev_b32 v118, 16, v247
  v_and_b32 v119, 0xffff0000, v247
  v_xor_b32 v108, 0x160, v41
  v_xor_b32 v109, 0x170, v41
  v_add_u32 v108, v108, v40
  v_add_u32 v109, v109, v40
  v_pk_mul_f32 v[96:97], v[96:97], v[44:45]
  v_accvgpr_read_b32 v64, a96
  v_pk_mul_f32 v[98:99], v[98:99], v[44:45]
  v_accvgpr_read_b32 v65, a97
  v_pk_mul_f32 v[100:101], v[100:101], v[44:45]
  v_accvgpr_read_b32 v66, a98
  v_pk_mul_f32 v[102:103], v[102:103], v[44:45]
  v_accvgpr_read_b32 v67, a99
  v_pk_fma_f32 v[96:97], v[112:113], v[46:47], v[96:97]
  v_accvgpr_read_b32 v68, a100
  v_pk_fma_f32 v[98:99], v[114:115], v[46:47], v[98:99]
  v_accvgpr_read_b32 v69, a101
  v_pk_fma_f32 v[100:101], v[116:117], v[46:47], v[100:101]
  v_accvgpr_read_b32 v70, a102
  v_pk_fma_f32 v[102:103], v[118:119], v[46:47], v[102:103]
  v_accvgpr_read_b32 v71, a103
  v_cvt_pk_bf16_f32 v104, v96, v97
  v_lshlrev_b32 v80, 16, v248
  v_cvt_pk_bf16_f32 v105, v98, v99
  v_and_b32 v81, 0xffff0000, v248
  v_cvt_pk_bf16_f32 v106, v100, v101
  v_lshlrev_b32 v82, 16, v249
  v_cvt_pk_bf16_f32 v107, v102, v103
  v_and_b32 v83, 0xffff0000, v249
  ds_write_b64 v108, v[104:105]
  v_lshlrev_b32 v84, 16, v250
  ds_write_b64 v109, v[106:107]
  v_and_b32 v85, 0xffff0000, v250
  v_lshlrev_b32 v86, 16, v251
  v_and_b32 v87, 0xffff0000, v251
  v_xor_b32 v76, 0x180, v41
  v_xor_b32 v77, 0x190, v41
  v_add_u32 v76, v76, v40
  v_add_u32 v77, v77, v40
  v_pk_mul_f32 v[64:65], v[64:65], v[44:45]
  v_accvgpr_read_b32 v96, a104
  v_pk_mul_f32 v[66:67], v[66:67], v[44:45]
  v_accvgpr_read_b32 v97, a105
  v_pk_mul_f32 v[68:69], v[68:69], v[44:45]
  v_accvgpr_read_b32 v98, a106
  v_pk_mul_f32 v[70:71], v[70:71], v[44:45]
  v_accvgpr_read_b32 v99, a107
  v_pk_fma_f32 v[64:65], v[80:81], v[46:47], v[64:65]
  v_accvgpr_read_b32 v100, a108
  v_pk_fma_f32 v[66:67], v[82:83], v[46:47], v[66:67]
  v_accvgpr_read_b32 v101, a109
  v_pk_fma_f32 v[68:69], v[84:85], v[46:47], v[68:69]
  v_accvgpr_read_b32 v102, a110
  v_pk_fma_f32 v[70:71], v[86:87], v[46:47], v[70:71]
  v_accvgpr_read_b32 v103, a111
  v_cvt_pk_bf16_f32 v72, v64, v65
  v_lshlrev_b32 v112, 16, v252
  v_cvt_pk_bf16_f32 v73, v66, v67
  v_and_b32 v113, 0xffff0000, v252
  v_cvt_pk_bf16_f32 v74, v68, v69
  v_lshlrev_b32 v114, 16, v253
  v_cvt_pk_bf16_f32 v75, v70, v71
  v_and_b32 v115, 0xffff0000, v253
  ds_write_b64 v76, v[72:73]
  v_lshlrev_b32 v116, 16, v254
  ds_write_b64 v77, v[74:75]
  v_and_b32 v117, 0xffff0000, v254
  v_lshlrev_b32 v118, 16, v255
  v_and_b32 v119, 0xffff0000, v255
  v_xor_b32 v108, 0x1a0, v41
  v_xor_b32 v109, 0x1b0, v41
  v_add_u32 v108, v108, v40
  v_add_u32 v109, v109, v40
  v_pk_mul_f32 v[96:97], v[96:97], v[44:45]
  v_accvgpr_read_b32 v64, a112
  v_pk_mul_f32 v[98:99], v[98:99], v[44:45]
  v_accvgpr_read_b32 v65, a113
  v_pk_mul_f32 v[100:101], v[100:101], v[44:45]
  v_accvgpr_read_b32 v66, a114
  v_pk_mul_f32 v[102:103], v[102:103], v[44:45]
  v_accvgpr_read_b32 v67, a115
  v_pk_fma_f32 v[96:97], v[112:113], v[46:47], v[96:97]
  v_accvgpr_read_b32 v68, a116
  v_pk_fma_f32 v[98:99], v[114:115], v[46:47], v[98:99]
  v_accvgpr_read_b32 v69, a117
  v_pk_fma_f32 v[100:101], v[116:117], v[46:47], v[100:101]
  v_accvgpr_read_b32 v70, a118
  v_pk_fma_f32 v[102:103], v[118:119], v[46:47], v[102:103]
  v_accvgpr_read_b32 v71, a119
  v_cvt_pk_bf16_f32 v104, v96, v97
  v_lshlrev_b32 v80, 16, v50
  v_cvt_pk_bf16_f32 v105, v98, v99
  v_and_b32 v81, 0xffff0000, v50
  v_cvt_pk_bf16_f32 v106, v100, v101
  v_lshlrev_b32 v82, 16, v51
  v_cvt_pk_bf16_f32 v107, v102, v103
  v_and_b32 v83, 0xffff0000, v51
  ds_write_b64 v108, v[104:105]
  v_lshlrev_b32 v84, 16, v52
  ds_write_b64 v109, v[106:107]
  v_and_b32 v85, 0xffff0000, v52
  v_lshlrev_b32 v86, 16, v53
  v_and_b32 v87, 0xffff0000, v53
  v_xor_b32 v76, 0x1c0, v41
  v_xor_b32 v77, 0x1d0, v41
  v_add_u32 v76, v76, v40
  v_add_u32 v77, v77, v40
  v_pk_mul_f32 v[64:65], v[64:65], v[44:45]
  v_accvgpr_read_b32 v96, a120
  v_pk_mul_f32 v[66:67], v[66:67], v[44:45]
  v_accvgpr_read_b32 v97, a121
  v_pk_mul_f32 v[68:69], v[68:69], v[44:45]
  v_accvgpr_read_b32 v98, a122
  v_pk_mul_f32 v[70:71], v[70:71], v[44:45]
  v_accvgpr_read_b32 v99, a123
  v_pk_fma_f32 v[64:65], v[80:81], v[46:47], v[64:65]
  v_accvgpr_read_b32 v100, a124
  v_pk_fma_f32 v[66:67], v[82:83], v[46:47], v[66:67]
  v_accvgpr_read_b32 v101, a125
  v_pk_fma_f32 v[68:69], v[84:85], v[46:47], v[68:69]
  v_accvgpr_read_b32 v102, a126
  v_pk_fma_f32 v[70:71], v[86:87], v[46:47], v[70:71]
  v_accvgpr_read_b32 v103, a127
  v_cvt_pk_bf16_f32 v72, v64, v65
  v_lshlrev_b32 v112, 16, v54
  v_cvt_pk_bf16_f32 v73, v66, v67
  v_and_b32 v113, 0xffff0000, v54
  v_cvt_pk_bf16_f32 v74, v68, v69
  v_lshlrev_b32 v114, 16, v55
  v_cvt_pk_bf16_f32 v75, v70, v71
  v_and_b32 v115, 0xffff0000, v55
  ds_write_b64 v76, v[72:73]
  v_lshlrev_b32 v116, 16, v56
  ds_write_b64 v77, v[74:75]
  v_and_b32 v117, 0xffff0000, v56
  v_lshlrev_b32 v118, 16, v57
  v_and_b32 v119, 0xffff0000, v57
  v_xor_b32 v108, 0x1e0, v41
  v_xor_b32 v109, 0x1f0, v41
  v_add_u32 v108, v108, v40
  v_add_u32 v109, v109, v40
  v_pk_mul_f32 v[96:97], v[96:97], v[44:45]
  v_pk_mul_f32 v[98:99], v[98:99], v[44:45]
  v_pk_mul_f32 v[100:101], v[100:101], v[44:45]
  v_pk_mul_f32 v[102:103], v[102:103], v[44:45]
  v_pk_fma_f32 v[96:97], v[112:113], v[46:47], v[96:97]
  v_pk_fma_f32 v[98:99], v[114:115], v[46:47], v[98:99]
  v_pk_fma_f32 v[100:101], v[116:117], v[46:47], v[100:101]
  v_pk_fma_f32 v[102:103], v[118:119], v[46:47], v[102:103]
  v_cvt_pk_bf16_f32 v104, v96, v97
  v_cvt_pk_bf16_f32 v105, v98, v99
  v_cvt_pk_bf16_f32 v106, v100, v101
  v_cvt_pk_bf16_f32 v107, v102, v103
  ds_write_b64 v108, v[104:105]
  ds_write_b64 v109, v[106:107]
  s_waitcnt lgkmcnt(0)
  v_xor_b32 v128, 0x0, v43
  ds_read_b128 v[64:67], v128 offset:0
  v_xor_b32 v129, 0x20, v43
  ds_read_b128 v[68:71], v129 offset:1024
  v_xor_b32 v130, 0x40, v43
  ds_read_b128 v[72:75], v130 offset:2048
  v_xor_b32 v131, 0x60, v43
  ds_read_b128 v[76:79], v131 offset:3072
  v_xor_b32 v132, 0x80, v43
  ds_read_b128 v[80:83], v132 offset:4096
  v_xor_b32 v133, 0xa0, v43
  ds_read_b128 v[84:87], v133 offset:5120
  v_xor_b32 v134, 0xc0, v43
  ds_read_b128 v[88:91], v134 offset:6144
  v_xor_b32 v135, 0xe0, v43
  ds_read_b128 v[92:95], v135 offset:7168
  v_xor_b32 v136, 0x100, v43
  ds_read_b128 v[96:99], v136 offset:8192
  v_xor_b32 v137, 0x120, v43
  ds_read_b128 v[100:103], v137 offset:9216
  v_xor_b32 v138, 0x140, v43
  ds_read_b128 v[104:107], v138 offset:10240
  v_xor_b32 v139, 0x160, v43
  ds_read_b128 v[108:111], v139 offset:11264
  v_xor_b32 v140, 0x180, v43
  ds_read_b128 v[112:115], v140 offset:12288
  v_xor_b32 v141, 0x1a0, v43
  ds_read_b128 v[116:119], v141 offset:13312
  v_xor_b32 v142, 0x1c0, v43
  ds_read_b128 v[120:123], v142 offset:14336
  v_xor_b32 v143, 0x1e0, v43
  ds_read_b128 v[124:127], v143 offset:15360
  s_waitcnt lgkmcnt(15)
  buffer_store_dwordx4 v[64:67], v25, s[16:19], s52 offen offset:0 sc1
  s_waitcnt lgkmcnt(14)
  buffer_store_dwordx4 v[68:71], v25, s[16:19], s52 offen offset:1024 sc1
  s_waitcnt lgkmcnt(13)
  buffer_store_dwordx4 v[72:75], v25, s[16:19], s52 offen offset:2048 sc1
  s_waitcnt lgkmcnt(12)
  buffer_store_dwordx4 v[76:79], v25, s[16:19], s52 offen offset:3072 sc1
  s_add_u32 s52, s52, 0x1000
  s_waitcnt lgkmcnt(11)
  buffer_store_dwordx4 v[80:83], v25, s[16:19], s52 offen offset:0 sc1
  s_waitcnt lgkmcnt(10)
  buffer_store_dwordx4 v[84:87], v25, s[16:19], s52 offen offset:1024 sc1
  s_waitcnt lgkmcnt(9)
  buffer_store_dwordx4 v[88:91], v25, s[16:19], s52 offen offset:2048 sc1
  s_waitcnt lgkmcnt(8)
  buffer_store_dwordx4 v[92:95], v25, s[16:19], s52 offen offset:3072 sc1
  s_add_u32 s52, s52, 0x1000
  s_waitcnt lgkmcnt(7)
  buffer_store_dwordx4 v[96:99], v25, s[16:19], s52 offen offset:0 sc1
  s_waitcnt lgkmcnt(6)
  buffer_store_dwordx4 v[100:103], v25, s[16:19], s52 offen offset:1024 sc1
  s_waitcnt lgkmcnt(5)
  buffer_store_dwordx4 v[104:107], v25, s[16:19], s52 offen offset:2048 sc1
  s_waitcnt lgkmcnt(4)
  buffer_store_dwordx4 v[108:111], v25, s[16:19], s52 offen offset:3072 sc1
  s_add_u32 s52, s52, 0x1000
  s_waitcnt lgkmcnt(3)
  buffer_store_dwordx4 v[112:115], v25, s[16:19], s52 offen offset:0 sc1
  s_waitcnt lgkmcnt(2)
  buffer_store_dwordx4 v[116:119], v25, s[16:19], s52 offen offset:1024 sc1
  s_waitcnt lgkmcnt(1)
  buffer_store_dwordx4 v[120:123], v25, s[16:19], s52 offen offset:2048 sc1
  s_waitcnt lgkmcnt(0)
  buffer_store_dwordx4 v[124:127], v25, s[16:19], s52 offen offset:3072 sc1
L_end:
  s_endpgm
L_hook:
  s_bitcmp1_b32 s43, 0
  s_cbranch_scc0 L_h1
  s_bitset0_b32 s43, 0
  s_cmp_lg_u32 s28, 0
  s_cbranch_scc1 L_h1
  v_mov_b32 v39, 1
  v_mov_b32 v38, 0
  s_mov_b64 s[56:57], exec
  s_mov_b64 exec, 1
  buffer_store_byte v39, v38, s[24:27], s51 offen sc1
  s_mov_b64 exec, s[56:57]
L_h1:
  s_bitcmp1_b32 s43, 1
  s_cbranch_scc0 L_h2
  s_cmp_eq_u32 s79, 1
  s_cbranch_scc0 L_p1
  s_lshl_b32 s76, s78, 15
  s_add_u32 s76, s76, s29
  s_mov_b32 s77, s76
  s_mov_b32 s79, 2
  s_branch L_h2
L_p1:
  s_cmp_eq_u32 s79, 2
  s_cbranch_scc0 L_p3
  s_mov_b64 s[68:69], s[4:5]
  s_mov_b64 s[70:71], s[6:7]
  s_mov_b64 s[72:73], s[4:5]
  s_mov_b64 s[74:75], s[6:7]
  s_mov_b32 s76, s65
  s_add_u32 s77, s65, 0x8000
  s_mov_b32 s79, 3
  s_branch L_h2
L_p3:
  s_mov_b32 s76, s45
  s_mov_b32 s77, s45
  s_bitset0_b32 s43, 1
L_h2:
  s_bitcmp1_b32 s43, 2
  s_cbranch_scc0 L_h3
  v_cmp_ne_u32 vcc, 0, v61
  s_cbranch_vccnz L_got
  v_mov_b32 v38, 0
  buffer_load_ubyte v61, v38, s[24:27], s51 offen sc1
  s_setpc_b64 s[96:97]
L_got:
  buffer_inv sc1
  s_mov_b32 s99, 1
  s_bitset0_b32 s43, 2
  s_bitset1_b32 s43, 4
  s_mov_b32 s67, 0
  s_lshl_b32 s53, s28, 9
  s_add_u32 s53, s53, s46
  s_add_u32 s53, s53, 0x20000
  v_lshlrev_b32 v39, 3, v1
  buffer_load_dwordx2 v[58:59], v39, s[20:23], s53 offen sc1
L_h3:
  s_and_b32 s53, s43, 0x18
  s_cbranch_scc0 L_hret
  s_lshl_b32 s52, s28, 14
  s_add_u32 s52, s52, s46
  s_bitcmp1_b32 s43, 3
  s_cbranch_scc0 L_ld_0
L_st_0:
  s_cmp_lg_u32 s67, 0
  s_cbranch_scc1 L_st_1
  s_add_u32 s53, s52, 0x0
  buffer_store_dwordx4 v[200:203], v25, s[20:23], s53 offen offset:0 sc1
  buffer_store_dwordx4 v[204:207], v25, s[20:23], s53 offen offset:1024 sc1
  buffer_store_dwordx4 v[208:211], v25, s[20:23], s53 offen offset:2048 sc1
  buffer_store_dwordx4 v[212:215], v25, s[20:23], s53 offen offset:3072 sc1
  s_add_u32 s53, s52, 0x1000
  buffer_store_dwordx4 v[216:219], v25, s[20:23], s53 offen offset:0 sc1
  buffer_store_dwordx4 v[220:223], v25, s[20:23], s53 offen offset:1024 sc1
  buffer_store_dwordx4 v[224:227], v25, s[20:23], s53 offen offset:2048 sc1
  buffer_store_dwordx4 v[228:231], v25, s[20:23], s53 offen offset:3072 sc1
  s_add_u32 s67, s67, 1
  s_setpc_b64 s[96:97]
L_st_1:
  s_add_u32 s53, s52, 0x2000
  buffer_store_dwordx4 v[232:235], v25, s[20:23], s53 offen offset:0 sc1
  buffer_store_dwordx4 v[236:239], v25, s[20:23], s53 offen offset:1024 sc1
  buffer_store_dwordx4 v[240:243], v25, s[20:23], s53 offen offset:2048 sc1
  buffer_store_dwordx4 v[244:247], v25, s[20:23], s53 offen offset:3072 sc1
  s_add_u32 s53, s52, 0x3000
  buffer_store_dwordx4 v[248:251], v25, s[20:23], s53 offen offset:0 sc1
  buffer_store_dwordx4 v[252:255], v25, s[20:23], s53 offen offset:1024 sc1
  buffer_store_dwordx4 v[50:53], v25, s[20:23], s53 offen offset:2048 sc1
  buffer_store_dwordx4 v[54:57], v25, s[20:23], s53 offen offset:3072 sc1
  s_bitset0_b32 s43, 3
  s_bitset1_b32 s43, 0
  s_setpc_b64 s[96:97]
L_ld_0:
  s_cmp_lg_u32 s67, 0
  s_cbranch_scc1 L_ld_1
  s_add_u32 s53, s52, 0x0
  buffer_load_dwordx4 v[200:203], v25, s[20:23], s53 offen offset:0 sc1
  buffer_load_dwordx4 v[204:207], v25, s[20:23], s53 offen offset:1024 sc1
  buffer_load_dwordx4 v[208:211], v25, s[20:23], s53 offen offset:2048 sc1
  buffer_load_dwordx4 v[212:215], v25, s[20:23], s53 offen offset:3072 sc1
  s_add_u32 s53, s52, 0x1000
  buffer_load_dwordx4 v[216:219], v25, s[20:23], s53 offen offset:0 sc1
  buffer_load_dwordx4 v[220:223], v25, s[20:23], s53 offen offset:1024 sc1
  buffer_load_dwordx4 v[224:227], v25, s[20:23], s53 offen offset:2048 sc1
  buffer_load_dwordx4 v[228:231], v25, s[20:23], s53 offen offset:3072 sc1
  s_add_u32 s67, s67, 1
  s_setpc_b64 s[96:97]
L_ld_1:
  s_add_u32 s53, s52, 0x2000
  buffer_load_dwordx4 v[232:235], v25, s[20:23], s53 offen offset:0 sc1
  buffer_load_dwordx4 v[236:239], v25, s[20:23], s53 offen offset:1024 sc1
  buffer_load_dwordx4 v[240:243], v25, s[20:23], s53 offen offset:2048 sc1
  buffer_load_dwordx4 v[244:247], v25, s[20:23], s53 offen offset:3072 sc1
  s_add_u32 s53, s52, 0x3000
  buffer_load_dwordx4 v[248:251], v25, s[20:23], s53 offen offset:0 sc1
  buffer_load_dwordx4 v[252:255], v25, s[20:23], s53 offen offset:1024 sc1
  buffer_load_dwordx4 v[50:53], v25, s[20:23], s53 offen offset:2048 sc1
  buffer_load_dwordx4 v[54:57], v25, s[20:23], s53 offen offset:3072 sc1
  s_bitset0_b32 s43, 4
  s_setpc_b64 s[96:97]
L_hret:
  s_setpc_b64 s[96:97]
L_mask0_1:
  s_lshl_b32 s52, s32, 6
  v_subrev_u32 v38, s52, v26
  v_cmp_gt_i32 s[56:57], 0, v38
  v_cmp_gt_i32 s[58:59], 1, v38
  v_cmp_gt_i32 s[60:61], 2, v38
  v_cmp_gt_i32 s[62:63], 3, v38
  v_cndmask_b32 v64, v64, v37, s[56:57]
  v_cndmask_b32 v65, v65, v37, s[58:59]
  v_cndmask_b32 v66, v66, v37, s[60:61]
  v_cndmask_b32 v67, v67, v37, s[62:63]
  v_cmp_gt_i32 s[56:57], 8, v38
  v_cmp_gt_i32 s[58:59], 9, v38
  v_cmp_gt_i32 s[60:61], 10, v38
  v_cmp_gt_i32 s[62:63], 11, v38
  v_cndmask_b32 v68, v68, v37, s[56:57]
  v_cndmask_b32 v69, v69, v37, s[58:59]
  v_cndmask_b32 v70, v70, v37, s[60:61]
  v_cndmask_b32 v71, v71, v37, s[62:63]
  v_cmp_gt_i32 s[56:57], 16, v38
  v_cmp_gt_i32 s[58:59], 17, v38
  v_cmp_gt_i32 s[60:61], 18, v38
  v_cmp_gt_i32 s[62:63], 19, v38
  v_cndmask_b32 v72, v72, v37, s[56:57]
  v_cndmask_b32 v73, v73, v37, s[58:59]
  v_cndmask_b32 v74, v74, v37, s[60:61]
  v_cndmask_b32 v75, v75, v37, s[62:63]
  v_cmp_gt_i32 s[56:57], 24, v38
  v_cmp_gt_i32 s[58:59], 25, v38
  v_cmp_gt_i32 s[60:61], 26, v38
  v_cmp_gt_i32 s[62:63], 27, v38
  v_cndmask_b32 v76, v76, v37, s[56:57]
  v_cndmask_b32 v77, v77, v37, s[58:59]
  v_cndmask_b32 v78, v78, v37, s[60:61]
  v_cndmask_b32 v79, v79, v37, s[62:63]
  s_branch L_ret_2
L_mask1_3:
  s_lshl_b32 s52, s32, 6
  v_subrev_u32 v38, s52, v26
  v_cmp_gt_i32 s[56:57], 32, v38
  v_cmp_gt_i32 s[58:59], 33, v38
  v_cmp_gt_i32 s[60:61], 34, v38
  v_cmp_gt_i32 s[62:63], 35, v38
  v_cndmask_b32 v80, v80, v37, s[56:57]
  v_cndmask_b32 v81, v81, v37, s[58:59]
  v_cndmask_b32 v82, v82, v37, s[60:61]
  v_cndmask_b32 v83, v83, v37, s[62:63]
  v_cmp_gt_i32 s[56:57], 40, v38
  v_cmp_gt_i32 s[58:59], 41, v38
  v_cmp_gt_i32 s[60:61], 42, v38
  v_cmp_gt_i32 s[62:63], 43, v38
  v_cndmask_b32 v84, v84, v37, s[56:57]
  v_cndmask_b32 v85, v85, v37, s[58:59]
  v_cndmask_b32 v86, v86, v37, s[60:61]
  v_cndmask_b32 v87, v87, v37, s[62:63]
  v_cmp_gt_i32 s[56:57], 48, v38
  v_cmp_gt_i32 s[58:59], 49, v38
  v_cmp_gt_i32 s[60:61], 50, v38
  v_cmp_gt_i32 s[62:63], 51, v38
  v_cndmask_b32 v88, v88, v37, s[56:57]
  v_cndmask_b32 v89, v89, v37, s[58:59]
  v_cndmask_b32 v90, v90, v37, s[60:61]
  v_cndmask_b32 v91, v91, v37, s[62:63]
  v_cmp_gt_i32 s[56:57], 56, v38
  v_cmp_gt_i32 s[58:59], 57, v38
  v_cmp_gt_i32 s[60:61], 58, v38
  v_cmp_gt_i32 s[62:63], 59, v38
  v_cndmask_b32 v92, v92, v37, s[56:57]
  v_cndmask_b32 v93, v93, v37, s[58:59]
  v_cndmask_b32 v94, v94, v37, s[60:61]
  v_cndmask_b32 v95, v95, v37, s[62:63]
  s_branch L_ret_4
L_mask0_6:
  s_lshl_b32 s52, s32, 6
  v_subrev_u32 v38, s52, v26
  v_cmp_gt_i32 s[56:57], 0, v38
  v_cmp_gt_i32 s[58:59], 1, v38
  v_cmp_gt_i32 s[60:61], 2, v38
  v_cmp_gt_i32 s[62:63], 3, v38
  v_cndmask_b32 v96, v96, v37, s[56:57]
  v_cndmask_b32 v97, v97, v37, s[58:59]
  v_cndmask_b32 v98, v98, v37, s[60:61]
  v_cndmask_b32 v99, v99, v37, s[62:63]
  v_cmp_gt_i32 s[56:57], 8, v38
  v_cmp_gt_i32 s[58:59], 9, v38
  v_cmp_gt_i32 s[60:61], 10, v38
  v_cmp_gt_i32 s[62:63], 11, v38
  v_cndmask_b32 v100, v100, v37, s[56:57]
  v_cndmask_b32 v101, v101, v37, s[58:59]
  v_cndmask_b32 v102, v102, v37, s[60:61]
  v_cndmask_b32 v103, v103, v37, s[62:63]
  v_cmp_gt_i32 s[56:57], 16, v38
  v_cmp_gt_i32 s[58:59], 17, v38
  v_cmp_gt_i32 s[60:61], 18, v38
  v_cmp_gt_i32 s[62:63], 19, v38
  v_cndmask_b32 v104, v104, v37, s[56:57]
  v_cndmask_b32 v105, v105, v37, s[58:59]
  v_cndmask_b32 v106, v106, v37, s[60:61]
  v_cndmask_b32 v107, v107, v37, s[62:63]
  v_cmp_gt_i32 s[56:57], 24, v38
  v_cmp_gt_i32 s[58:59], 25, v38
  v_cmp_gt_i32 s[60:61], 26, v38
  v_cmp_gt_i32 s[62:63], 27, v38
  v_cndmask_b32 v108, v108, v37, s[56:57]
  v_cndmask_b32 v109, v109, v37, s[58:59]
  v_cndmask_b32 v110, v110, v37, s[60:61]
  v_cndmask_b32 v111, v111, v37, s[62:63]
  s_branch L_ret_7
L_mask1_8:
  s_lshl_b32 s52, s32, 6
  v_subrev_u32 v38, s52, v26
  v_cmp_gt_i32 s[56:57], 32, v38
  v_cmp_gt_i32 s[58:59], 33, v38
  v_cmp_gt_i32 s[60:61], 34, v38
  v_cmp_gt_i32 s[62:63], 35, v38
  v_cndmask_b32 v112, v112, v37, s[56:57]
  v_cndmask_b32 v113, v113, v37, s[58:59]
  v_cndmask_b32 v114, v114, v37, s[60:61]
  v_cndmask_b32 v115, v115, v37, s[62:63]
  v_cmp_gt_i32 s[56:57], 40, v38
  v_cmp_gt_i32 s[58:59], 41, v38
  v_cmp_gt_i32 s[60:61], 42, v38
  v_cmp_gt_i32 s[62:63], 43, v38
  v_cndmask_b32 v116, v116, v37, s[56:57]
  v_cndmask_b32 v117, v117, v37, s[58:59]
  v_cndmask_b32 v118, v118, v37, s[60:61]
  v_cndmask_b32 v119, v119, v37, s[62:63]
  v_cmp_gt_i32 s[56:57], 48, v38
  v_cmp_gt_i32 s[58:59], 49, v38
  v_cmp_gt_i32 s[60:61], 50, v38
  v_cmp_gt_i32 s[62:63], 51, v38
  v_cndmask_b32 v120, v120, v37, s[56:57]
  v_cndmask_b32 v121, v121, v37, s[58:59]
  v_cndmask_b32 v122, v122, v37, s[60:61]
  v_cndmask_b32 v123, v123, v37, s[62:63]
  v_cmp_gt_i32 s[56:57], 56, v38
  v_cmp_gt_i32 s[58:59], 57, v38
  v_cmp_gt_i32 s[60:61], 58, v38
  v_cmp_gt_i32 s[62:63], 59, v38
  v_cndmask_b32 v124, v124, v37, s[56:57]
  v_cndmask_b32 v125, v125, v37, s[58:59]
  v_cndmask_b32 v126, v126, v37, s[60:61]
  v_cndmask_b32 v127, v127, v37, s[62:63]
  s_branch L_ret_9
L_rare_10:
  v_mov_b32 v36, v35
  s_nop 1
  v_permlane32_swap_b32 v36, v35
  v_max3_f32 v36, v27, v35, v36
  v_sub_f32 v39, v27, v36
  v_mul_f32 v39, s30, v39
  v_exp_f32 v34, v39
  v_mov_b32 v27, v36
  v_add_f32 v28, 0x42b17218, v36
  v_mul_f32 v29, s30, v36
  v_mul_f32 v30, v30, v34
  v_mul_f32 v31, v31, v34
  v_mul_f32 v32, v32, v34
  v_mul_f32 v33, v33, v34
  s_mov_b32 s42, 1
  s_branch L_ret_11
L_resc_12:
  s_nop 15
  s_nop 15
  v_accvgpr_read_b32 v40, a0
  v_accvgpr_read_b32 v41, a1
  v_accvgpr_read_b32 v42, a2
  v_accvgpr_read_b32 v43, a3
  v_accvgpr_read_b32 v44, a4
  v_accvgpr_read_b32 v45, a5
  v_accvgpr_read_b32 v46, a6
  v_accvgpr_read_b32 v47, a7
  v_mul_f32 v40, v40, v34
  v_mul_f32 v41, v41, v34
  v_mul_f32 v42, v42, v34
  v_mul_f32 v43, v43, v34
  v_mul_f32 v44, v44, v34
  v_mul_f32 v45, v45, v34
  v_mul_f32 v46, v46, v34
  v_mul_f32 v47, v47, v34
  v_accvgpr_write_b32 a0, v40
  v_accvgpr_write_b32 a1, v41
  v_accvgpr_write_b32 a2, v42
  v_accvgpr_write_b32 a3, v43
  v_accvgpr_write_b32 a4, v44
  v_accvgpr_write_b32 a5, v45
  v_accvgpr_write_b32 a6, v46
  v_accvgpr_write_b32 a7, v47
  v_accvgpr_read_b32 v40, a8
  v_accvgpr_read_b32 v41, a9
  v_accvgpr_read_b32 v42, a10
  v_accvgpr_read_b32 v43, a11
  v_accvgpr_read_b32 v44, a12
  v_accvgpr_read_b32 v45, a13
  v_accvgpr_read_b32 v46, a14
  v_accvgpr_read_b32 v47, a15
  v_mul_f32 v40, v40, v34
  v_mul_f32 v41, v41, v34
  v_mul_f32 v42, v42, v34
  v_mul_f32 v43, v43, v34
  v_mul_f32 v44, v44, v34
  v_mul_f32 v45, v45, v34
  v_mul_f32 v46, v46, v34
  v_mul_f32 v47, v47, v34
  v_accvgpr_write_b32 a8, v40
  v_accvgpr_write_b32 a9, v41
  v_accvgpr_write_b32 a10, v42
  v_accvgpr_write_b32 a11, v43
  v_accvgpr_write_b32 a12, v44
  v_accvgpr_write_b32 a13, v45
  v_accvgpr_write_b32 a14, v46
  v_accvgpr_write_b32 a15, v47
  v_accvgpr_read_b32 v40, a16
  v_accvgpr_read_b32 v41, a17
  v_accvgpr_read_b32 v42, a18
  v_accvgpr_read_b32 v43, a19
  v_accvgpr_read_b32 v44, a20
  v_accvgpr_read_b32 v45, a21
  v_accvgpr_read_b32 v46, a22
  v_accvgpr_read_b32 v47, a23
  v_mul_f32 v40, v40, v34
  v_mul_f32 v41, v41, v34
  v_mul_f32 v42, v42, v34
  v_mul_f32 v43, v43, v34
  v_mul_f32 v44, v44, v34
  v_mul_f32 v45, v45, v34
  v_mul_f32 v46, v46, v34
  v_mul_f32 v47, v47, v34
  v_accvgpr_write_b32 a16, v40
  v_accvgpr_write_b32 a17, v41
  v_accvgpr_write_b32 a18, v42
  v_accvgpr_write_b32 a19, v43
  v_accvgpr_write_b32 a20, v44
  v_accvgpr_write_b32 a21, v45
  v_accvgpr_write_b32 a22, v46
  v_accvgpr_write_b32 a23, v47
  v_accvgpr_read_b32 v40, a24
  v_accvgpr_read_b32 v41, a25
  v_accvgpr_read_b32 v42, a26
  v_accvgpr_read_b32 v43, a27
  v_accvgpr_read_b32 v44, a28
  v_accvgpr_read_b32 v45, a29
  v_accvgpr_read_b32 v46, a30
  v_accvgpr_read_b32 v47, a31
  v_mul_f32 v40, v40, v34
  v_mul_f32 v41, v41, v34
  v_mul_f32 v42, v42, v34
  v_mul_f32 v43, v43, v34
  v_mul_f32 v44, v44, v34
  v_mul_f32 v45, v45, v34
  v_mul_f32 v46, v46, v34
  v_mul_f32 v47, v47, v34
  v_accvgpr_write_b32 a24, v40
  v_accvgpr_write_b32 a25, v41
  v_accvgpr_write_b32 a26, v42
  v_accvgpr_write_b32 a27, v43
  v_accvgpr_write_b32 a28, v44
  v_accvgpr_write_b32 a29, v45
  v_accvgpr_write_b32 a30, v46
  v_accvgpr_write_b32 a31, v47
  v_accvgpr_read_b32 v40, a32
  v_accvgpr_read_b32 v41, a33
  v_accvgpr_read_b32 v42, a34
  v_accvgpr_read_b32 v43, a35
  v_accvgpr_read_b32 v44, a36
  v_accvgpr_read_b32 v45, a37
  v_accvgpr_read_b32 v46, a38
  v_accvgpr_read_b32 v47, a39
  v_mul_f32 v40, v40, v34
  v_mul_f32 v41, v41, v34
  v_mul_f32 v42, v42, v34
  v_mul_f32 v43, v43, v34
  v_mul_f32 v44, v44, v34
  v_mul_f32 v45, v45, v34
  v_mul_f32 v46, v46, v34
  v_mul_f32 v47, v47, v34
  v_accvgpr_write_b32 a32, v40
  v_accvgpr_write_b32 a33, v41
  v_accvgpr_write_b32 a34, v42
  v_accvgpr_write_b32 a35, v43
  v_accvgpr_write_b32 a36, v44
  v_accvgpr_write_b32 a37, v45
  v_accvgpr_write_b32 a38, v46
  v_accvgpr_write_b32 a39, v47
  v_accvgpr_read_b32 v40, a40
  v_accvgpr_read_b32 v41, a41
  v_accvgpr_read_b32 v42, a42
  v_accvgpr_read_b32 v43, a43
  v_accvgpr_read_b32 v44, a44
  v_accvgpr_read_b32 v45, a45
  v_accvgpr_read_b32 v46, a46
  v_accvgpr_read_b32 v47, a47
  v_mul_f32 v40, v40, v34
  v_mul_f32 v41, v41, v34
  v_mul_f32 v42, v42, v34
  v_mul_f32 v43, v43, v34
  v_mul_f32 v44, v44, v34
  v_mul_f32 v45, v45, v34
  v_mul_f32 v46, v46, v34
  v_mul_f32 v47, v47, v34
  v_accvgpr_write_b32 a40, v40
  v_accvgpr_write_b32 a41, v41
  v_accvgpr_write_b32 a42, v42
  v_accvgpr_write_b32 a43, v43
  v_accvgpr_write_b32 a44, v44
  v_accvgpr_write_b32 a45, v45
  v_accvgpr_write_b32 a46, v46
  v_accvgpr_write_b32 a47, v47
  v_accvgpr_read_b32 v40, a48
  v_accvgpr_read_b32 v41, a49
  v_accvgpr_read_b32 v42, a50
  v_accvgpr_read_b32 v43, a51
  v_accvgpr_read_b32 v44, a52
  v_accvgpr_read_b32 v45, a53
  v_accvgpr_read_b32 v46, a54
  v_accvgpr_read_b32 v47, a55
  v_mul_f32 v40, v40, v34
  v_mul_f32 v41, v41, v34
  v_mul_f32 v42, v42, v34
  v_mul_f32 v43, v43, v34
  v_mul_f32 v44, v44, v34
  v_mul_f32 v45, v45, v34
  v_mul_f32 v46, v46, v34
  v_mul_f32 v47, v47, v34
  v_accvgpr_write_b32 a48, v40
  v_accvgpr_write_b32 a49, v41
  v_accvgpr_write_b32 a50, v42
  v_accvgpr_write_b32 a51, v43
  v_accvgpr_write_b32 a52, v44
  v_accvgpr_write_b32 a53, v45
  v_accvgpr_write_b32 a54, v46
  v_accvgpr_write_b32 a55, v47
  v_accvgpr_read_b32 v40, a56
  v_accvgpr_read_b32 v41, a57
  v_accvgpr_read_b32 v42, a58
  v_accvgpr_read_b32 v43, a59
  v_accvgpr_read_b32 v44, a60
  v_accvgpr_read_b32 v45, a61
  v_accvgpr_read_b32 v46, a62
  v_accvgpr_read_b32 v47, a63
  v_mul_f32 v40, v40, v34
  v_mul_f32 v41, v41, v34
  v_mul_f32 v42, v42, v34
  v_mul_f32 v43, v43, v34
  v_mul_f32 v44, v44, v34
  v_mul_f32 v45, v45, v34
  v_mul_f32 v46, v46, v34
  v_mul_f32 v47, v47, v34
  v_accvgpr_write_b32 a56, v40
  v_accvgpr_write_b32 a57, v41
  v_accvgpr_write_b32 a58, v42
  v_accvgpr_write_b32 a59, v43
  v_accvgpr_write_b32 a60, v44
  v_accvgpr_write_b32 a61, v45
  v_accvgpr_write_b32 a62, v46
  v_accvgpr_write_b32 a63, v47
  v_accvgpr_read_b32 v40, a64
  v_accvgpr_read_b32 v41, a65
  v_accvgpr_read_b32 v42, a66
  v_accvgpr_read_b32 v43, a67
  v_accvgpr_read_b32 v44, a68
  v_accvgpr_read_b32 v45, a69
  v_accvgpr_read_b32 v46, a70
  v_accvgpr_read_b32 v47, a71
  v_mul_f32 v40, v40, v34
  v_mul_f32 v41, v41, v34
  v_mul_f32 v42, v42, v34
  v_mul_f32 v43, v43, v34
  v_mul_f32 v44, v44, v34
  v_mul_f32 v45, v45, v34
  v_mul_f32 v46, v46, v34
  v_mul_f32 v47, v47, v34
  v_accvgpr_write_b32 a64, v40
  v_accvgpr_write_b32 a65, v41
  v_accvgpr_write_b32 a66, v42
  v_accvgpr_write_b32 a67, v43
  v_accvgpr_write_b32 a68, v44
  v_accvgpr_write_b32 a69, v45
  v_accvgpr_write_b32 a70, v46
  v_accvgpr_write_b32 a71, v47
  v_accvgpr_read_b32 v40, a72
  v_accvgpr_read_b32 v41, a73
  v_accvgpr_read_b32 v42, a74
  v_accvgpr_read_b32 v43, a75
  v_accvgpr_read_b32 v44, a76
  v_accvgpr_read_b32 v45, a77
  v_accvgpr_read_b32 v46, a78
  v_accvgpr_read_b32 v47, a79
  v_mul_f32 v40, v40, v34
  v_mul_f32 v41, v41, v34
  v_mul_f32 v42, v42, v34
  v_mul_f32 v43, v43, v34
  v_mul_f32 v44, v44, v34
  v_mul_f32 v45, v45, v34
  v_mul_f32 v46, v46, v34
  v_mul_f32 v47, v47, v34
  v_accvgpr_write_b32 a72, v40
  v_accvgpr_write_b32 a73, v41
  v_accvgpr_write_b32 a74, v42
  v_accvgpr_write_b32 a75, v43
  v_accvgpr_write_b32 a76, v44
  v_accvgpr_write_b32 a77, v45
  v_accvgpr_write_b32 a78, v46
  v_accvgpr_write_b32 a79, v47
  v_accvgpr_read_b32 v40, a80
  v_accvgpr_read_b32 v41, a81
  v_accvgpr_read_b32 v42, a82
  v_accvgpr_read_b32 v43, a83
  v_accvgpr_read_b32 v44, a84
  v_accvgpr_read_b32 v45, a85
  v_accvgpr_read_b32 v46, a86
  v_accvgpr_read_b32 v47, a87
  v_mul_f32 v40, v40, v34
  v_mul_f32 v41, v41, v34
  v_mul_f32 v42, v42, v34
  v_mul_f32 v43, v43, v34
  v_mul_f32 v44, v44, v34
  v_mul_f32 v45, v45, v34
  v_mul_f32 v46, v46, v34
  v_mul_f32 v47, v47, v34
  v_accvgpr_write_b32 a80, v40
  v_accvgpr_write_b32 a81, v41
  v_accvgpr_write_b32 a82, v42
  v_accvgpr_write_b32 a83, v43
  v_accvgpr_write_b32 a84, v44
  v_accvgpr_write_b32 a85, v45
  v_accvgpr_write_b32 a86, v46
  v_accvgpr_write_b32 a87, v47
  v_accvgpr_read_b32 v40, a88
  v_accvgpr_read_b32 v41, a89
  v_accvgpr_read_b32 v42, a90
  v_accvgpr_read_b32 v43, a91
  v_accvgpr_read_b32 v44, a92
  v_accvgpr_read_b32 v45, a93
  v_accvgpr_read_b32 v46, a94
  v_accvgpr_read_b32 v47, a95
  v_mul_f32 v40, v40, v34
  v_mul_f32 v41, v41, v34
  v_mul_f32 v42, v42, v34
  v_mul_f32 v43, v43, v34
  v_mul_f32 v44, v44, v34
  v_mul_f32 v45, v45, v34
  v_mul_f32 v46, v46, v34
  v_mul_f32 v47, v47, v34
  v_accvgpr_write_b32 a88, v40
  v_accvgpr_write_b32 a89, v41
  v_accvgpr_write_b32 a90, v42
  v_accvgpr_write_b32 a91, v43
  v_accvgpr_write_b32 a92, v44
  v_accvgpr_write_b32 a93, v45
  v_accvgpr_write_b32 a94, v46
  v_accvgpr_write_b32 a95, v47
  v_accvgpr_read_b32 v40, a96
  v_accvgpr_read_b32 v41, a97
  v_accvgpr_read_b32 v42, a98
  v_accvgpr_read_b32 v43, a99
  v_accvgpr_read_b32 v44, a100
  v_accvgpr_read_b32 v45, a101
  v_accvgpr_read_b32 v46, a102
  v_accvgpr_read_b32 v47, a103
  v_mul_f32 v40, v40, v34
  v_mul_f32 v41, v41, v34
  v_mul_f32 v42, v42, v34
  v_mul_f32 v43, v43, v34
  v_mul_f32 v44, v44, v34
  v_mul_f32 v45, v45, v34
  v_mul_f32 v46, v46, v34
  v_mul_f32 v47, v47, v34
  v_accvgpr_write_b32 a96, v40
  v_accvgpr_write_b32 a97, v41
  v_accvgpr_write_b32 a98, v42
  v_accvgpr_write_b32 a99, v43
  v_accvgpr_write_b32 a100, v44
  v_accvgpr_write_b32 a101, v45
  v_accvgpr_write_b32 a102, v46
  v_accvgpr_write_b32 a103, v47
  v_accvgpr_read_b32 v40, a104
  v_accvgpr_read_b32 v41, a105
  v_accvgpr_read_b32 v42, a106
  v_accvgpr_read_b32 v43, a107
  v_accvgpr_read_b32 v44, a108
  v_accvgpr_read_b32 v45, a109
  v_accvgpr_read_b32 v46, a110
  v_accvgpr_read_b32 v47, a111
  v_mul_f32 v40, v40, v34
  v_mul_f32 v41, v41, v34
  v_mul_f32 v42, v42, v34
  v_mul_f32 v43, v43, v34
  v_mul_f32 v44, v44, v34
  v_mul_f32 v45, v45, v34
  v_mul_f32 v46, v46, v34
  v_mul_f32 v47, v47, v34
  v_accvgpr_write_b32 a104, v40
  v_accvgpr_write_b32 a105, v41
  v_accvgpr_write_b32 a106, v42
  v_accvgpr_write_b32 a107, v43
  v_accvgpr_write_b32 a108, v44
  v_accvgpr_write_b32 a109, v45
  v_accvgpr_write_b32 a110, v46
  v_accvgpr_write_b32 a111, v47
  v_accvgpr_read_b32 v40, a112
  v_accvgpr_read_b32 v41, a113
  v_accvgpr_read_b32 v42, a114
  v_accvgpr_read_b32 v43, a115
  v_accvgpr_read_b32 v44, a116
  v_accvgpr_read_b32 v45, a117
  v_accvgpr_read_b32 v46, a118
  v_accvgpr_read_b32 v47, a119
  v_mul_f32 v40, v40, v34
  v_mul_f32 v41, v41, v34
  v_mul_f32 v42, v42, v34
  v_mul_f32 v43, v43, v34
  v_mul_f32 v44, v44, v34
  v_mul_f32 v45, v45, v34
  v_mul_f32 v46, v46, v34
  v_mul_f32 v47, v47, v34
  v_accvgpr_write_b32 a112, v40
  v_accvgpr_write_b32 a113, v41
  v_accvgpr_write_b32 a114, v42
  v_accvgpr_write_b32 a115, v43
  v_accvgpr_write_b32 a116, v44
  v_accvgpr_write_b32 a117, v45
  v_accvgpr_write_b32 a118, v46
  v_accvgpr_write_b32 a119, v47
  v_accvgpr_read_b32 v40, a120
  v_accvgpr_read_b32 v41, a121
  v_accvgpr_read_b32 v42, a122
  v_accvgpr_read_b32 v43, a123
  v_accvgpr_read_b32 v44, a124
  v_accvgpr_read_b32 v45, a125
  v_accvgpr_read_b32 v46, a126
  v_accvgpr_read_b32 v47, a127
  v_mul_f32 v40, v40, v34
  v_mul_f32 v41, v41, v34
  v_mul_f32 v42, v42, v34
  v_mul_f32 v43, v43, v34
  v_mul_f32 v44, v44, v34
  v_mul_f32 v45, v45, v34
  v_mul_f32 v46, v46, v34
  v_mul_f32 v47, v47, v34
  v_accvgpr_write_b32 a120, v40
  v_accvgpr_write_b32 a121, v41
  v_accvgpr_write_b32 a122, v42
  v_accvgpr_write_b32 a123, v43
  v_accvgpr_write_b32 a124, v44
  v_accvgpr_write_b32 a125, v45
  v_accvgpr_write_b32 a126, v46
  v_accvgpr_write_b32 a127, v47
  s_mov_b32 s42, 0
  s_nop 1
  s_branch L_ret_13
L_mask0_15:
  s_lshl_b32 s52, s32, 6
  v_subrev_u32 v38, s52, v26
  v_cmp_gt_i32 s[56:57], 0, v38
  v_cmp_gt_i32 s[58:59], 1, v38
  v_cmp_gt_i32 s[60:61], 2, v38
  v_cmp_gt_i32 s[62:63], 3, v38
  v_cndmask_b32 v64, v64, v37, s[56:57]
  v_cndmask_b32 v65, v65, v37, s[58:59]
  v_cndmask_b32 v66, v66, v37, s[60:61]
  v_cndmask_b32 v67, v67, v37, s[62:63]
  v_cmp_gt_i32 s[56:57], 8, v38
  v_cmp_gt_i32 s[58:59], 9, v38
  v_cmp_gt_i32 s[60:61], 10, v38
  v_cmp_gt_i32 s[62:63], 11, v38
  v_cndmask_b32 v68, v68, v37, s[56:57]
  v_cndmask_b32 v69, v69, v37, s[58:59]
  v_cndmask_b32 v70, v70, v37, s[60:61]
  v_cndmask_b32 v71, v71, v37, s[62:63]
  v_cmp_gt_i32 s[56:57], 16, v38
  v_cmp_gt_i32 s[58:59], 17, v38
  v_cmp_gt_i32 s[60:61], 18, v38
  v_cmp_gt_i32 s[62:63], 19, v38
  v_cndmask_b32 v72, v72, v37, s[56:57]
  v_cndmask_b32 v73, v73, v37, s[58:59]
  v_cndmask_b32 v74, v74, v37, s[60:61]
  v_cndmask_b32 v75, v75, v37, s[62:63]
  v_cmp_gt_i32 s[56:57], 24, v38
  v_cmp_gt_i32 s[58:59], 25, v38
  v_cmp_gt_i32 s[60:61], 26, v38
  v_cmp_gt_i32 s[62:63], 27, v38
  v_cndmask_b32 v76, v76, v37, s[56:57]
  v_cndmask_b32 v77, v77, v37, s[58:59]
  v_cndmask_b32 v78, v78, v37, s[60:61]
  v_cndmask_b32 v79, v79, v37, s[62:63]
  s_branch L_ret_16
L_mask1_17:
  s_lshl_b32 s52, s32, 6
  v_subrev_u32 v38, s52, v26
  v_cmp_gt_i32 s[56:57], 32, v38
  v_cmp_gt_i32 s[58:59], 33, v38
  v_cmp_gt_i32 s[60:61], 34, v38
  v_cmp_gt_i32 s[62:63], 35, v38
  v_cndmask_b32 v80, v80, v37, s[56:57]
  v_cndmask_b32 v81, v81, v37, s[58:59]
  v_cndmask_b32 v82, v82, v37, s[60:61]
  v_cndmask_b32 v83, v83, v37, s[62:63]
  v_cmp_gt_i32 s[56:57], 40, v38
  v_cmp_gt_i32 s[58:59], 41, v38
  v_cmp_gt_i32 s[60:61], 42, v38
  v_cmp_gt_i32 s[62:63], 43, v38
  v_cndmask_b32 v84, v84, v37, s[56:57]
  v_cndmask_b32 v85, v85, v37, s[58:59]
  v_cndmask_b32 v86, v86, v37, s[60:61]
  v_cndmask_b32 v87, v87, v37, s[62:63]
  v_cmp_gt_i32 s[56:57], 48, v38
  v_cmp_gt_i32 s[58:59], 49, v38
  v_cmp_gt_i32 s[60:61], 50, v38
  v_cmp_gt_i32 s[62:63], 51, v38
  v_cndmask_b32 v88, v88, v37, s[56:57]
  v_cndmask_b32 v89, v89, v37, s[58:59]
  v_cndmask_b32 v90, v90, v37, s[60:61]
  v_cndmask_b32 v91, v91, v37, s[62:63]
  v_cmp_gt_i32 s[56:57], 56, v38
  v_cmp_gt_i32 s[58:59], 57, v38
  v_cmp_gt_i32 s[60:61], 58, v38
  v_cmp_gt_i32 s[62:63], 59, v38
  v_cndmask_b32 v92, v92, v37, s[56:57]
  v_cndmask_b32 v93, v93, v37, s[58:59]
  v_cndmask_b32 v94, v94, v37, s[60:61]
  v_cndmask_b32 v95, v95, v37, s[62:63]
  s_branch L_ret_18
L_rare_19:
  v_mov_b32 v36, v35
  s_nop 1
  v_permlane32_swap_b32 v36, v35
  v_max3_f32 v36, v27, v35, v36
  v_sub_f32 v39, v27, v36
  v_mul_f32 v39, s30, v39
  v_exp_f32 v34, v39
  v_mov_b32 v27, v36
  v_add_f32 v28, 0x42b17218, v36
  v_mul_f32 v29, s30, v36
  v_mul_f32 v30, v30, v34
  v_mul_f32 v31, v31, v34
  v_mul_f32 v32, v32, v34
  v_mul_f32 v33, v33, v34
  s_mov_b32 s42, 1
  s_branch L_ret_20
L_resc_21:
  s_nop 15
  s_nop 15
  v_accvgpr_read_b32 v40, a0
  v_accvgpr_read_b32 v41, a1
  v_accvgpr_read_b32 v42, a2
  v_accvgpr_read_b32 v43, a3
  v_accvgpr_read_b32 v44, a4
  v_accvgpr_read_b32 v45, a5
  v_accvgpr_read_b32 v46, a6
  v_accvgpr_read_b32 v47, a7
  v_mul_f32 v40, v40, v34
  v_mul_f32 v41, v41, v34
  v_mul_f32 v42, v42, v34
  v_mul_f32 v43, v43, v34
  v_mul_f32 v44, v44, v34
  v_mul_f32 v45, v45, v34
  v_mul_f32 v46, v46, v34
  v_mul_f32 v47, v47, v34
  v_accvgpr_write_b32 a0, v40
  v_accvgpr_write_b32 a1, v41
  v_accvgpr_write_b32 a2, v42
  v_accvgpr_write_b32 a3, v43
  v_accvgpr_write_b32 a4, v44
  v_accvgpr_write_b32 a5, v45
  v_accvgpr_write_b32 a6, v46
  v_accvgpr_write_b32 a7, v47
  v_accvgpr_read_b32 v40, a8
  v_accvgpr_read_b32 v41, a9
  v_accvgpr_read_b32 v42, a10
  v_accvgpr_read_b32 v43, a11
  v_accvgpr_read_b32 v44, a12
  v_accvgpr_read_b32 v45, a13
  v_accvgpr_read_b32 v46, a14
  v_accvgpr_read_b32 v47, a15
  v_mul_f32 v40, v40, v34
  v_mul_f32 v41, v41, v34
  v_mul_f32 v42, v42, v34
  v_mul_f32 v43, v43, v34
  v_mul_f32 v44, v44, v34
  v_mul_f32 v45, v45, v34
  v_mul_f32 v46, v46, v34
  v_mul_f32 v47, v47, v34
  v_accvgpr_write_b32 a8, v40
  v_accvgpr_write_b32 a9, v41
  v_accvgpr_write_b32 a10, v42
  v_accvgpr_write_b32 a11, v43
  v_accvgpr_write_b32 a12, v44
  v_accvgpr_write_b32 a13, v45
  v_accvgpr_write_b32 a14, v46
  v_accvgpr_write_b32 a15, v47
  v_accvgpr_read_b32 v40, a16
  v_accvgpr_read_b32 v41, a17
  v_accvgpr_read_b32 v42, a18
  v_accvgpr_read_b32 v43, a19
  v_accvgpr_read_b32 v44, a20
  v_accvgpr_read_b32 v45, a21
  v_accvgpr_read_b32 v46, a22
  v_accvgpr_read_b32 v47, a23
  v_mul_f32 v40, v40, v34
  v_mul_f32 v41, v41, v34
  v_mul_f32 v42, v42, v34
  v_mul_f32 v43, v43, v34
  v_mul_f32 v44, v44, v34
  v_mul_f32 v45, v45, v34
  v_mul_f32 v46, v46, v34
  v_mul_f32 v47, v47, v34
  v_accvgpr_write_b32 a16, v40
  v_accvgpr_write_b32 a17, v41
  v_accvgpr_write_b32 a18, v42
  v_accvgpr_write_b32 a19, v43
  v_accvgpr_write_b32 a20, v44
  v_accvgpr_write_b32 a21, v45
  v_accvgpr_write_b32 a22, v46
  v_accvgpr_write_b32 a23, v47
  v_accvgpr_read_b32 v40, a24
  v_accvgpr_read_b32 v41, a25
  v_accvgpr_read_b32 v42, a26
  v_accvgpr_read_b32 v43, a27
  v_accvgpr_read_b32 v44, a28
  v_accvgpr_read_b32 v45, a29
  v_accvgpr_read_b32 v46, a30
  v_accvgpr_read_b32 v47, a31
  v_mul_f32 v40, v40, v34
  v_mul_f32 v41, v41, v34
  v_mul_f32 v42, v42, v34
  v_mul_f32 v43, v43, v34
  v_mul_f32 v44, v44, v34
  v_mul_f32 v45, v45, v34
  v_mul_f32 v46, v46, v34
  v_mul_f32 v47, v47, v34
  v_accvgpr_write_b32 a24, v40
  v_accvgpr_write_b32 a25, v41
  v_accvgpr_write_b32 a26, v42
  v_accvgpr_write_b32 a27, v43
  v_accvgpr_write_b32 a28, v44
  v_accvgpr_write_b32 a29, v45
  v_accvgpr_write_b32 a30, v46
  v_accvgpr_write_b32 a31, v47
  v_accvgpr_read_b32 v40, a32
  v_accvgpr_read_b32 v41, a33
  v_accvgpr_read_b32 v42, a34
  v_accvgpr_read_b32 v43, a35
  v_accvgpr_read_b32 v44, a36
  v_accvgpr_read_b32 v45, a37
  v_accvgpr_read_b32 v46, a38
  v_accvgpr_read_b32 v47, a39
  v_mul_f32 v40, v40, v34
  v_mul_f32 v41, v41, v34
  v_mul_f32 v42, v42, v34
  v_mul_f32 v43, v43, v34
  v_mul_f32 v44, v44, v34
  v_mul_f32 v45, v45, v34
  v_mul_f32 v46, v46, v34
  v_mul_f32 v47, v47, v34
  v_accvgpr_write_b32 a32, v40
  v_accvgpr_write_b32 a33, v41
  v_accvgpr_write_b32 a34, v42
  v_accvgpr_write_b32 a35, v43
  v_accvgpr_write_b32 a36, v44
  v_accvgpr_write_b32 a37, v45
  v_accvgpr_write_b32 a38, v46
  v_accvgpr_write_b32 a39, v47
  v_accvgpr_read_b32 v40, a40
  v_accvgpr_read_b32 v41, a41
  v_accvgpr_read_b32 v42, a42
  v_accvgpr_read_b32 v43, a43
  v_accvgpr_read_b32 v44, a44
  v_accvgpr_read_b32 v45, a45
  v_accvgpr_read_b32 v46, a46
  v_accvgpr_read_b32 v47, a47
  v_mul_f32 v40, v40, v34
  v_mul_f32 v41, v41, v34
  v_mul_f32 v42, v42, v34
  v_mul_f32 v43, v43, v34
  v_mul_f32 v44, v44, v34
  v_mul_f32 v45, v45, v34
  v_mul_f32 v46, v46, v34
  v_mul_f32 v47, v47, v34
  v_accvgpr_write_b32 a40, v40
  v_accvgpr_write_b32 a41, v41
  v_accvgpr_write_b32 a42, v42
  v_accvgpr_write_b32 a43, v43
  v_accvgpr_write_b32 a44, v44
  v_accvgpr_write_b32 a45, v45
  v_accvgpr_write_b32 a46, v46
  v_accvgpr_write_b32 a47, v47
  v_accvgpr_read_b32 v40, a48
  v_accvgpr_read_b32 v41, a49
  v_accvgpr_read_b32 v42, a50
  v_accvgpr_read_b32 v43, a51
  v_accvgpr_read_b32 v44, a52
  v_accvgpr_read_b32 v45, a53
  v_accvgpr_read_b32 v46, a54
  v_accvgpr_read_b32 v47, a55
  v_mul_f32 v40, v40, v34
  v_mul_f32 v41, v41, v34
  v_mul_f32 v42, v42, v34
  v_mul_f32 v43, v43, v34
  v_mul_f32 v44, v44, v34
  v_mul_f32 v45, v45, v34
  v_mul_f32 v46, v46, v34
  v_mul_f32 v47, v47, v34
  v_accvgpr_write_b32 a48, v40
  v_accvgpr_write_b32 a49, v41
  v_accvgpr_write_b32 a50, v42
  v_accvgpr_write_b32 a51, v43
  v_accvgpr_write_b32 a52, v44
  v_accvgpr_write_b32 a53, v45
  v_accvgpr_write_b32 a54, v46
  v_accvgpr_write_b32 a55, v47
  v_accvgpr_read_b32 v40, a56
  v_accvgpr_read_b32 v41, a57
  v_accvgpr_read_b32 v42, a58
  v_accvgpr_read_b32 v43, a59
  v_accvgpr_read_b32 v44, a60
  v_accvgpr_read_b32 v45, a61
  v_accvgpr_read_b32 v46, a62
  v_accvgpr_read_b32 v47, a63
  v_mul_f32 v40, v40, v34
  v_mul_f32 v41, v41, v34
  v_mul_f32 v42, v42, v34
  v_mul_f32 v43, v43, v34
  v_mul_f32 v44, v44, v34
  v_mul_f32 v45, v45, v34
  v_mul_f32 v46, v46, v34
  v_mul_f32 v47, v47, v34
  v_accvgpr_write_b32 a56, v40
  v_accvgpr_write_b32 a57, v41
  v_accvgpr_write_b32 a58, v42
  v_accvgpr_write_b32 a59, v43
  v_accvgpr_write_b32 a60, v44
  v_accvgpr_write_b32 a61, v45
  v_accvgpr_write_b32 a62, v46
  v_accvgpr_write_b32 a63, v47
  v_accvgpr_read_b32 v40, a64
  v_accvgpr_read_b32 v41, a65
  v_accvgpr_read_b32 v42, a66
  v_accvgpr_read_b32 v43, a67
  v_accvgpr_read_b32 v44, a68
  v_accvgpr_read_b32 v45, a69
  v_accvgpr_read_b32 v46, a70
  v_accvgpr_read_b32 v47, a71
  v_mul_f32 v40, v40, v34
  v_mul_f32 v41, v41, v34
  v_mul_f32 v42, v42, v34
  v_mul_f32 v43, v43, v34
  v_mul_f32 v44, v44, v34
  v_mul_f32 v45, v45, v34
  v_mul_f32 v46, v46, v34
  v_mul_f32 v47, v47, v34
  v_accvgpr_write_b32 a64, v40
  v_accvgpr_write_b32 a65, v41
  v_accvgpr_write_b32 a66, v42
  v_accvgpr_write_b32 a67, v43
  v_accvgpr_write_b32 a68, v44
  v_accvgpr_write_b32 a69, v45
  v_accvgpr_write_b32 a70, v46
  v_accvgpr_write_b32 a71, v47
  v_accvgpr_read_b32 v40, a72
  v_accvgpr_read_b32 v41, a73
  v_accvgpr_read_b32 v42, a74
  v_accvgpr_read_b32 v43, a75
  v_accvgpr_read_b32 v44, a76
  v_accvgpr_read_b32 v45, a77
  v_accvgpr_read_b32 v46, a78
  v_accvgpr_read_b32 v47, a79
  v_mul_f32 v40, v40, v34
  v_mul_f32 v41, v41, v34
  v_mul_f32 v42, v42, v34
  v_mul_f32 v43, v43, v34
  v_mul_f32 v44, v44, v34
  v_mul_f32 v45, v45, v34
  v_mul_f32 v46, v46, v34
  v_mul_f32 v47, v47, v34
  v_accvgpr_write_b32 a72, v40
  v_accvgpr_write_b32 a73, v41
  v_accvgpr_write_b32 a74, v42
  v_accvgpr_write_b32 a75, v43
  v_accvgpr_write_b32 a76, v44
  v_accvgpr_write_b32 a77, v45
  v_accvgpr_write_b32 a78, v46
  v_accvgpr_write_b32 a79, v47
  v_accvgpr_read_b32 v40, a80
  v_accvgpr_read_b32 v41, a81
  v_accvgpr_read_b32 v42, a82
  v_accvgpr_read_b32 v43, a83
  v_accvgpr_read_b32 v44, a84
  v_accvgpr_read_b32 v45, a85
  v_accvgpr_read_b32 v46, a86
  v_accvgpr_read_b32 v47, a87
  v_mul_f32 v40, v40, v34
  v_mul_f32 v41, v41, v34
  v_mul_f32 v42, v42, v34
  v_mul_f32 v43, v43, v34
  v_mul_f32 v44, v44, v34
  v_mul_f32 v45, v45, v34
  v_mul_f32 v46, v46, v34
  v_mul_f32 v47, v47, v34
  v_accvgpr_write_b32 a80, v40
  v_accvgpr_write_b32 a81, v41
  v_accvgpr_write_b32 a82, v42
  v_accvgpr_write_b32 a83, v43
  v_accvgpr_write_b32 a84, v44
  v_accvgpr_write_b32 a85, v45
  v_accvgpr_write_b32 a86, v46
  v_accvgpr_write_b32 a87, v47
  v_accvgpr_read_b32 v40, a88
  v_accvgpr_read_b32 v41, a89
  v_accvgpr_read_b32 v42, a90
  v_accvgpr_read_b32 v43, a91
  v_accvgpr_read_b32 v44, a92
  v_accvgpr_read_b32 v45, a93
  v_accvgpr_read_b32 v46, a94
  v_accvgpr_read_b32 v47, a95
  v_mul_f32 v40, v40, v34
  v_mul_f32 v41, v41, v34
  v_mul_f32 v42, v42, v34
  v_mul_f32 v43, v43, v34
  v_mul_f32 v44, v44, v34
  v_mul_f32 v45, v45, v34
  v_mul_f32 v46, v46, v34
  v_mul_f32 v47, v47, v34
  v_accvgpr_write_b32 a88, v40
  v_accvgpr_write_b32 a89, v41
  v_accvgpr_write_b32 a90, v42
  v_accvgpr_write_b32 a91, v43
  v_accvgpr_write_b32 a92, v44
  v_accvgpr_write_b32 a93, v45
  v_accvgpr_write_b32 a94, v46
  v_accvgpr_write_b32 a95, v47
  v_accvgpr_read_b32 v40, a96
  v_accvgpr_read_b32 v41, a97
  v_accvgpr_read_b32 v42, a98
  v_accvgpr_read_b32 v43, a99
  v_accvgpr_read_b32 v44, a100
  v_accvgpr_read_b32 v45, a101
  v_accvgpr_read_b32 v46, a102
  v_accvgpr_read_b32 v47, a103
  v_mul_f32 v40, v40, v34
  v_mul_f32 v41, v41, v34
  v_mul_f32 v42, v42, v34
  v_mul_f32 v43, v43, v34
  v_mul_f32 v44, v44, v34
  v_mul_f32 v45, v45, v34
  v_mul_f32 v46, v46, v34
  v_mul_f32 v47, v47, v34
  v_accvgpr_write_b32 a96, v40
  v_accvgpr_write_b32 a97, v41
  v_accvgpr_write_b32 a98, v42
  v_accvgpr_write_b32 a99, v43
  v_accvgpr_write_b32 a100, v44
  v_accvgpr_write_b32 a101, v45
  v_accvgpr_write_b32 a102, v46
  v_accvgpr_write_b32 a103, v47
  v_accvgpr_read_b32 v40, a104
  v_accvgpr_read_b32 v41, a105
  v_accvgpr_read_b32 v42, a106
  v_accvgpr_read_b32 v43, a107
  v_accvgpr_read_b32 v44, a108
  v_accvgpr_read_b32 v45, a109
  v_accvgpr_read_b32 v46, a110
  v_accvgpr_read_b32 v47, a111
  v_mul_f32 v40, v40, v34
  v_mul_f32 v41, v41, v34
  v_mul_f32 v42, v42, v34
  v_mul_f32 v43, v43, v34
  v_mul_f32 v44, v44, v34
  v_mul_f32 v45, v45, v34
  v_mul_f32 v46, v46, v34
  v_mul_f32 v47, v47, v34
  v_accvgpr_write_b32 a104, v40
  v_accvgpr_write_b32 a105, v41
  v_accvgpr_write_b32 a106, v42
  v_accvgpr_write_b32 a107, v43
  v_accvgpr_write_b32 a108, v44
  v_accvgpr_write_b32 a109, v45
  v_accvgpr_write_b32 a110, v46
  v_accvgpr_write_b32 a111, v47
  v_accvgpr_read_b32 v40, a112
  v_accvgpr_read_b32 v41, a113
  v_accvgpr_read_b32 v42, a114
  v_accvgpr_read_b32 v43, a115
  v_accvgpr_read_b32 v44, a116
  v_accvgpr_read_b32 v45, a117
  v_accvgpr_read_b32 v46, a118
  v_accvgpr_read_b32 v47, a119
  v_mul_f32 v40, v40, v34
  v_mul_f32 v41, v41, v34
  v_mul_f32 v42, v42, v34
  v_mul_f32 v43, v43, v34
  v_mul_f32 v44, v44, v34
  v_mul_f32 v45, v45, v34
  v_mul_f32 v46, v46, v34
  v_mul_f32 v47, v47, v34
  v_accvgpr_write_b32 a112, v40
  v_accvgpr_write_b32 a113, v41
  v_accvgpr_write_b32 a114, v42
  v_accvgpr_write_b32 a115, v43
  v_accvgpr_write_b32 a116, v44
  v_accvgpr_write_b32 a117, v45
  v_accvgpr_write_b32 a118, v46
  v_accvgpr_write_b32 a119, v47
  v_accvgpr_read_b32 v40, a120
  v_accvgpr_read_b32 v41, a121
  v_accvgpr_read_b32 v42, a122
  v_accvgpr_read_b32 v43, a123
  v_accvgpr_read_b32 v44, a124
  v_accvgpr_read_b32 v45, a125
  v_accvgpr_read_b32 v46, a126
  v_accvgpr_read_b32 v47, a127
  v_mul_f32 v40, v40, v34
  v_mul_f32 v41, v41, v34
  v_mul_f32 v42, v42, v34
  v_mul_f32 v43, v43, v34
  v_mul_f32 v44, v44, v34
  v_mul_f32 v45, v45, v34
  v_mul_f32 v46, v46, v34
  v_mul_f32 v47, v47, v34
  v_accvgpr_write_b32 a120, v40
  v_accvgpr_write_b32 a121, v41
  v_accvgpr_write_b32 a122, v42
  v_accvgpr_write_b32 a123, v43
  v_accvgpr_write_b32 a124, v44
  v_accvgpr_write_b32 a125, v45
  v_accvgpr_write_b32 a126, v46
  v_accvgpr_write_b32 a127, v47
  s_mov_b32 s42, 0
  s_nop 1
  s_branch L_ret_22
L_resc_23:
  s_nop 15
  s_nop 15
  v_accvgpr_read_b32 v40, a0
  v_accvgpr_read_b32 v41, a1
  v_accvgpr_read_b32 v42, a2
  v_accvgpr_read_b32 v43, a3
  v_accvgpr_read_b32 v44, a4
  v_accvgpr_read_b32 v45, a5
  v_accvgpr_read_b32 v46, a6
  v_accvgpr_read_b32 v47, a7
  v_mul_f32 v40, v40, v34
  v_mul_f32 v41, v41, v34
  v_mul_f32 v42, v42, v34
  v_mul_f32 v43, v43, v34
  v_mul_f32 v44, v44, v34
  v_mul_f32 v45, v45, v34
  v_mul_f32 v46, v46, v34
  v_mul_f32 v47, v47, v34
  v_accvgpr_write_b32 a0, v40
  v_accvgpr_write_b32 a1, v41
  v_accvgpr_write_b32 a2, v42
  v_accvgpr_write_b32 a3, v43
  v_accvgpr_write_b32 a4, v44
  v_accvgpr_write_b32 a5, v45
  v_accvgpr_write_b32 a6, v46
  v_accvgpr_write_b32 a7, v47
  v_accvgpr_read_b32 v40, a8
  v_accvgpr_read_b32 v41, a9
  v_accvgpr_read_b32 v42, a10
  v_accvgpr_read_b32 v43, a11
  v_accvgpr_read_b32 v44, a12
  v_accvgpr_read_b32 v45, a13
  v_accvgpr_read_b32 v46, a14
  v_accvgpr_read_b32 v47, a15
  v_mul_f32 v40, v40, v34
  v_mul_f32 v41, v41, v34
  v_mul_f32 v42, v42, v34
  v_mul_f32 v43, v43, v34
  v_mul_f32 v44, v44, v34
  v_mul_f32 v45, v45, v34
  v_mul_f32 v46, v46, v34
  v_mul_f32 v47, v47, v34
  v_accvgpr_write_b32 a8, v40
  v_accvgpr_write_b32 a9, v41
  v_accvgpr_write_b32 a10, v42
  v_accvgpr_write_b32 a11, v43
  v_accvgpr_write_b32 a12, v44
  v_accvgpr_write_b32 a13, v45
  v_accvgpr_write_b32 a14, v46
  v_accvgpr_write_b32 a15, v47
  v_accvgpr_read_b32 v40, a16
  v_accvgpr_read_b32 v41, a17
  v_accvgpr_read_b32 v42, a18
  v_accvgpr_read_b32 v43, a19
  v_accvgpr_read_b32 v44, a20
  v_accvgpr_read_b32 v45, a21
  v_accvgpr_read_b32 v46, a22
  v_accvgpr_read_b32 v47, a23
  v_mul_f32 v40, v40, v34
  v_mul_f32 v41, v41, v34
  v_mul_f32 v42, v42, v34
  v_mul_f32 v43, v43, v34
  v_mul_f32 v44, v44, v34
  v_mul_f32 v45, v45, v34
  v_mul_f32 v46, v46, v34
  v_mul_f32 v47, v47, v34
  v_accvgpr_write_b32 a16, v40
  v_accvgpr_write_b32 a17, v41
  v_accvgpr_write_b32 a18, v42
  v_accvgpr_write_b32 a19, v43
  v_accvgpr_write_b32 a20, v44
  v_accvgpr_write_b32 a21, v45
  v_accvgpr_write_b32 a22, v46
  v_accvgpr_write_b32 a23, v47
  v_accvgpr_read_b32 v40, a24
  v_accvgpr_read_b32 v41, a25
  v_accvgpr_read_b32 v42, a26
  v_accvgpr_read_b32 v43, a27
  v_accvgpr_read_b32 v44, a28
  v_accvgpr_read_b32 v45, a29
  v_accvgpr_read_b32 v46, a30
  v_accvgpr_read_b32 v47, a31
  v_mul_f32 v40, v40, v34
  v_mul_f32 v41, v41, v34
  v_mul_f32 v42, v42, v34
  v_mul_f32 v43, v43, v34
  v_mul_f32 v44, v44, v34
  v_mul_f32 v45, v45, v34
  v_mul_f32 v46, v46, v34
  v_mul_f32 v47, v47, v34
  v_accvgpr_write_b32 a24, v40
  v_accvgpr_write_b32 a25, v41
  v_accvgpr_write_b32 a26, v42
  v_accvgpr_write_b32 a27, v43
  v_accvgpr_write_b32 a28, v44
  v_accvgpr_write_b32 a29, v45
  v_accvgpr_write_b32 a30, v46
  v_accvgpr_write_b32 a31, v47
  v_accvgpr_read_b32 v40, a32
  v_accvgpr_read_b32 v41, a33
  v_accvgpr_read_b32 v42, a34
  v_accvgpr_read_b32 v43, a35
  v_accvgpr_read_b32 v44, a36
  v_accvgpr_read_b32 v45, a37
  v_accvgpr_read_b32 v46, a38
  v_accvgpr_read_b32 v47, a39
  v_mul_f32 v40, v40, v34
  v_mul_f32 v41, v41, v34
  v_mul_f32 v42, v42, v34
  v_mul_f32 v43, v43, v34
  v_mul_f32 v44, v44, v34
  v_mul_f32 v45, v45, v34
  v_mul_f32 v46, v46, v34
  v_mul_f32 v47, v47, v34
  v_accvgpr_write_b32 a32, v40
  v_accvgpr_write_b32 a33, v41
  v_accvgpr_write_b32 a34, v42
  v_accvgpr_write_b32 a35, v43
  v_accvgpr_write_b32 a36, v44
  v_accvgpr_write_b32 a37, v45
  v_accvgpr_write_b32 a38, v46
  v_accvgpr_write_b32 a39, v47
  v_accvgpr_read_b32 v40, a40
  v_accvgpr_read_b32 v41, a41
  v_accvgpr_read_b32 v42, a42
  v_accvgpr_read_b32 v43, a43
  v_accvgpr_read_b32 v44, a44
  v_accvgpr_read_b32 v45, a45
  v_accvgpr_read_b32 v46, a46
  v_accvgpr_read_b32 v47, a47
  v_mul_f32 v40, v40, v34
  v_mul_f32 v41, v41, v34
  v_mul_f32 v42, v42, v34
  v_mul_f32 v43, v43, v34
  v_mul_f32 v44, v44, v34
  v_mul_f32 v45, v45, v34
  v_mul_f32 v46, v46, v34
  v_mul_f32 v47, v47, v34
  v_accvgpr_write_b32 a40, v40
  v_accvgpr_write_b32 a41, v41
  v_accvgpr_write_b32 a42, v42
  v_accvgpr_write_b32 a43, v43
  v_accvgpr_write_b32 a44, v44
  v_accvgpr_write_b32 a45, v45
  v_accvgpr_write_b32 a46, v46
  v_accvgpr_write_b32 a47, v47
  v_accvgpr_read_b32 v40, a48
  v_accvgpr_read_b32 v41, a49
  v_accvgpr_read_b32 v42, a50
  v_accvgpr_read_b32 v43, a51
  v_accvgpr_read_b32 v44, a52
  v_accvgpr_read_b32 v45, a53
  v_accvgpr_read_b32 v46, a54
  v_accvgpr_read_b32 v47, a55
  v_mul_f32 v40, v40, v34
  v_mul_f32 v41, v41, v34
  v_mul_f32 v42, v42, v34
  v_mul_f32 v43, v43, v34
  v_mul_f32 v44, v44, v34
  v_mul_f32 v45, v45, v34
  v_mul_f32 v46, v46, v34
  v_mul_f32 v47, v47, v34
  v_accvgpr_write_b32 a48, v40
  v_accvgpr_write_b32 a49, v41
  v_accvgpr_write_b32 a50, v42
  v_accvgpr_write_b32 a51, v43
  v_accvgpr_write_b32 a52, v44
  v_accvgpr_write_b32 a53, v45
  v_accvgpr_write_b32 a54, v46
  v_accvgpr_write_b32 a55, v47
  v_accvgpr_read_b32 v40, a56
  v_accvgpr_read_b32 v41, a57
  v_accvgpr_read_b32 v42, a58
  v_accvgpr_read_b32 v43, a59
  v_accvgpr_read_b32 v44, a60
  v_accvgpr_read_b32 v45, a61
  v_accvgpr_read_b32 v46, a62
  v_accvgpr_read_b32 v47, a63
  v_mul_f32 v40, v40, v34
  v_mul_f32 v41, v41, v34
  v_mul_f32 v42, v42, v34
  v_mul_f32 v43, v43, v34
  v_mul_f32 v44, v44, v34
  v_mul_f32 v45, v45, v34
  v_mul_f32 v46, v46, v34
  v_mul_f32 v47, v47, v34
  v_accvgpr_write_b32 a56, v40
  v_accvgpr_write_b32 a57, v41
  v_accvgpr_write_b32 a58, v42
  v_accvgpr_write_b32 a59, v43
  v_accvgpr_write_b32 a60, v44
  v_accvgpr_write_b32 a61, v45
  v_accvgpr_write_b32 a62, v46
  v_accvgpr_write_b32 a63, v47
  v_accvgpr_read_b32 v40, a64
  v_accvgpr_read_b32 v41, a65
  v_accvgpr_read_b32 v42, a66
  v_accvgpr_read_b32 v43, a67
  v_accvgpr_read_b32 v44, a68
  v_accvgpr_read_b32 v45, a69
  v_accvgpr_read_b32 v46, a70
  v_accvgpr_read_b32 v47, a71
  v_mul_f32 v40, v40, v34
  v_mul_f32 v41, v41, v34
  v_mul_f32 v42, v42, v34
  v_mul_f32 v43, v43, v34
  v_mul_f32 v44, v44, v34
  v_mul_f32 v45, v45, v34
  v_mul_f32 v46, v46, v34
  v_mul_f32 v47, v47, v34
  v_accvgpr_write_b32 a64, v40
  v_accvgpr_write_b32 a65, v41
  v_accvgpr_write_b32 a66, v42
  v_accvgpr_write_b32 a67, v43
  v_accvgpr_write_b32 a68, v44
  v_accvgpr_write_b32 a69, v45
  v_accvgpr_write_b32 a70, v46
  v_accvgpr_write_b32 a71, v47
  v_accvgpr_read_b32 v40, a72
  v_accvgpr_read_b32 v41, a73
  v_accvgpr_read_b32 v42, a74
  v_accvgpr_read_b32 v43, a75
  v_accvgpr_read_b32 v44, a76
  v_accvgpr_read_b32 v45, a77
  v_accvgpr_read_b32 v46, a78
  v_accvgpr_read_b32 v47, a79
  v_mul_f32 v40, v40, v34
  v_mul_f32 v41, v41, v34
  v_mul_f32 v42, v42, v34
  v_mul_f32 v43, v43, v34
  v_mul_f32 v44, v44, v34
  v_mul_f32 v45, v45, v34
  v_mul_f32 v46, v46, v34
  v_mul_f32 v47, v47, v34
  v_accvgpr_write_b32 a72, v40
  v_accvgpr_write_b32 a73, v41
  v_accvgpr_write_b32 a74, v42
  v_accvgpr_write_b32 a75, v43
  v_accvgpr_write_b32 a76, v44
  v_accvgpr_write_b32 a77, v45
  v_accvgpr_write_b32 a78, v46
  v_accvgpr_write_b32 a79, v47
  v_accvgpr_read_b32 v40, a80
  v_accvgpr_read_b32 v41, a81
  v_accvgpr_read_b32 v42, a82
  v_accvgpr_read_b32 v43, a83
  v_accvgpr_read_b32 v44, a84
  v_accvgpr_read_b32 v45, a85
  v_accvgpr_read_b32 v46, a86
  v_accvgpr_read_b32 v47, a87
  v_mul_f32 v40, v40, v34
  v_mul_f32 v41, v41, v34
  v_mul_f32 v42, v42, v34
  v_mul_f32 v43, v43, v34
  v_mul_f32 v44, v44, v34
  v_mul_f32 v45, v45, v34
  v_mul_f32 v46, v46, v34
  v_mul_f32 v47, v47, v34
  v_accvgpr_write_b32 a80, v40
  v_accvgpr_write_b32 a81, v41
  v_accvgpr_write_b32 a82, v42
  v_accvgpr_write_b32 a83, v43
  v_accvgpr_write_b32 a84, v44
  v_accvgpr_write_b32 a85, v45
  v_accvgpr_write_b32 a86, v46
  v_accvgpr_write_b32 a87, v47
  v_accvgpr_read_b32 v40, a88
  v_accvgpr_read_b32 v41, a89
  v_accvgpr_read_b32 v42, a90
  v_accvgpr_read_b32 v43, a91
  v_accvgpr_read_b32 v44, a92
  v_accvgpr_read_b32 v45, a93
  v_accvgpr_read_b32 v46, a94
  v_accvgpr_read_b32 v47, a95
  v_mul_f32 v40, v40, v34
  v_mul_f32 v41, v41, v34
  v_mul_f32 v42, v42, v34
  v_mul_f32 v43, v43, v34
  v_mul_f32 v44, v44, v34
  v_mul_f32 v45, v45, v34
  v_mul_f32 v46, v46, v34
  v_mul_f32 v47, v47, v34
  v_accvgpr_write_b32 a88, v40
  v_accvgpr_write_b32 a89, v41
  v_accvgpr_write_b32 a90, v42
  v_accvgpr_write_b32 a91, v43
  v_accvgpr_write_b32 a92, v44
  v_accvgpr_write_b32 a93, v45
  v_accvgpr_write_b32 a94, v46
  v_accvgpr_write_b32 a95, v47
  v_accvgpr_read_b32 v40, a96
  v_accvgpr_read_b32 v41, a97
  v_accvgpr_read_b32 v42, a98
  v_accvgpr_read_b32 v43, a99
  v_accvgpr_read_b32 v44, a100
  v_accvgpr_read_b32 v45, a101
  v_accvgpr_read_b32 v46, a102
  v_accvgpr_read_b32 v47, a103
  v_mul_f32 v40, v40, v34
  v_mul_f32 v41, v41, v34
  v_mul_f32 v42, v42, v34
  v_mul_f32 v43, v43, v34
  v_mul_f32 v44, v44, v34
  v_mul_f32 v45, v45, v34
  v_mul_f32 v46, v46, v34
  v_mul_f32 v47, v47, v34
  v_accvgpr_write_b32 a96, v40
  v_accvgpr_write_b32 a97, v41
  v_accvgpr_write_b32 a98, v42
  v_accvgpr_write_b32 a99, v43
  v_accvgpr_write_b32 a100, v44
  v_accvgpr_write_b32 a101, v45
  v_accvgpr_write_b32 a102, v46
  v_accvgpr_write_b32 a103, v47
  v_accvgpr_read_b32 v40, a104
  v_accvgpr_read_b32 v41, a105
  v_accvgpr_read_b32 v42, a106
  v_accvgpr_read_b32 v43, a107
  v_accvgpr_read_b32 v44, a108
  v_accvgpr_read_b32 v45, a109
  v_accvgpr_read_b32 v46, a110
  v_accvgpr_read_b32 v47, a111
  v_mul_f32 v40, v40, v34
  v_mul_f32 v41, v41, v34
  v_mul_f32 v42, v42, v34
  v_mul_f32 v43, v43, v34
  v_mul_f32 v44, v44, v34
  v_mul_f32 v45, v45, v34
  v_mul_f32 v46, v46, v34
  v_mul_f32 v47, v47, v34
  v_accvgpr_write_b32 a104, v40
  v_accvgpr_write_b32 a105, v41
  v_accvgpr_write_b32 a106, v42
  v_accvgpr_write_b32 a107, v43
  v_accvgpr_write_b32 a108, v44
  v_accvgpr_write_b32 a109, v45
  v_accvgpr_write_b32 a110, v46
  v_accvgpr_write_b32 a111, v47
  v_accvgpr_read_b32 v40, a112
  v_accvgpr_read_b32 v41, a113
  v_accvgpr_read_b32 v42, a114
  v_accvgpr_read_b32 v43, a115
  v_accvgpr_read_b32 v44, a116
  v_accvgpr_read_b32 v45, a117
  v_accvgpr_read_b32 v46, a118
  v_accvgpr_read_b32 v47, a119
  v_mul_f32 v40, v40, v34
  v_mul_f32 v41, v41, v34
  v_mul_f32 v42, v42, v34
  v_mul_f32 v43, v43, v34
  v_mul_f32 v44, v44, v34
  v_mul_f32 v45, v45, v34
  v_mul_f32 v46, v46, v34
  v_mul_f32 v47, v47, v34
  v_accvgpr_write_b32 a112, v40
  v_accvgpr_write_b32 a113, v41
  v_accvgpr_write_b32 a114, v42
  v_accvgpr_write_b32 a115, v43
  v_accvgpr_write_b32 a116, v44
  v_accvgpr_write_b32 a117, v45
  v_accvgpr_write_b32 a118, v46
  v_accvgpr_write_b32 a119, v47
  v_accvgpr_read_b32 v40, a120
  v_accvgpr_read_b32 v41, a121
  v_accvgpr_read_b32 v42, a122
  v_accvgpr_read_b32 v43, a123
  v_accvgpr_read_b32 v44, a124
  v_accvgpr_read_b32 v45, a125
  v_accvgpr_read_b32 v46, a126
  v_accvgpr_read_b32 v47, a127
  v_mul_f32 v40, v40, v34
  v_mul_f32 v41, v41, v34
  v_mul_f32 v42, v42, v34
  v_mul_f32 v43, v43, v34
  v_mul_f32 v44, v44, v34
  v_mul_f32 v45, v45, v34
  v_mul_f32 v46, v46, v34
  v_mul_f32 v47, v47, v34
  v_accvgpr_write_b32 a120, v40
  v_accvgpr_write_b32 a121, v41
  v_accvgpr_write_b32 a122, v42
  v_accvgpr_write_b32 a123, v43
  v_accvgpr_write_b32 a124, v44
  v_accvgpr_write_b32 a125, v45
  v_accvgpr_write_b32 a126, v46
  v_accvgpr_write_b32 a127, v47
  s_mov_b32 s42, 0
  s_nop 1
  s_branch L_ret_24
L_resc_26:
  s_nop 15
  s_nop 15
  v_accvgpr_read_b32 v40, a0
  v_accvgpr_read_b32 v41, a1
  v_accvgpr_read_b32 v42, a2
  v_accvgpr_read_b32 v43, a3
  v_accvgpr_read_b32 v44, a4
  v_accvgpr_read_b32 v45, a5
  v_accvgpr_read_b32 v46, a6
  v_accvgpr_read_b32 v47, a7
  v_mul_f32 v40, v40, v34
  v_mul_f32 v41, v41, v34
  v_mul_f32 v42, v42, v34
  v_mul_f32 v43, v43, v34
  v_mul_f32 v44, v44, v34
  v_mul_f32 v45, v45, v34
  v_mul_f32 v46, v46, v34
  v_mul_f32 v47, v47, v34
  v_accvgpr_write_b32 a0, v40
  v_accvgpr_write_b32 a1, v41
  v_accvgpr_write_b32 a2, v42
  v_accvgpr_write_b32 a3, v43
  v_accvgpr_write_b32 a4, v44
  v_accvgpr_write_b32 a5, v45
  v_accvgpr_write_b32 a6, v46
  v_accvgpr_write_b32 a7, v47
  v_accvgpr_read_b32 v40, a8
  v_accvgpr_read_b32 v41, a9
  v_accvgpr_read_b32 v42, a10
  v_accvgpr_read_b32 v43, a11
  v_accvgpr_read_b32 v44, a12
  v_accvgpr_read_b32 v45, a13
  v_accvgpr_read_b32 v46, a14
  v_accvgpr_read_b32 v47, a15
  v_mul_f32 v40, v40, v34
  v_mul_f32 v41, v41, v34
  v_mul_f32 v42, v42, v34
  v_mul_f32 v43, v43, v34
  v_mul_f32 v44, v44, v34
  v_mul_f32 v45, v45, v34
  v_mul_f32 v46, v46, v34
  v_mul_f32 v47, v47, v34
  v_accvgpr_write_b32 a8, v40
  v_accvgpr_write_b32 a9, v41
  v_accvgpr_write_b32 a10, v42
  v_accvgpr_write_b32 a11, v43
  v_accvgpr_write_b32 a12, v44
  v_accvgpr_write_b32 a13, v45
  v_accvgpr_write_b32 a14, v46
  v_accvgpr_write_b32 a15, v47
  v_accvgpr_read_b32 v40, a16
  v_accvgpr_read_b32 v41, a17
  v_accvgpr_read_b32 v42, a18
  v_accvgpr_read_b32 v43, a19
  v_accvgpr_read_b32 v44, a20
  v_accvgpr_read_b32 v45, a21
  v_accvgpr_read_b32 v46, a22
  v_accvgpr_read_b32 v47, a23
  v_mul_f32 v40, v40, v34
  v_mul_f32 v41, v41, v34
  v_mul_f32 v42, v42, v34
  v_mul_f32 v43, v43, v34
  v_mul_f32 v44, v44, v34
  v_mul_f32 v45, v45, v34
  v_mul_f32 v46, v46, v34
  v_mul_f32 v47, v47, v34
  v_accvgpr_write_b32 a16, v40
  v_accvgpr_write_b32 a17, v41
  v_accvgpr_write_b32 a18, v42
  v_accvgpr_write_b32 a19, v43
  v_accvgpr_write_b32 a20, v44
  v_accvgpr_write_b32 a21, v45
  v_accvgpr_write_b32 a22, v46
  v_accvgpr_write_b32 a23, v47
  v_accvgpr_read_b32 v40, a24
  v_accvgpr_read_b32 v41, a25
  v_accvgpr_read_b32 v42, a26
  v_accvgpr_read_b32 v43, a27
  v_accvgpr_read_b32 v44, a28
  v_accvgpr_read_b32 v45, a29
  v_accvgpr_read_b32 v46, a30
  v_accvgpr_read_b32 v47, a31
  v_mul_f32 v40, v40, v34
  v_mul_f32 v41, v41, v34
  v_mul_f32 v42, v42, v34
  v_mul_f32 v43, v43, v34
  v_mul_f32 v44, v44, v34
  v_mul_f32 v45, v45, v34
  v_mul_f32 v46, v46, v34
  v_mul_f32 v47, v47, v34
  v_accvgpr_write_b32 a24, v40
  v_accvgpr_write_b32 a25, v41
  v_accvgpr_write_b32 a26, v42
  v_accvgpr_write_b32 a27, v43
  v_accvgpr_write_b32 a28, v44
  v_accvgpr_write_b32 a29, v45
  v_accvgpr_write_b32 a30, v46
  v_accvgpr_write_b32 a31, v47
  v_accvgpr_read_b32 v40, a32
  v_accvgpr_read_b32 v41, a33
  v_accvgpr_read_b32 v42, a34
  v_accvgpr_read_b32 v43, a35
  v_accvgpr_read_b32 v44, a36
  v_accvgpr_read_b32 v45, a37
  v_accvgpr_read_b32 v46, a38
  v_accvgpr_read_b32 v47, a39
  v_mul_f32 v40, v40, v34
  v_mul_f32 v41, v41, v34
  v_mul_f32 v42, v42, v34
  v_mul_f32 v43, v43, v34
  v_mul_f32 v44, v44, v34
  v_mul_f32 v45, v45, v34
  v_mul_f32 v46, v46, v34
  v_mul_f32 v47, v47, v34
  v_accvgpr_write_b32 a32, v40
  v_accvgpr_write_b32 a33, v41
  v_accvgpr_write_b32 a34, v42
  v_accvgpr_write_b32 a35, v43
  v_accvgpr_write_b32 a36, v44
  v_accvgpr_write_b32 a37, v45
  v_accvgpr_write_b32 a38, v46
  v_accvgpr_write_b32 a39, v47
  v_accvgpr_read_b32 v40, a40
  v_accvgpr_read_b32 v41, a41
  v_accvgpr_read_b32 v42, a42
  v_accvgpr_read_b32 v43, a43
  v_accvgpr_read_b32 v44, a44
  v_accvgpr_read_b32 v45, a45
  v_accvgpr_read_b32 v46, a46
  v_accvgpr_read_b32 v47, a47
  v_mul_f32 v40, v40, v34
  v_mul_f32 v41, v41, v34
  v_mul_f32 v42, v42, v34
  v_mul_f32 v43, v43, v34
  v_mul_f32 v44, v44, v34
  v_mul_f32 v45, v45, v34
  v_mul_f32 v46, v46, v34
  v_mul_f32 v47, v47, v34
  v_accvgpr_write_b32 a40, v40
  v_accvgpr_write_b32 a41, v41
  v_accvgpr_write_b32 a42, v42
  v_accvgpr_write_b32 a43, v43
  v_accvgpr_write_b32 a44, v44
  v_accvgpr_write_b32 a45, v45
  v_accvgpr_write_b32 a46, v46
  v_accvgpr_write_b32 a47, v47
  v_accvgpr_read_b32 v40, a48
  v_accvgpr_read_b32 v41, a49
  v_accvgpr_read_b32 v42, a50
  v_accvgpr_read_b32 v43, a51
  v_accvgpr_read_b32 v44, a52
  v_accvgpr_read_b32 v45, a53
  v_accvgpr_read_b32 v46, a54
  v_accvgpr_read_b32 v47, a55
  v_mul_f32 v40, v40, v34
  v_mul_f32 v41, v41, v34
  v_mul_f32 v42, v42, v34
  v_mul_f32 v43, v43, v34
  v_mul_f32 v44, v44, v34
  v_mul_f32 v45, v45, v34
  v_mul_f32 v46, v46, v34
  v_mul_f32 v47, v47, v34
  v_accvgpr_write_b32 a48, v40
  v_accvgpr_write_b32 a49, v41
  v_accvgpr_write_b32 a50, v42
  v_accvgpr_write_b32 a51, v43
  v_accvgpr_write_b32 a52, v44
  v_accvgpr_write_b32 a53, v45
  v_accvgpr_write_b32 a54, v46
  v_accvgpr_write_b32 a55, v47
  v_accvgpr_read_b32 v40, a56
  v_accvgpr_read_b32 v41, a57
  v_accvgpr_read_b32 v42, a58
  v_accvgpr_read_b32 v43, a59
  v_accvgpr_read_b32 v44, a60
  v_accvgpr_read_b32 v45, a61
  v_accvgpr_read_b32 v46, a62
  v_accvgpr_read_b32 v47, a63
  v_mul_f32 v40, v40, v34
  v_mul_f32 v41, v41, v34
  v_mul_f32 v42, v42, v34
  v_mul_f32 v43, v43, v34
  v_mul_f32 v44, v44, v34
  v_mul_f32 v45, v45, v34
  v_mul_f32 v46, v46, v34
  v_mul_f32 v47, v47, v34
  v_accvgpr_write_b32 a56, v40
  v_accvgpr_write_b32 a57, v41
  v_accvgpr_write_b32 a58, v42
  v_accvgpr_write_b32 a59, v43
  v_accvgpr_write_b32 a60, v44
  v_accvgpr_write_b32 a61, v45
  v_accvgpr_write_b32 a62, v46
  v_accvgpr_write_b32 a63, v47
  v_accvgpr_read_b32 v40, a64
  v_accvgpr_read_b32 v41, a65
  v_accvgpr_read_b32 v42, a66
  v_accvgpr_read_b32 v43, a67
  v_accvgpr_read_b32 v44, a68
  v_accvgpr_read_b32 v45, a69
  v_accvgpr_read_b32 v46, a70
  v_accvgpr_read_b32 v47, a71
  v_mul_f32 v40, v40, v34
  v_mul_f32 v41, v41, v34
  v_mul_f32 v42, v42, v34
  v_mul_f32 v43, v43, v34
  v_mul_f32 v44, v44, v34
  v_mul_f32 v45, v45, v34
  v_mul_f32 v46, v46, v34
  v_mul_f32 v47, v47, v34
  v_accvgpr_write_b32 a64, v40
  v_accvgpr_write_b32 a65, v41
  v_accvgpr_write_b32 a66, v42
  v_accvgpr_write_b32 a67, v43
  v_accvgpr_write_b32 a68, v44
  v_accvgpr_write_b32 a69, v45
  v_accvgpr_write_b32 a70, v46
  v_accvgpr_write_b32 a71, v47
  v_accvgpr_read_b32 v40, a72
  v_accvgpr_read_b32 v41, a73
  v_accvgpr_read_b32 v42, a74
  v_accvgpr_read_b32 v43, a75
  v_accvgpr_read_b32 v44, a76
  v_accvgpr_read_b32 v45, a77
  v_accvgpr_read_b32 v46, a78
  v_accvgpr_read_b32 v47, a79
  v_mul_f32 v40, v40, v34
  v_mul_f32 v41, v41, v34
  v_mul_f32 v42, v42, v34
  v_mul_f32 v43, v43, v34
  v_mul_f32 v44, v44, v34
  v_mul_f32 v45, v45, v34
  v_mul_f32 v46, v46, v34
  v_mul_f32 v47, v47, v34
  v_accvgpr_write_b32 a72, v40
  v_accvgpr_write_b32 a73, v41
  v_accvgpr_write_b32 a74, v42
  v_accvgpr_write_b32 a75, v43
  v_accvgpr_write_b32 a76, v44
  v_accvgpr_write_b32 a77, v45
  v_accvgpr_write_b32 a78, v46
  v_accvgpr_write_b32 a79, v47
  v_accvgpr_read_b32 v40, a80
  v_accvgpr_read_b32 v41, a81
  v_accvgpr_read_b32 v42, a82
  v_accvgpr_read_b32 v43, a83
  v_accvgpr_read_b32 v44, a84
  v_accvgpr_read_b32 v45, a85
  v_accvgpr_read_b32 v46, a86
  v_accvgpr_read_b32 v47, a87
  v_mul_f32 v40, v40, v34
  v_mul_f32 v41, v41, v34
  v_mul_f32 v42, v42, v34
  v_mul_f32 v43, v43, v34
  v_mul_f32 v44, v44, v34
  v_mul_f32 v45, v45, v34
  v_mul_f32 v46, v46, v34
  v_mul_f32 v47, v47, v34
  v_accvgpr_write_b32 a80, v40
  v_accvgpr_write_b32 a81, v41
  v_accvgpr_write_b32 a82, v42
  v_accvgpr_write_b32 a83, v43
  v_accvgpr_write_b32 a84, v44
  v_accvgpr_write_b32 a85, v45
  v_accvgpr_write_b32 a86, v46
  v_accvgpr_write_b32 a87, v47
  v_accvgpr_read_b32 v40, a88
  v_accvgpr_read_b32 v41, a89
  v_accvgpr_read_b32 v42, a90
  v_accvgpr_read_b32 v43, a91
  v_accvgpr_read_b32 v44, a92
  v_accvgpr_read_b32 v45, a93
  v_accvgpr_read_b32 v46, a94
  v_accvgpr_read_b32 v47, a95
  v_mul_f32 v40, v40, v34
  v_mul_f32 v41, v41, v34
  v_mul_f32 v42, v42, v34
  v_mul_f32 v43, v43, v34
  v_mul_f32 v44, v44, v34
  v_mul_f32 v45, v45, v34
  v_mul_f32 v46, v46, v34
  v_mul_f32 v47, v47, v34
  v_accvgpr_write_b32 a88, v40
  v_accvgpr_write_b32 a89, v41
  v_accvgpr_write_b32 a90, v42
  v_accvgpr_write_b32 a91, v43
  v_accvgpr_write_b32 a92, v44
  v_accvgpr_write_b32 a93, v45
  v_accvgpr_write_b32 a94, v46
  v_accvgpr_write_b32 a95, v47
  v_accvgpr_read_b32 v40, a96
  v_accvgpr_read_b32 v41, a97
  v_accvgpr_read_b32 v42, a98
  v_accvgpr_read_b32 v43, a99
  v_accvgpr_read_b32 v44, a100
  v_accvgpr_read_b32 v45, a101
  v_accvgpr_read_b32 v46, a102
  v_accvgpr_read_b32 v47, a103
  v_mul_f32 v40, v40, v34
  v_mul_f32 v41, v41, v34
  v_mul_f32 v42, v42, v34
  v_mul_f32 v43, v43, v34
  v_mul_f32 v44, v44, v34
  v_mul_f32 v45, v45, v34
  v_mul_f32 v46, v46, v34
  v_mul_f32 v47, v47, v34
  v_accvgpr_write_b32 a96, v40
  v_accvgpr_write_b32 a97, v41
  v_accvgpr_write_b32 a98, v42
  v_accvgpr_write_b32 a99, v43
  v_accvgpr_write_b32 a100, v44
  v_accvgpr_write_b32 a101, v45
  v_accvgpr_write_b32 a102, v46
  v_accvgpr_write_b32 a103, v47
  v_accvgpr_read_b32 v40, a104
  v_accvgpr_read_b32 v41, a105
  v_accvgpr_read_b32 v42, a106
  v_accvgpr_read_b32 v43, a107
  v_accvgpr_read_b32 v44, a108
  v_accvgpr_read_b32 v45, a109
  v_accvgpr_read_b32 v46, a110
  v_accvgpr_read_b32 v47, a111
  v_mul_f32 v40, v40, v34
  v_mul_f32 v41, v41, v34
  v_mul_f32 v42, v42, v34
  v_mul_f32 v43, v43, v34
  v_mul_f32 v44, v44, v34
  v_mul_f32 v45, v45, v34
  v_mul_f32 v46, v46, v34
  v_mul_f32 v47, v47, v34
  v_accvgpr_write_b32 a104, v40
  v_accvgpr_write_b32 a105, v41
  v_accvgpr_write_b32 a106, v42
  v_accvgpr_write_b32 a107, v43
  v_accvgpr_write_b32 a108, v44
  v_accvgpr_write_b32 a109, v45
  v_accvgpr_write_b32 a110, v46
  v_accvgpr_write_b32 a111, v47
  v_accvgpr_read_b32 v40, a112
  v_accvgpr_read_b32 v41, a113
  v_accvgpr_read_b32 v42, a114
  v_accvgpr_read_b32 v43, a115
  v_accvgpr_read_b32 v44, a116
  v_accvgpr_read_b32 v45, a117
  v_accvgpr_read_b32 v46, a118
  v_accvgpr_read_b32 v47, a119
  v_mul_f32 v40, v40, v34
  v_mul_f32 v41, v41, v34
  v_mul_f32 v42, v42, v34
  v_mul_f32 v43, v43, v34
  v_mul_f32 v44, v44, v34
  v_mul_f32 v45, v45, v34
  v_mul_f32 v46, v46, v34
  v_mul_f32 v47, v47, v34
  v_accvgpr_write_b32 a112, v40
  v_accvgpr_write_b32 a113, v41
  v_accvgpr_write_b32 a114, v42
  v_accvgpr_write_b32 a115, v43
  v_accvgpr_write_b32 a116, v44
  v_accvgpr_write_b32 a117, v45
  v_accvgpr_write_b32 a118, v46
  v_accvgpr_write_b32 a119, v47
  v_accvgpr_read_b32 v40, a120
  v_accvgpr_read_b32 v41, a121
  v_accvgpr_read_b32 v42, a122
  v_accvgpr_read_b32 v43, a123
  v_accvgpr_read_b32 v44, a124
  v_accvgpr_read_b32 v45, a125
  v_accvgpr_read_b32 v46, a126
  v_accvgpr_read_b32 v47, a127
  v_mul_f32 v40, v40, v34
  v_mul_f32 v41, v41, v34
  v_mul_f32 v42, v42, v34
  v_mul_f32 v43, v43, v34
  v_mul_f32 v44, v44, v34
  v_mul_f32 v45, v45, v34
  v_mul_f32 v46, v46, v34
  v_mul_f32 v47, v47, v34
  v_accvgpr_write_b32 a120, v40
  v_accvgpr_write_b32 a121, v41
  v_accvgpr_write_b32 a122, v42
  v_accvgpr_write_b32 a123, v43
  v_accvgpr_write_b32 a124, v44
  v_accvgpr_write_b32 a125, v45
  v_accvgpr_write_b32 a126, v46
  v_accvgpr_write_b32 a127, v47
  s_mov_b32 s42, 0
  s_nop 1
  s_branch L_ret_27
L_resc_29:
  s_nop 15
  s_nop 15
  v_accvgpr_read_b32 v40, a0
  v_accvgpr_read_b32 v41, a1
  v_accvgpr_read_b32 v42, a2
  v_accvgpr_read_b32 v43, a3
  v_accvgpr_read_b32 v44, a4
  v_accvgpr_read_b32 v45, a5
  v_accvgpr_read_b32 v46, a6
  v_accvgpr_read_b32 v47, a7
  v_mul_f32 v40, v40, v34
  v_mul_f32 v41, v41, v34
  v_mul_f32 v42, v42, v34
  v_mul_f32 v43, v43, v34
  v_mul_f32 v44, v44, v34
  v_mul_f32 v45, v45, v34
  v_mul_f32 v46, v46, v34
  v_mul_f32 v47, v47, v34
  v_accvgpr_write_b32 a0, v40
  v_accvgpr_write_b32 a1, v41
  v_accvgpr_write_b32 a2, v42
  v_accvgpr_write_b32 a3, v43
  v_accvgpr_write_b32 a4, v44
  v_accvgpr_write_b32 a5, v45
  v_accvgpr_write_b32 a6, v46
  v_accvgpr_write_b32 a7, v47
  v_accvgpr_read_b32 v40, a8
  v_accvgpr_read_b32 v41, a9
  v_accvgpr_read_b32 v42, a10
  v_accvgpr_read_b32 v43, a11
  v_accvgpr_read_b32 v44, a12
  v_accvgpr_read_b32 v45, a13
  v_accvgpr_read_b32 v46, a14
  v_accvgpr_read_b32 v47, a15
  v_mul_f32 v40, v40, v34
  v_mul_f32 v41, v41, v34
  v_mul_f32 v42, v42, v34
  v_mul_f32 v43, v43, v34
  v_mul_f32 v44, v44, v34
  v_mul_f32 v45, v45, v34
  v_mul_f32 v46, v46, v34
  v_mul_f32 v47, v47, v34
  v_accvgpr_write_b32 a8, v40
  v_accvgpr_write_b32 a9, v41
  v_accvgpr_write_b32 a10, v42
  v_accvgpr_write_b32 a11, v43
  v_accvgpr_write_b32 a12, v44
  v_accvgpr_write_b32 a13, v45
  v_accvgpr_write_b32 a14, v46
  v_accvgpr_write_b32 a15, v47
  v_accvgpr_read_b32 v40, a16
  v_accvgpr_read_b32 v41, a17
  v_accvgpr_read_b32 v42, a18
  v_accvgpr_read_b32 v43, a19
  v_accvgpr_read_b32 v44, a20
  v_accvgpr_read_b32 v45, a21
  v_accvgpr_read_b32 v46, a22
  v_accvgpr_read_b32 v47, a23
  v_mul_f32 v40, v40, v34
  v_mul_f32 v41, v41, v34
  v_mul_f32 v42, v42, v34
  v_mul_f32 v43, v43, v34
  v_mul_f32 v44, v44, v34
  v_mul_f32 v45, v45, v34
  v_mul_f32 v46, v46, v34
  v_mul_f32 v47, v47, v34
  v_accvgpr_write_b32 a16, v40
  v_accvgpr_write_b32 a17, v41
  v_accvgpr_write_b32 a18, v42
  v_accvgpr_write_b32 a19, v43
  v_accvgpr_write_b32 a20, v44
  v_accvgpr_write_b32 a21, v45
  v_accvgpr_write_b32 a22, v46
  v_accvgpr_write_b32 a23, v47
  v_accvgpr_read_b32 v40, a24
  v_accvgpr_read_b32 v41, a25
  v_accvgpr_read_b32 v42, a26
  v_accvgpr_read_b32 v43, a27
  v_accvgpr_read_b32 v44, a28
  v_accvgpr_read_b32 v45, a29
  v_accvgpr_read_b32 v46, a30
  v_accvgpr_read_b32 v47, a31
  v_mul_f32 v40, v40, v34
  v_mul_f32 v41, v41, v34
  v_mul_f32 v42, v42, v34
  v_mul_f32 v43, v43, v34
  v_mul_f32 v44, v44, v34
  v_mul_f32 v45, v45, v34
  v_mul_f32 v46, v46, v34
  v_mul_f32 v47, v47, v34
  v_accvgpr_write_b32 a24, v40
  v_accvgpr_write_b32 a25, v41
  v_accvgpr_write_b32 a26, v42
  v_accvgpr_write_b32 a27, v43
  v_accvgpr_write_b32 a28, v44
  v_accvgpr_write_b32 a29, v45
  v_accvgpr_write_b32 a30, v46
  v_accvgpr_write_b32 a31, v47
  v_accvgpr_read_b32 v40, a32
  v_accvgpr_read_b32 v41, a33
  v_accvgpr_read_b32 v42, a34
  v_accvgpr_read_b32 v43, a35
  v_accvgpr_read_b32 v44, a36
  v_accvgpr_read_b32 v45, a37
  v_accvgpr_read_b32 v46, a38
  v_accvgpr_read_b32 v47, a39
  v_mul_f32 v40, v40, v34
  v_mul_f32 v41, v41, v34
  v_mul_f32 v42, v42, v34
  v_mul_f32 v43, v43, v34
  v_mul_f32 v44, v44, v34
  v_mul_f32 v45, v45, v34
  v_mul_f32 v46, v46, v34
  v_mul_f32 v47, v47, v34
  v_accvgpr_write_b32 a32, v40
  v_accvgpr_write_b32 a33, v41
  v_accvgpr_write_b32 a34, v42
  v_accvgpr_write_b32 a35, v43
  v_accvgpr_write_b32 a36, v44
  v_accvgpr_write_b32 a37, v45
  v_accvgpr_write_b32 a38, v46
  v_accvgpr_write_b32 a39, v47
  v_accvgpr_read_b32 v40, a40
  v_accvgpr_read_b32 v41, a41
  v_accvgpr_read_b32 v42, a42
  v_accvgpr_read_b32 v43, a43
  v_accvgpr_read_b32 v44, a44
  v_accvgpr_read_b32 v45, a45
  v_accvgpr_read_b32 v46, a46
  v_accvgpr_read_b32 v47, a47
  v_mul_f32 v40, v40, v34
  v_mul_f32 v41, v41, v34
  v_mul_f32 v42, v42, v34
  v_mul_f32 v43, v43, v34
  v_mul_f32 v44, v44, v34
  v_mul_f32 v45, v45, v34
  v_mul_f32 v46, v46, v34
  v_mul_f32 v47, v47, v34
  v_accvgpr_write_b32 a40, v40
  v_accvgpr_write_b32 a41, v41
  v_accvgpr_write_b32 a42, v42
  v_accvgpr_write_b32 a43, v43
  v_accvgpr_write_b32 a44, v44
  v_accvgpr_write_b32 a45, v45
  v_accvgpr_write_b32 a46, v46
  v_accvgpr_write_b32 a47, v47
  v_accvgpr_read_b32 v40, a48
  v_accvgpr_read_b32 v41, a49
  v_accvgpr_read_b32 v42, a50
  v_accvgpr_read_b32 v43, a51
  v_accvgpr_read_b32 v44, a52
  v_accvgpr_read_b32 v45, a53
  v_accvgpr_read_b32 v46, a54
  v_accvgpr_read_b32 v47, a55
  v_mul_f32 v40, v40, v34
  v_mul_f32 v41, v41, v34
  v_mul_f32 v42, v42, v34
  v_mul_f32 v43, v43, v34
  v_mul_f32 v44, v44, v34
  v_mul_f32 v45, v45, v34
  v_mul_f32 v46, v46, v34
  v_mul_f32 v47, v47, v34
  v_accvgpr_write_b32 a48, v40
  v_accvgpr_write_b32 a49, v41
  v_accvgpr_write_b32 a50, v42
  v_accvgpr_write_b32 a51, v43
  v_accvgpr_write_b32 a52, v44
  v_accvgpr_write_b32 a53, v45
  v_accvgpr_write_b32 a54, v46
  v_accvgpr_write_b32 a55, v47
  v_accvgpr_read_b32 v40, a56
  v_accvgpr_read_b32 v41, a57
  v_accvgpr_read_b32 v42, a58
  v_accvgpr_read_b32 v43, a59
  v_accvgpr_read_b32 v44, a60
  v_accvgpr_read_b32 v45, a61
  v_accvgpr_read_b32 v46, a62
  v_accvgpr_read_b32 v47, a63
  v_mul_f32 v40, v40, v34
  v_mul_f32 v41, v41, v34
  v_mul_f32 v42, v42, v34
  v_mul_f32 v43, v43, v34
  v_mul_f32 v44, v44, v34
  v_mul_f32 v45, v45, v34
  v_mul_f32 v46, v46, v34
  v_mul_f32 v47, v47, v34
  v_accvgpr_write_b32 a56, v40
  v_accvgpr_write_b32 a57, v41
  v_accvgpr_write_b32 a58, v42
  v_accvgpr_write_b32 a59, v43
  v_accvgpr_write_b32 a60, v44
  v_accvgpr_write_b32 a61, v45
  v_accvgpr_write_b32 a62, v46
  v_accvgpr_write_b32 a63, v47
  v_accvgpr_read_b32 v40, a64
  v_accvgpr_read_b32 v41, a65
  v_accvgpr_read_b32 v42, a66
  v_accvgpr_read_b32 v43, a67
  v_accvgpr_read_b32 v44, a68
  v_accvgpr_read_b32 v45, a69
  v_accvgpr_read_b32 v46, a70
  v_accvgpr_read_b32 v47, a71
  v_mul_f32 v40, v40, v34
  v_mul_f32 v41, v41, v34
  v_mul_f32 v42, v42, v34
  v_mul_f32 v43, v43, v34
  v_mul_f32 v44, v44, v34
  v_mul_f32 v45, v45, v34
  v_mul_f32 v46, v46, v34
  v_mul_f32 v47, v47, v34
  v_accvgpr_write_b32 a64, v40
  v_accvgpr_write_b32 a65, v41
  v_accvgpr_write_b32 a66, v42
  v_accvgpr_write_b32 a67, v43
  v_accvgpr_write_b32 a68, v44
  v_accvgpr_write_b32 a69, v45
  v_accvgpr_write_b32 a70, v46
  v_accvgpr_write_b32 a71, v47
  v_accvgpr_read_b32 v40, a72
  v_accvgpr_read_b32 v41, a73
  v_accvgpr_read_b32 v42, a74
  v_accvgpr_read_b32 v43, a75
  v_accvgpr_read_b32 v44, a76
  v_accvgpr_read_b32 v45, a77
  v_accvgpr_read_b32 v46, a78
  v_accvgpr_read_b32 v47, a79
  v_mul_f32 v40, v40, v34
  v_mul_f32 v41, v41, v34
  v_mul_f32 v42, v42, v34
  v_mul_f32 v43, v43, v34
  v_mul_f32 v44, v44, v34
  v_mul_f32 v45, v45, v34
  v_mul_f32 v46, v46, v34
  v_mul_f32 v47, v47, v34
  v_accvgpr_write_b32 a72, v40
  v_accvgpr_write_b32 a73, v41
  v_accvgpr_write_b32 a74, v42
  v_accvgpr_write_b32 a75, v43
  v_accvgpr_write_b32 a76, v44
  v_accvgpr_write_b32 a77, v45
  v_accvgpr_write_b32 a78, v46
  v_accvgpr_write_b32 a79, v47
  v_accvgpr_read_b32 v40, a80
  v_accvgpr_read_b32 v41, a81
  v_accvgpr_read_b32 v42, a82
  v_accvgpr_read_b32 v43, a83
  v_accvgpr_read_b32 v44, a84
  v_accvgpr_read_b32 v45, a85
  v_accvgpr_read_b32 v46, a86
  v_accvgpr_read_b32 v47, a87
  v_mul_f32 v40, v40, v34
  v_mul_f32 v41, v41, v34
  v_mul_f32 v42, v42, v34
  v_mul_f32 v43, v43, v34
  v_mul_f32 v44, v44, v34
  v_mul_f32 v45, v45, v34
  v_mul_f32 v46, v46, v34
  v_mul_f32 v47, v47, v34
  v_accvgpr_write_b32 a80, v40
  v_accvgpr_write_b32 a81, v41
  v_accvgpr_write_b32 a82, v42
  v_accvgpr_write_b32 a83, v43
  v_accvgpr_write_b32 a84, v44
  v_accvgpr_write_b32 a85, v45
  v_accvgpr_write_b32 a86, v46
  v_accvgpr_write_b32 a87, v47
  v_accvgpr_read_b32 v40, a88
  v_accvgpr_read_b32 v41, a89
  v_accvgpr_read_b32 v42, a90
  v_accvgpr_read_b32 v43, a91
  v_accvgpr_read_b32 v44, a92
  v_accvgpr_read_b32 v45, a93
  v_accvgpr_read_b32 v46, a94
  v_accvgpr_read_b32 v47, a95
  v_mul_f32 v40, v40, v34
  v_mul_f32 v41, v41, v34
  v_mul_f32 v42, v42, v34
  v_mul_f32 v43, v43, v34
  v_mul_f32 v44, v44, v34
  v_mul_f32 v45, v45, v34
  v_mul_f32 v46, v46, v34
  v_mul_f32 v47, v47, v34
  v_accvgpr_write_b32 a88, v40
  v_accvgpr_write_b32 a89, v41
  v_accvgpr_write_b32 a90, v42
  v_accvgpr_write_b32 a91, v43
  v_accvgpr_write_b32 a92, v44
  v_accvgpr_write_b32 a93, v45
  v_accvgpr_write_b32 a94, v46
  v_accvgpr_write_b32 a95, v47
  v_accvgpr_read_b32 v40, a96
  v_accvgpr_read_b32 v41, a97
  v_accvgpr_read_b32 v42, a98
  v_accvgpr_read_b32 v43, a99
  v_accvgpr_read_b32 v44, a100
  v_accvgpr_read_b32 v45, a101
  v_accvgpr_read_b32 v46, a102
  v_accvgpr_read_b32 v47, a103
  v_mul_f32 v40, v40, v34
  v_mul_f32 v41, v41, v34
  v_mul_f32 v42, v42, v34
  v_mul_f32 v43, v43, v34
  v_mul_f32 v44, v44, v34
  v_mul_f32 v45, v45, v34
  v_mul_f32 v46, v46, v34
  v_mul_f32 v47, v47, v34
  v_accvgpr_write_b32 a96, v40
  v_accvgpr_write_b32 a97, v41
  v_accvgpr_write_b32 a98, v42
  v_accvgpr_write_b32 a99, v43
  v_accvgpr_write_b32 a100, v44
  v_accvgpr_write_b32 a101, v45
  v_accvgpr_write_b32 a102, v46
  v_accvgpr_write_b32 a103, v47
  v_accvgpr_read_b32 v40, a104
  v_accvgpr_read_b32 v41, a105
  v_accvgpr_read_b32 v42, a106
  v_accvgpr_read_b32 v43, a107
  v_accvgpr_read_b32 v44, a108
  v_accvgpr_read_b32 v45, a109
  v_accvgpr_read_b32 v46, a110
  v_accvgpr_read_b32 v47, a111
  v_mul_f32 v40, v40, v34
  v_mul_f32 v41, v41, v34
  v_mul_f32 v42, v42, v34
  v_mul_f32 v43, v43, v34
  v_mul_f32 v44, v44, v34
  v_mul_f32 v45, v45, v34
  v_mul_f32 v46, v46, v34
  v_mul_f32 v47, v47, v34
  v_accvgpr_write_b32 a104, v40
  v_accvgpr_write_b32 a105, v41
  v_accvgpr_write_b32 a106, v42
  v_accvgpr_write_b32 a107, v43
  v_accvgpr_write_b32 a108, v44
  v_accvgpr_write_b32 a109, v45
  v_accvgpr_write_b32 a110, v46
  v_accvgpr_write_b32 a111, v47
  v_accvgpr_read_b32 v40, a112
  v_accvgpr_read_b32 v41, a113
  v_accvgpr_read_b32 v42, a114
  v_accvgpr_read_b32 v43, a115
  v_accvgpr_read_b32 v44, a116
  v_accvgpr_read_b32 v45, a117
  v_accvgpr_read_b32 v46, a118
  v_accvgpr_read_b32 v47, a119
  v_mul_f32 v40, v40, v34
  v_mul_f32 v41, v41, v34
  v_mul_f32 v42, v42, v34
  v_mul_f32 v43, v43, v34
  v_mul_f32 v44, v44, v34
  v_mul_f32 v45, v45, v34
  v_mul_f32 v46, v46, v34
  v_mul_f32 v47, v47, v34
  v_accvgpr_write_b32 a112, v40
  v_accvgpr_write_b32 a113, v41
  v_accvgpr_write_b32 a114, v42
  v_accvgpr_write_b32 a115, v43
  v_accvgpr_write_b32 a116, v44
  v_accvgpr_write_b32 a117, v45
  v_accvgpr_write_b32 a118, v46
  v_accvgpr_write_b32 a119, v47
  v_accvgpr_read_b32 v40, a120
  v_accvgpr_read_b32 v41, a121
  v_accvgpr_read_b32 v42, a122
  v_accvgpr_read_b32 v43, a123
  v_accvgpr_read_b32 v44, a124
  v_accvgpr_read_b32 v45, a125
  v_accvgpr_read_b32 v46, a126
  v_accvgpr_read_b32 v47, a127
  v_mul_f32 v40, v40, v34
  v_mul_f32 v41, v41, v34
  v_mul_f32 v42, v42, v34
  v_mul_f32 v43, v43, v34
  v_mul_f32 v44, v44, v34
  v_mul_f32 v45, v45, v34
  v_mul_f32 v46, v46, v34
  v_mul_f32 v47, v47, v34
  v_accvgpr_write_b32 a120, v40
  v_accvgpr_write_b32 a121, v41
  v_accvgpr_write_b32 a122, v42
  v_accvgpr_write_b32 a123, v43
  v_accvgpr_write_b32 a124, v44
  v_accvgpr_write_b32 a125, v45
  v_accvgpr_write_b32 a126, v46
  v_accvgpr_write_b32 a127, v47
  s_mov_b32 s42, 0
  s_nop 1
  s_branch L_ret_30
L_resc_32:
  s_nop 15
  s_nop 15
  v_accvgpr_read_b32 v40, a0
  v_accvgpr_read_b32 v41, a1
  v_accvgpr_read_b32 v42, a2
  v_accvgpr_read_b32 v43, a3
  v_accvgpr_read_b32 v44, a4
  v_accvgpr_read_b32 v45, a5
  v_accvgpr_read_b32 v46, a6
  v_accvgpr_read_b32 v47, a7
  v_mul_f32 v40, v40, v34
  v_mul_f32 v41, v41, v34
  v_mul_f32 v42, v42, v34
  v_mul_f32 v43, v43, v34
  v_mul_f32 v44, v44, v34
  v_mul_f32 v45, v45, v34
  v_mul_f32 v46, v46, v34
  v_mul_f32 v47, v47, v34
  v_accvgpr_write_b32 a0, v40
  v_accvgpr_write_b32 a1, v41
  v_accvgpr_write_b32 a2, v42
  v_accvgpr_write_b32 a3, v43
  v_accvgpr_write_b32 a4, v44
  v_accvgpr_write_b32 a5, v45
  v_accvgpr_write_b32 a6, v46
  v_accvgpr_write_b32 a7, v47
  v_accvgpr_read_b32 v40, a8
  v_accvgpr_read_b32 v41, a9
  v_accvgpr_read_b32 v42, a10
  v_accvgpr_read_b32 v43, a11
  v_accvgpr_read_b32 v44, a12
  v_accvgpr_read_b32 v45, a13
  v_accvgpr_read_b32 v46, a14
  v_accvgpr_read_b32 v47, a15
  v_mul_f32 v40, v40, v34
  v_mul_f32 v41, v41, v34
  v_mul_f32 v42, v42, v34
  v_mul_f32 v43, v43, v34
  v_mul_f32 v44, v44, v34
  v_mul_f32 v45, v45, v34
  v_mul_f32 v46, v46, v34
  v_mul_f32 v47, v47, v34
  v_accvgpr_write_b32 a8, v40
  v_accvgpr_write_b32 a9, v41
  v_accvgpr_write_b32 a10, v42
  v_accvgpr_write_b32 a11, v43
  v_accvgpr_write_b32 a12, v44
  v_accvgpr_write_b32 a13, v45
  v_accvgpr_write_b32 a14, v46
  v_accvgpr_write_b32 a15, v47
  v_accvgpr_read_b32 v40, a16
  v_accvgpr_read_b32 v41, a17
  v_accvgpr_read_b32 v42, a18
  v_accvgpr_read_b32 v43, a19
  v_accvgpr_read_b32 v44, a20
  v_accvgpr_read_b32 v45, a21
  v_accvgpr_read_b32 v46, a22
  v_accvgpr_read_b32 v47, a23
  v_mul_f32 v40, v40, v34
  v_mul_f32 v41, v41, v34
  v_mul_f32 v42, v42, v34
  v_mul_f32 v43, v43, v34
  v_mul_f32 v44, v44, v34
  v_mul_f32 v45, v45, v34
  v_mul_f32 v46, v46, v34
  v_mul_f32 v47, v47, v34
  v_accvgpr_write_b32 a16, v40
  v_accvgpr_write_b32 a17, v41
  v_accvgpr_write_b32 a18, v42
  v_accvgpr_write_b32 a19, v43
  v_accvgpr_write_b32 a20, v44
  v_accvgpr_write_b32 a21, v45
  v_accvgpr_write_b32 a22, v46
  v_accvgpr_write_b32 a23, v47
  v_accvgpr_read_b32 v40, a24
  v_accvgpr_read_b32 v41, a25
  v_accvgpr_read_b32 v42, a26
  v_accvgpr_read_b32 v43, a27
  v_accvgpr_read_b32 v44, a28
  v_accvgpr_read_b32 v45, a29
  v_accvgpr_read_b32 v46, a30
  v_accvgpr_read_b32 v47, a31
  v_mul_f32 v40, v40, v34
  v_mul_f32 v41, v41, v34
  v_mul_f32 v42, v42, v34
  v_mul_f32 v43, v43, v34
  v_mul_f32 v44, v44, v34
  v_mul_f32 v45, v45, v34
  v_mul_f32 v46, v46, v34
  v_mul_f32 v47, v47, v34
  v_accvgpr_write_b32 a24, v40
  v_accvgpr_write_b32 a25, v41
  v_accvgpr_write_b32 a26, v42
  v_accvgpr_write_b32 a27, v43
  v_accvgpr_write_b32 a28, v44
  v_accvgpr_write_b32 a29, v45
  v_accvgpr_write_b32 a30, v46
  v_accvgpr_write_b32 a31, v47
  v_accvgpr_read_b32 v40, a32
  v_accvgpr_read_b32 v41, a33
  v_accvgpr_read_b32 v42, a34
  v_accvgpr_read_b32 v43, a35
  v_accvgpr_read_b32 v44, a36
  v_accvgpr_read_b32 v45, a37
  v_accvgpr_read_b32 v46, a38
  v_accvgpr_read_b32 v47, a39
  v_mul_f32 v40, v40, v34
  v_mul_f32 v41, v41, v34
  v_mul_f32 v42, v42, v34
  v_mul_f32 v43, v43, v34
  v_mul_f32 v44, v44, v34
  v_mul_f32 v45, v45, v34
  v_mul_f32 v46, v46, v34
  v_mul_f32 v47, v47, v34
  v_accvgpr_write_b32 a32, v40
  v_accvgpr_write_b32 a33, v41
  v_accvgpr_write_b32 a34, v42
  v_accvgpr_write_b32 a35, v43
  v_accvgpr_write_b32 a36, v44
  v_accvgpr_write_b32 a37, v45
  v_accvgpr_write_b32 a38, v46
  v_accvgpr_write_b32 a39, v47
  v_accvgpr_read_b32 v40, a40
  v_accvgpr_read_b32 v41, a41
  v_accvgpr_read_b32 v42, a42
  v_accvgpr_read_b32 v43, a43
  v_accvgpr_read_b32 v44, a44
  v_accvgpr_read_b32 v45, a45
  v_accvgpr_read_b32 v46, a46
  v_accvgpr_read_b32 v47, a47
  v_mul_f32 v40, v40, v34
  v_mul_f32 v41, v41, v34
  v_mul_f32 v42, v42, v34
  v_mul_f32 v43, v43, v34
  v_mul_f32 v44, v44, v34
  v_mul_f32 v45, v45, v34
  v_mul_f32 v46, v46, v34
  v_mul_f32 v47, v47, v34
  v_accvgpr_write_b32 a40, v40
  v_accvgpr_write_b32 a41, v41
  v_accvgpr_write_b32 a42, v42
  v_accvgpr_write_b32 a43, v43
  v_accvgpr_write_b32 a44, v44
  v_accvgpr_write_b32 a45, v45
  v_accvgpr_write_b32 a46, v46
  v_accvgpr_write_b32 a47, v47
  v_accvgpr_read_b32 v40, a48
  v_accvgpr_read_b32 v41, a49
  v_accvgpr_read_b32 v42, a50
  v_accvgpr_read_b32 v43, a51
  v_accvgpr_read_b32 v44, a52
  v_accvgpr_read_b32 v45, a53
  v_accvgpr_read_b32 v46, a54
  v_accvgpr_read_b32 v47, a55
  v_mul_f32 v40, v40, v34
  v_mul_f32 v41, v41, v34
  v_mul_f32 v42, v42, v34
  v_mul_f32 v43, v43, v34
  v_mul_f32 v44, v44, v34
  v_mul_f32 v45, v45, v34
  v_mul_f32 v46, v46, v34
  v_mul_f32 v47, v47, v34
  v_accvgpr_write_b32 a48, v40
  v_accvgpr_write_b32 a49, v41
  v_accvgpr_write_b32 a50, v42
  v_accvgpr_write_b32 a51, v43
  v_accvgpr_write_b32 a52, v44
  v_accvgpr_write_b32 a53, v45
  v_accvgpr_write_b32 a54, v46
  v_accvgpr_write_b32 a55, v47
  v_accvgpr_read_b32 v40, a56
  v_accvgpr_read_b32 v41, a57
  v_accvgpr_read_b32 v42, a58
  v_accvgpr_read_b32 v43, a59
  v_accvgpr_read_b32 v44, a60
  v_accvgpr_read_b32 v45, a61
  v_accvgpr_read_b32 v46, a62
  v_accvgpr_read_b32 v47, a63
  v_mul_f32 v40, v40, v34
  v_mul_f32 v41, v41, v34
  v_mul_f32 v42, v42, v34
  v_mul_f32 v43, v43, v34
  v_mul_f32 v44, v44, v34
  v_mul_f32 v45, v45, v34
  v_mul_f32 v46, v46, v34
  v_mul_f32 v47, v47, v34
  v_accvgpr_write_b32 a56, v40
  v_accvgpr_write_b32 a57, v41
  v_accvgpr_write_b32 a58, v42
  v_accvgpr_write_b32 a59, v43
  v_accvgpr_write_b32 a60, v44
  v_accvgpr_write_b32 a61, v45
  v_accvgpr_write_b32 a62, v46
  v_accvgpr_write_b32 a63, v47
  v_accvgpr_read_b32 v40, a64
  v_accvgpr_read_b32 v41, a65
  v_accvgpr_read_b32 v42, a66
  v_accvgpr_read_b32 v43, a67
  v_accvgpr_read_b32 v44, a68
  v_accvgpr_read_b32 v45, a69
  v_accvgpr_read_b32 v46, a70
  v_accvgpr_read_b32 v47, a71
  v_mul_f32 v40, v40, v34
  v_mul_f32 v41, v41, v34
  v_mul_f32 v42, v42, v34
  v_mul_f32 v43, v43, v34
  v_mul_f32 v44, v44, v34
  v_mul_f32 v45, v45, v34
  v_mul_f32 v46, v46, v34
  v_mul_f32 v47, v47, v34
  v_accvgpr_write_b32 a64, v40
  v_accvgpr_write_b32 a65, v41
  v_accvgpr_write_b32 a66, v42
  v_accvgpr_write_b32 a67, v43
  v_accvgpr_write_b32 a68, v44
  v_accvgpr_write_b32 a69, v45
  v_accvgpr_write_b32 a70, v46
  v_accvgpr_write_b32 a71, v47
  v_accvgpr_read_b32 v40, a72
  v_accvgpr_read_b32 v41, a73
  v_accvgpr_read_b32 v42, a74
  v_accvgpr_read_b32 v43, a75
  v_accvgpr_read_b32 v44, a76
  v_accvgpr_read_b32 v45, a77
  v_accvgpr_read_b32 v46, a78
  v_accvgpr_read_b32 v47, a79
  v_mul_f32 v40, v40, v34
  v_mul_f32 v41, v41, v34
  v_mul_f32 v42, v42, v34
  v_mul_f32 v43, v43, v34
  v_mul_f32 v44, v44, v34
  v_mul_f32 v45, v45, v34
  v_mul_f32 v46, v46, v34
  v_mul_f32 v47, v47, v34
  v_accvgpr_write_b32 a72, v40
  v_accvgpr_write_b32 a73, v41
  v_accvgpr_write_b32 a74, v42
  v_accvgpr_write_b32 a75, v43
  v_accvgpr_write_b32 a76, v44
  v_accvgpr_write_b32 a77, v45
  v_accvgpr_write_b32 a78, v46
  v_accvgpr_write_b32 a79, v47
  v_accvgpr_read_b32 v40, a80
  v_accvgpr_read_b32 v41, a81
  v_accvgpr_read_b32 v42, a82
  v_accvgpr_read_b32 v43, a83
  v_accvgpr_read_b32 v44, a84
  v_accvgpr_read_b32 v45, a85
  v_accvgpr_read_b32 v46, a86
  v_accvgpr_read_b32 v47, a87
  v_mul_f32 v40, v40, v34
  v_mul_f32 v41, v41, v34
  v_mul_f32 v42, v42, v34
  v_mul_f32 v43, v43, v34
  v_mul_f32 v44, v44, v34
  v_mul_f32 v45, v45, v34
  v_mul_f32 v46, v46, v34
  v_mul_f32 v47, v47, v34
  v_accvgpr_write_b32 a80, v40
  v_accvgpr_write_b32 a81, v41
  v_accvgpr_write_b32 a82, v42
  v_accvgpr_write_b32 a83, v43
  v_accvgpr_write_b32 a84, v44
  v_accvgpr_write_b32 a85, v45
  v_accvgpr_write_b32 a86, v46
  v_accvgpr_write_b32 a87, v47
  v_accvgpr_read_b32 v40, a88
  v_accvgpr_read_b32 v41, a89
  v_accvgpr_read_b32 v42, a90
  v_accvgpr_read_b32 v43, a91
  v_accvgpr_read_b32 v44, a92
  v_accvgpr_read_b32 v45, a93
  v_accvgpr_read_b32 v46, a94
  v_accvgpr_read_b32 v47, a95
  v_mul_f32 v40, v40, v34
  v_mul_f32 v41, v41, v34
  v_mul_f32 v42, v42, v34
  v_mul_f32 v43, v43, v34
  v_mul_f32 v44, v44, v34
  v_mul_f32 v45, v45, v34
  v_mul_f32 v46, v46, v34
  v_mul_f32 v47, v47, v34
  v_accvgpr_write_b32 a88, v40
  v_accvgpr_write_b32 a89, v41
  v_accvgpr_write_b32 a90, v42
  v_accvgpr_write_b32 a91, v43
  v_accvgpr_write_b32 a92, v44
  v_accvgpr_write_b32 a93, v45
  v_accvgpr_write_b32 a94, v46
  v_accvgpr_write_b32 a95, v47
  v_accvgpr_read_b32 v40, a96
  v_accvgpr_read_b32 v41, a97
  v_accvgpr_read_b32 v42, a98
  v_accvgpr_read_b32 v43, a99
  v_accvgpr_read_b32 v44, a100
  v_accvgpr_read_b32 v45, a101
  v_accvgpr_read_b32 v46, a102
  v_accvgpr_read_b32 v47, a103
  v_mul_f32 v40, v40, v34
  v_mul_f32 v41, v41, v34
  v_mul_f32 v42, v42, v34
  v_mul_f32 v43, v43, v34
  v_mul_f32 v44, v44, v34
  v_mul_f32 v45, v45, v34
  v_mul_f32 v46, v46, v34
  v_mul_f32 v47, v47, v34
  v_accvgpr_write_b32 a96, v40
  v_accvgpr_write_b32 a97, v41
  v_accvgpr_write_b32 a98, v42
  v_accvgpr_write_b32 a99, v43
  v_accvgpr_write_b32 a100, v44
  v_accvgpr_write_b32 a101, v45
  v_accvgpr_write_b32 a102, v46
  v_accvgpr_write_b32 a103, v47
  v_accvgpr_read_b32 v40, a104
  v_accvgpr_read_b32 v41, a105
  v_accvgpr_read_b32 v42, a106
  v_accvgpr_read_b32 v43, a107
  v_accvgpr_read_b32 v44, a108
  v_accvgpr_read_b32 v45, a109
  v_accvgpr_read_b32 v46, a110
  v_accvgpr_read_b32 v47, a111
  v_mul_f32 v40, v40, v34
  v_mul_f32 v41, v41, v34
  v_mul_f32 v42, v42, v34
  v_mul_f32 v43, v43, v34
  v_mul_f32 v44, v44, v34
  v_mul_f32 v45, v45, v34
  v_mul_f32 v46, v46, v34
  v_mul_f32 v47, v47, v34
  v_accvgpr_write_b32 a104, v40
  v_accvgpr_write_b32 a105, v41
  v_accvgpr_write_b32 a106, v42
  v_accvgpr_write_b32 a107, v43
  v_accvgpr_write_b32 a108, v44
  v_accvgpr_write_b32 a109, v45
  v_accvgpr_write_b32 a110, v46
  v_accvgpr_write_b32 a111, v47
  v_accvgpr_read_b32 v40, a112
  v_accvgpr_read_b32 v41, a113
  v_accvgpr_read_b32 v42, a114
  v_accvgpr_read_b32 v43, a115
  v_accvgpr_read_b32 v44, a116
  v_accvgpr_read_b32 v45, a117
  v_accvgpr_read_b32 v46, a118
  v_accvgpr_read_b32 v47, a119
  v_mul_f32 v40, v40, v34
  v_mul_f32 v41, v41, v34
  v_mul_f32 v42, v42, v34
  v_mul_f32 v43, v43, v34
  v_mul_f32 v44, v44, v34
  v_mul_f32 v45, v45, v34
  v_mul_f32 v46, v46, v34
  v_mul_f32 v47, v47, v34
  v_accvgpr_write_b32 a112, v40
  v_accvgpr_write_b32 a113, v41
  v_accvgpr_write_b32 a114, v42
  v_accvgpr_write_b32 a115, v43
  v_accvgpr_write_b32 a116, v44
  v_accvgpr_write_b32 a117, v45
  v_accvgpr_write_b32 a118, v46
  v_accvgpr_write_b32 a119, v47
  v_accvgpr_read_b32 v40, a120
  v_accvgpr_read_b32 v41, a121
  v_accvgpr_read_b32 v42, a122
  v_accvgpr_read_b32 v43, a123
  v_accvgpr_read_b32 v44, a124
  v_accvgpr_read_b32 v45, a125
  v_accvgpr_read_b32 v46, a126
  v_accvgpr_read_b32 v47, a127
  v_mul_f32 v40, v40, v34
  v_mul_f32 v41, v41, v34
  v_mul_f32 v42, v42, v34
  v_mul_f32 v43, v43, v34
  v_mul_f32 v44, v44, v34
  v_mul_f32 v45, v45, v34
  v_mul_f32 v46, v46, v34
  v_mul_f32 v47, v47, v34
  v_accvgpr_write_b32 a120, v40
  v_accvgpr_write_b32 a121, v41
  v_accvgpr_write_b32 a122, v42
  v_accvgpr_write_b32 a123, v43
  v_accvgpr_write_b32 a124, v44
  v_accvgpr_write_b32 a125, v45
  v_accvgpr_write_b32 a126, v46
  v_accvgpr_write_b32 a127, v47
  s_mov_b32 s42, 0
  s_nop 1
  s_branch L_ret_33
L_mask0_36:
  s_lshl_b32 s52, s32, 6
  v_subrev_u32 v38, s52, v26
  v_cmp_gt_i32 s[56:57], 0, v38
  v_cmp_gt_i32 s[58:59], 1, v38
  v_cmp_gt_i32 s[60:61], 2, v38
  v_cmp_gt_i32 s[62:63], 3, v38
  v_cndmask_b32 v64, v64, v37, s[56:57]
  v_cndmask_b32 v65, v65, v37, s[58:59]
  v_cndmask_b32 v66, v66, v37, s[60:61]
  v_cndmask_b32 v67, v67, v37, s[62:63]
  v_cmp_gt_i32 s[56:57], 8, v38
  v_cmp_gt_i32 s[58:59], 9, v38
  v_cmp_gt_i32 s[60:61], 10, v38
  v_cmp_gt_i32 s[62:63], 11, v38
  v_cndmask_b32 v68, v68, v37, s[56:57]
  v_cndmask_b32 v69, v69, v37, s[58:59]
  v_cndmask_b32 v70, v70, v37, s[60:61]
  v_cndmask_b32 v71, v71, v37, s[62:63]
  v_cmp_gt_i32 s[56:57], 16, v38
  v_cmp_gt_i32 s[58:59], 17, v38
  v_cmp_gt_i32 s[60:61], 18, v38
  v_cmp_gt_i32 s[62:63], 19, v38
  v_cndmask_b32 v72, v72, v37, s[56:57]
  v_cndmask_b32 v73, v73, v37, s[58:59]
  v_cndmask_b32 v74, v74, v37, s[60:61]
  v_cndmask_b32 v75, v75, v37, s[62:63]
  v_cmp_gt_i32 s[56:57], 24, v38
  v_cmp_gt_i32 s[58:59], 25, v38
  v_cmp_gt_i32 s[60:61], 26, v38
  v_cmp_gt_i32 s[62:63], 27, v38
  v_cndmask_b32 v76, v76, v37, s[56:57]
  v_cndmask_b32 v77, v77, v37, s[58:59]
  v_cndmask_b32 v78, v78, v37, s[60:61]
  v_cndmask_b32 v79, v79, v37, s[62:63]
  s_branch L_ret_37
L_mask1_38:
  s_lshl_b32 s52, s32, 6
  v_subrev_u32 v38, s52, v26
  v_cmp_gt_i32 s[56:57], 32, v38
  v_cmp_gt_i32 s[58:59], 33, v38
  v_cmp_gt_i32 s[60:61], 34, v38
  v_cmp_gt_i32 s[62:63], 35, v38
  v_cndmask_b32 v80, v80, v37, s[56:57]
  v_cndmask_b32 v81, v81, v37, s[58:59]
  v_cndmask_b32 v82, v82, v37, s[60:61]
  v_cndmask_b32 v83, v83, v37, s[62:63]
  v_cmp_gt_i32 s[56:57], 40, v38
  v_cmp_gt_i32 s[58:59], 41, v38
  v_cmp_gt_i32 s[60:61], 42, v38
  v_cmp_gt_i32 s[62:63], 43, v38
  v_cndmask_b32 v84, v84, v37, s[56:57]
  v_cndmask_b32 v85, v85, v37, s[58:59]
  v_cndmask_b32 v86, v86, v37, s[60:61]
  v_cndmask_b32 v87, v87, v37, s[62:63]
  v_cmp_gt_i32 s[56:57], 48, v38
  v_cmp_gt_i32 s[58:59], 49, v38
  v_cmp_gt_i32 s[60:61], 50, v38
  v_cmp_gt_i32 s[62:63], 51, v38
  v_cndmask_b32 v88, v88, v37, s[56:57]
  v_cndmask_b32 v89, v89, v37, s[58:59]
  v_cndmask_b32 v90, v90, v37, s[60:61]
  v_cndmask_b32 v91, v91, v37, s[62:63]
  v_cmp_gt_i32 s[56:57], 56, v38
  v_cmp_gt_i32 s[58:59], 57, v38
  v_cmp_gt_i32 s[60:61], 58, v38
  v_cmp_gt_i32 s[62:63], 59, v38
  v_cndmask_b32 v92, v92, v37, s[56:57]
  v_cndmask_b32 v93, v93, v37, s[58:59]
  v_cndmask_b32 v94, v94, v37, s[60:61]
  v_cndmask_b32 v95, v95, v37, s[62:63]
  s_branch L_ret_39
L_mask0_41:
  s_lshl_b32 s52, s32, 6
  v_subrev_u32 v38, s52, v26
  v_cmp_gt_i32 s[56:57], 0, v38
  v_cmp_gt_i32 s[58:59], 1, v38
  v_cmp_gt_i32 s[60:61], 2, v38
  v_cmp_gt_i32 s[62:63], 3, v38
  v_cndmask_b32 v96, v96, v37, s[56:57]
  v_cndmask_b32 v97, v97, v37, s[58:59]
  v_cndmask_b32 v98, v98, v37, s[60:61]
  v_cndmask_b32 v99, v99, v37, s[62:63]
  v_cmp_gt_i32 s[56:57], 8, v38
  v_cmp_gt_i32 s[58:59], 9, v38
  v_cmp_gt_i32 s[60:61], 10, v38
  v_cmp_gt_i32 s[62:63], 11, v38
  v_cndmask_b32 v100, v100, v37, s[56:57]
  v_cndmask_b32 v101, v101, v37, s[58:59]
  v_cndmask_b32 v102, v102, v37, s[60:61]
  v_cndmask_b32 v103, v103, v37, s[62:63]
  v_cmp_gt_i32 s[56:57], 16, v38
  v_cmp_gt_i32 s[58:59], 17, v38
  v_cmp_gt_i32 s[60:61], 18, v38
  v_cmp_gt_i32 s[62:63], 19, v38
  v_cndmask_b32 v104, v104, v37, s[56:57]
  v_cndmask_b32 v105, v105, v37, s[58:59]
  v_cndmask_b32 v106, v106, v37, s[60:61]
  v_cndmask_b32 v107, v107, v37, s[62:63]
  v_cmp_gt_i32 s[56:57], 24, v38
  v_cmp_gt_i32 s[58:59], 25, v38
  v_cmp_gt_i32 s[60:61], 26, v38
  v_cmp_gt_i32 s[62:63], 27, v38
  v_cndmask_b32 v108, v108, v37, s[56:57]
  v_cndmask_b32 v109, v109, v37, s[58:59]
  v_cndmask_b32 v110, v110, v37, s[60:61]
  v_cndmask_b32 v111, v111, v37, s[62:63]
  s_branch L_ret_42
L_mask1_43:
  s_lshl_b32 s52, s32, 6
  v_subrev_u32 v38, s52, v26
  v_cmp_gt_i32 s[56:57], 32, v38
  v_cmp_gt_i32 s[58:59], 33, v38
  v_cmp_gt_i32 s[60:61], 34, v38
  v_cmp_gt_i32 s[62:63], 35, v38
  v_cndmask_b32 v112, v112, v37, s[56:57]
  v_cndmask_b32 v113, v113, v37, s[58:59]
  v_cndmask_b32 v114, v114, v37, s[60:61]
  v_cndmask_b32 v115, v115, v37, s[62:63]
  v_cmp_gt_i32 s[56:57], 40, v38
  v_cmp_gt_i32 s[58:59], 41, v38
  v_cmp_gt_i32 s[60:61], 42, v38
  v_cmp_gt_i32 s[62:63], 43, v38
  v_cndmask_b32 v116, v116, v37, s[56:57]
  v_cndmask_b32 v117, v117, v37, s[58:59]
  v_cndmask_b32 v118, v118, v37, s[60:61]
  v_cndmask_b32 v119, v119, v37, s[62:63]
  v_cmp_gt_i32 s[56:57], 48, v38
  v_cmp_gt_i32 s[58:59], 49, v38
  v_cmp_gt_i32 s[60:61], 50, v38
  v_cmp_gt_i32 s[62:63], 51, v38
  v_cndmask_b32 v120, v120, v37, s[56:57]
  v_cndmask_b32 v121, v121, v37, s[58:59]
  v_cndmask_b32 v122, v122, v37, s[60:61]
  v_cndmask_b32 v123, v123, v37, s[62:63]
  v_cmp_gt_i32 s[56:57], 56, v38
  v_cmp_gt_i32 s[58:59], 57, v38
  v_cmp_gt_i32 s[60:61], 58, v38
  v_cmp_gt_i32 s[62:63], 59, v38
  v_cndmask_b32 v124, v124, v37, s[56:57]
  v_cndmask_b32 v125, v125, v37, s[58:59]
  v_cndmask_b32 v126, v126, v37, s[60:61]
  v_cndmask_b32 v127, v127, v37, s[62:63]
  s_branch L_ret_44
.section .rodata,"a"
.p2align 6
.amdhsa_kernel standalone__softmax_full_causal__prompt_kernel
  .amdhsa_next_free_vgpr 512
  .amdhsa_next_free_sgpr 102
  .amdhsa_accum_offset 256
  .amdhsa_group_segment_fixed_size 0
  .amdhsa_kernarg_size 48
  .amdhsa_user_sgpr_count 2
  .amdhsa_user_sgpr_kernarg_segment_ptr 1
  .amdhsa_system_sgpr_workgroup_id_x 1
.end_amdhsa_kernel
```
